```python
import torch

def _softmax(x, axis=-1):
    return torch.softmax(x, dim=axis)
def _gelu(x):
    return torch.nn.functional.gelu(x, approximate="tanh")
def _silu(x):
    return torch.nn.functional.silu(x)
def _sigmoid(x):
    return torch.sigmoid(x)
def _layernorm(x, axis=-1, eps=1e-5):
    m = x.mean(dim=axis, keepdim=True)
    v = x.var(dim=axis, keepdim=True, unbiased=False)
    return (x - m) / torch.sqrt(v + eps)
def _scatter_add(tgt, idx, src, axis=0):
    return tgt.clone().index_add_(axis, idx, src)
def _segment_sum(src, seg, n):
    out = torch.zeros((n,) + src.shape[1:], dtype=src.dtype)
    return out.index_add_(0, seg, src)
def _pad(x, pw):
    flat = tuple(v for pair in reversed(pw) for v in pair)
    return torch.nn.functional.pad(x, flat)

kernel_name = 'gated_mix__sliding_block__swiglu_ffn__prompt'

def setup_inputs():

    _w = (lambda a: (lambda t: t.to(torch.bfloat16) if t.is_floating_point() else t)(torch.as_tensor(a)))
    def _A_setup():
        B, S, D = 1, 2048, 1024
        return {
            "x": _w((lambda *s: torch.randn(*s, dtype=torch.bfloat16) * 0.05)(B, S, D)),
            "wqkv": _w((lambda *s: torch.randn(*s, dtype=torch.bfloat16) * 1.6)(D, 3 * D)),
            "wo": _w((lambda *s: torch.randn(*s, dtype=torch.bfloat16) * 0.1)(D, D)),
        }
    _A_in = _A_setup()

    def _B_setup():
        B, S, D, F = 1, 2048, 1024, 3584
        return {
            "x": _w((lambda *s: torch.randn(*s, dtype=torch.bfloat16) * 0.05)(B, S, D)),
            "w_gate": _w((lambda *s: torch.randn(*s, dtype=torch.bfloat16) * 0.4)(D, F)),
            "w_up": _w((lambda *s: torch.randn(*s, dtype=torch.bfloat16) * 0.4)(D, F)),
            "w_down": _w((lambda *s: torch.randn(*s, dtype=torch.bfloat16) * 0.4)(F, D)),
        }
    _B_in = _B_setup()

    return {
        "A_x": _A_in["x"],
        "A_wqkv": _A_in["wqkv"],
        "A_wo": _A_in["wo"],
        "B_x": _B_in["x"],
        "B_w_gate": _B_in["w_gate"],
        "B_w_up": _B_in["w_up"],
        "B_w_down": _B_in["w_down"],
        "gate_w": _w((lambda *s: torch.randn(*s, dtype=torch.bfloat16) * 0.05)(1024) * 16.0),
    }

def reference(A_x, A_wqkv, A_wo, B_x, B_w_gate, B_w_up, B_w_down, gate_w):
    def _A_ref(x, wqkv, wo):
        B, S, D = x.shape
        H = 32; Dh = D // H; W = 256
        qkv = (lambda x, *d: x.permute(*d))((x @ wqkv).reshape(B, S, 3, H, Dh), 2, 0, 3, 1, 4)
        q, k, v = qkv[0], qkv[1], qkv[2]
        scores = torch.einsum("bhqd,bhkd->bhqk", q, k) * (Dh ** -0.5)
        idx = torch.arange(S)
        mask = (idx[:, None] - idx[None, :] >= 0) & (idx[:, None] - idx[None, :] < W)
        scores = torch.where(mask[None, None], scores, -1e9)
        p = _softmax(scores, axis=-1)
        o = torch.einsum("bhqk,bhkd->bhqd", p, v)
        return (lambda x, *d: x.permute(*d))(o, 0, 2, 1, 3).reshape(B, S, D) @ wo

    def _B_ref(x, w_gate, w_up, w_down):
        g = _silu(x @ w_gate)
        u = x @ w_up
        return (g * u) @ w_down

    x = A_x
    g = _sigmoid((x * gate_w).sum(-1, keepdims=True))
    a = _A_ref(x, A_wqkv, A_wo)
    b = _B_ref(x, B_w_gate, B_w_up, B_w_down)
    return g * a + (1 - g) * b
```

```asm
; @launch kernel=fz_kernel grid=(256,1,1) block=(256,1,1) lds=163840
.amdgcn_target "amdgcn-amd-amdhsa--gfx950"
.text
.globl fz_kernel
.p2align 8
.type fz_kernel,@function
fz_kernel:

    s_cmp_ge_u32 s2, 256
    s_cbranch_scc1 Lf_end
    s_load_dwordx4 s[4:7], s[0:1], 0
    s_load_dwordx4 s[8:11], s[0:1], 32
    s_load_dwordx2 s[12:13], s[0:1], 80
    s_load_dwordx4 s[40:43], s[0:1], 48
    s_load_dwordx2 s[44:45], s[0:1], 16
    s_load_dwordx2 s[100:101], s[0:1], 72
    v_lshrrev_b32 v1, 6, v0
    v_and_b32 v2, 63, v0
    v_readfirstlane_b32 s56, v1
    s_and_b32 s57, s2, 7
    s_lshr_b32 s58, s2, 3
    s_and_b32 s59, s58, 3
    s_lshr_b32 s58, s58, 2
    s_lshl_b32 s64, s58, 8
    v_lshrrev_b32 v3, 3, v2
    s_lshr_b32 s65, s56, 1
    s_lshl_b32 s65, s65, 7
    s_and_b32 s66, s56, 1
    s_lshl_b32 s66, s66, 5
    s_add_u32 s53, s65, s66
    s_add_u32 s65, s53, s64
    v_add_u32 v8, s65, v3
    v_lshlrev_b32 v8, 11, v8
    v_lshrrev_b32 v9, 4, v2
    v_and_b32 v10, 7, v2
    v_xor_b32 v9, v9, v10
    v_lshl_add_u32 v4, v9, 4, v8
    v_xor_b32 v9, 4, v9
    v_lshl_add_u32 v5, v9, 4, v8
    v_add_u32 v5, 15360, v5
    v_add_u32 v6, 30720, v4
    v_add_u32 v7, 30720, v5
    s_lshl_b32 s53, s53, 7
    s_mov_b32 s48, 0
    s_getpc_b64 s[76:77]
Lk1_pc:
    s_sub_u32 s76, s76, Lk1_pc-fz_kernel
    s_subb_u32 s77, s77, 0
    s_lshr_b32 s72, s2, 3
    s_lshl_b32 s72, s72, 2
    s_add_u32 s72, s72, s56
    s_lshl_b32 s72, s72, 9
    v_lshrrev_b32 v32, 4, v2
    v_lshlrev_b32 v32, 7, v32
    v_add_u32 v32, s72, v32
    s_nop 0
    v_min_u32 v32, Lcode_end-fz_kernel-4, v32
    v_mov_b32 v33, s77
    v_add_co_u32 v32, vcc, s76, v32
    s_nop 1
    v_addc_co_u32 v33, vcc, 0, v33, vcc
    global_load_dword v1, v[32:33], off
    s_waitcnt lgkmcnt(0)
    s_mov_b32 s16, s4
    s_mov_b32 s17, s5
    s_mov_b32 s18, 4194304
    s_mov_b32 s19, 0x20000
    s_add_u32 m0, s53, 0
    s_add_u32 s46, s48, 0
    s_nop 0
    buffer_load_dwordx4 v4, s[16:19], s46 offen offset:0 lds
    buffer_load_dwordx4 v5, s[16:19], s46 offen offset:1024 lds
    buffer_load_dwordx4 v6, s[16:19], s46 offen offset:2048 lds
    buffer_load_dwordx4 v7, s[16:19], s46 offen offset:3072 lds
    s_add_u32 m0, s53, 8192
    s_add_u32 s46, s48, 131072
    buffer_load_dwordx4 v4, s[16:19], s46 offen offset:0 lds
    buffer_load_dwordx4 v5, s[16:19], s46 offen offset:1024 lds
    buffer_load_dwordx4 v6, s[16:19], s46 offen offset:2048 lds
    buffer_load_dwordx4 v7, s[16:19], s46 offen offset:3072 lds
    s_add_u32 s48, s48, 128
    s_mul_i32 s60, s57, 7
    s_lshl_b32 s61, s59, 1
    s_add_u32 s60, s60, s61
    s_mov_b32 s62, 0x10011300
    s_mov_b32 s63, 0x12120
    s_cmp_eq_u32 s57, 1
    s_cselect_b32 s62, 0x11031202, s62
    s_cselect_b32 s63, 0x22622, s63
    s_cmp_eq_u32 s57, 2
    s_cselect_b32 s62, 0x141f0504, s62
    s_cselect_b32 s63, 0x22524, s63
    s_cmp_eq_u32 s57, 3
    s_cselect_b32 s62, 0x17160706, s62
    s_cselect_b32 s63, 0x32f28, s63
    s_cmp_eq_u32 s57, 4
    s_cselect_b32 s62, 0x19180908, s62
    s_cselect_b32 s63, 0x32b23, s63
    s_cmp_eq_u32 s57, 5
    s_cselect_b32 s62, 0x1d1a0a0b, s62
    s_cselect_b32 s63, 0x292a, s63
    s_cmp_eq_u32 s57, 6
    s_cselect_b32 s62, 0x1c0d0c1b, s62
    s_cselect_b32 s63, 0x2d2c, s63
    s_cmp_eq_u32 s57, 7
    s_cselect_b32 s62, 0x151e0f0e, s62
    s_cselect_b32 s63, 0x1272e, s63
    s_lshl_b32 s72, s59, 3
    s_lshr_b32 s61, s62, s72
    s_and_b32 s61, s61, 255
    s_and_b32 s98, s63, 255
    s_bfe_u32 s99, s63, 0x80008
    s_lshr_b32 s97, s63, 16
    s_lshl_b32 s72, s97, 3
    s_lshr_b32 s55, s62, s72
    s_and_b32 s55, s55, 255
    s_lshl_b32 s62, s60, 7
    s_lshl_b32 s63, s61, 7
    v_bfe_u32 v12, v2, 4, 1
    s_and_b32 s71, s56, 1
    s_lshl_b32 s66, s71, 1
    v_or_b32 v12, s66, v12
    v_lshlrev_b32 v12, 1, v12
    v_xor_b32 v12, v12, v10
    v_lshlrev_b32 v12, 4, v12
    s_lshl_b32 s66, s56, 3
    v_add_u32 v11, s66, v3
    s_cmp_eq_u32 s59, 3
    s_movk_i32 s68, 6144
    s_movk_i32 s69, 7168
    s_cselect_b32 s67, s68, s69
    v_mad_u32_u24 v8, v11, s69, v12
    v_mad_u32_u24 v9, v11, s67, v12
    v_mad_u32_u24 v10, v11, s68, v12
    v_lshl_add_u32 v16, v11, 11, v12
    s_lshl_b32 s52, s67, 5
    s_mul_i32 s54, s56, 5120
    s_add_u32 s54, s54, 65536
    s_mov_b32 s47, 0
    s_mov_b32 s49, 0
    s_mov_b32 s50, 0
    s_mov_b32 s51, 0
    s_sub_u32 s73, s63, 0
    s_ashr_i32 s74, s73, 31
    s_add_u32 s36, s6, s73
    s_addc_u32 s37, s7, s74
    s_sub_u32 s38, 6291456, s73
    s_mov_b32 s39, 0x20000
    s_sub_u32 s73, s62, 0
    s_ashr_i32 s74, s73, 31
    s_add_u32 s20, s8, s73
    s_addc_u32 s21, s9, s74
    s_sub_u32 s22, 7340032, s73
    s_mov_b32 s23, 0x20000
    s_sub_u32 s73, s62, 1024
    s_ashr_i32 s74, s73, 31
    s_add_u32 s24, s10, s73
    s_addc_u32 s25, s11, s74
    s_sub_u32 s26, 7340032, s73
    s_mov_b32 s27, 0x20000
    s_add_u32 s15, s62, 128
    s_lshl_b32 s75, s98, 7
    s_lshl_b32 s72, s99, 7
    s_cmp_eq_u32 s59, 3
    s_cselect_b32 s76, s6, s8
    s_cselect_b32 s77, s7, s9
    s_cselect_b32 s78, s6, s10
    s_cselect_b32 s79, s7, s11
    s_cselect_b32 s75, s75, s15
    s_cselect_b32 s15, s72, s15
    s_mov_b32 s14, 6291456
    s_cselect_b32 s14, s14, 7340032
    s_sub_u32 s73, s75, 2048
    s_ashr_i32 s74, s73, 31
    s_add_u32 s28, s76, s73
    s_addc_u32 s29, s77, s74
    s_sub_u32 s30, s14, s73
    s_mov_b32 s31, 0x20000
    s_sub_u32 s73, s15, 3072
    s_ashr_i32 s74, s73, 31
    s_add_u32 s32, s78, s73
    s_addc_u32 s33, s79, s74
    s_sub_u32 s34, s14, s73
    s_mov_b32 s35, 0x20000
    s_add_u32 m0, s54, 4096
    s_add_u32 s47, s51, 196608
    buffer_load_dwordx4 v10, s[36:39], s51 offen  nt lds
    s_add_u32 m0, s54, 24576
    s_nop 0
    buffer_load_dwordx4 v10, s[36:39], s47 offen  nt lds
    s_add_u32 s51, s47, 196608
    s_add_u32 m0, s54, 0
    s_add_u32 s47, s49, 229376
    buffer_load_dwordx4 v8, s[20:23], s49 offen offset:0 nt lds
    s_add_u32 m0, s54, 20480
    s_nop 0
    buffer_load_dwordx4 v8, s[20:23], s47 offen offset:0 nt lds
    s_add_u32 m0, s54, 0
    s_add_u32 s47, s49, 229376
    buffer_load_dwordx4 v8, s[24:27], s49 offen offset:1024 nt lds
    s_add_u32 m0, s54, 20480
    s_nop 0
    buffer_load_dwordx4 v8, s[24:27], s47 offen offset:1024 nt lds
    s_add_u32 s49, s47, 229376
    s_add_u32 m0, s54, 0
    s_add_u32 s47, s50, s52
    buffer_load_dwordx4 v9, s[28:31], s50 offen offset:2048 nt lds
    s_add_u32 m0, s54, 20480
    s_nop 0
    buffer_load_dwordx4 v9, s[28:31], s47 offen offset:2048 nt lds
    s_add_u32 m0, s54, 0
    s_add_u32 s47, s50, s52
    buffer_load_dwordx4 v9, s[32:35], s50 offen offset:3072 nt lds
    s_add_u32 m0, s54, 20480
    s_nop 0
    buffer_load_dwordx4 v9, s[32:35], s47 offen offset:3072 nt lds
    s_add_u32 s50, s47, s52
    s_add_u32 m0, s54, 45056
    s_add_u32 s47, s51, 196608
    buffer_load_dwordx4 v10, s[36:39], s51 offen  nt lds
    s_add_u32 m0, s54, 65536
    s_nop 0
    buffer_load_dwordx4 v10, s[36:39], s47 offen  nt lds
    s_add_u32 s51, s47, 196608
    v_and_b32 v11, 15, v2
    s_lshr_b32 s70, s56, 1
    s_lshl_b32 s72, s70, 7
    v_add_u32 v11, s72, v11
    v_lshlrev_b32 v11, 7, v11
    v_lshrrev_b32 v12, 4, v2
    v_bfe_u32 v13, v2, 1, 3
    v_xor_b32 v13, v13, v12
    v_lshl_add_u32 v11, v13, 4, v11
    v_xor_b32 v17, 64, v11
    v_lshrrev_b32 v20, 4, v2
    v_bfe_u32 v21, v2, 2, 2
    v_bfe_u32 v22, v2, 3, 2
    v_lshlrev_b32 v21, 7, v21
    v_and_b32 v23, 3, v2
    v_lshl_add_u32 v21, v23, 3, v21
    v_xor_b32_e64 v23, s56, v22
    v_lshl_add_u32 v18, v23, 5, v21
    v_lshl_add_u32 v18, v20, 10, v18
    v_add_u32 v18, 147456, v18
    s_lshl_b32 s72, s71, 1
    v_xor_b32 v22, s72, v22
    v_xor_b32 v23, 1, v22
    v_mul_u32_u24 v20, 5120, v20
    v_add_u32 v20, v20, v21
    v_add_u32 v20, 65536, v20
    v_lshl_add_u32 v12, v22, 5, v20
    v_lshl_add_u32 v13, v23, 5, v20
    v_add_u32 v14, 61440, v12
    v_add_u32 v15, 61440, v13
    v_lshlrev_b32 v19, 4, v2
    s_sub_u32 s76, s59, s97
    s_sub_u32 s76, s76, 1
    s_and_b32 s76, s76, 3
    s_and_b32 s72, s76, 1
    s_lshl_b32 s72, s72, 3
    s_add_u32 s72, s72, s58
    s_lshl_b32 s72, s72, 2
    s_add_u32 s72, s72, s56
    s_lshl_b32 s72, s72, 1
    s_mul_i32 s73, s57, 7
    s_lshl_b32 s77, s97, 1
    s_add_u32 s73, s73, s77
    s_lshl_b32 s73, s73, 7
    s_mul_i32 s14, s72, 7168
    s_add_u32 s73, s73, s14
    s_mul_i32 s74, s72, 6144
    v_and_b32 v39, 1, v2
    s_add_u32 s14, s73, 0
    s_add_u32 s14, s8, s14
    s_addc_u32 s15, s9, 0
    v_mov_b32 v36, s14
    v_mov_b32 v37, s15
    v_mov_b32 v38, 7168
    s_add_u32 s14, s73, 0
    s_add_u32 s14, s10, s14
    s_addc_u32 s15, s11, 0
    s_mov_b64 exec, 12
    v_mov_b32 v36, s14
    v_mov_b32 v37, s15
    v_mov_b32 v38, 7168
    s_lshl_b32 s77, s55, 7
    s_add_u32 s14, s77, s74
    s_add_u32 s14, s6, s14
    s_addc_u32 s15, s7, 0
    s_mov_b64 exec, 768
    v_mov_b32 v36, s14
    v_mov_b32 v37, s15
    v_mov_b32 v38, 6144
    s_cmp_eq_u32 s97, 3
    s_cbranch_scc1 Lk1_bpY
    s_add_u32 s14, s73, 128
    s_add_u32 s14, s8, s14
    s_addc_u32 s15, s9, 0
    s_mov_b64 exec, 48
    v_mov_b32 v36, s14
    v_mov_b32 v37, s15
    v_mov_b32 v38, 7168
    s_add_u32 s14, s73, 128
    s_add_u32 s14, s10, s14
    s_addc_u32 s15, s11, 0
    s_mov_b64 exec, 192
    v_mov_b32 v36, s14
    v_mov_b32 v37, s15
    v_mov_b32 v38, 7168
    s_branch Lk1_bpD
Lk1_bpY:
    s_lshl_b32 s77, s98, 7
    s_add_u32 s14, s77, s74
    s_add_u32 s14, s6, s14
    s_addc_u32 s15, s7, 0
    s_mov_b64 exec, 48
    v_mov_b32 v36, s14
    v_mov_b32 v37, s15
    v_mov_b32 v38, 6144
    s_lshl_b32 s77, s99, 7
    s_add_u32 s14, s77, s74
    s_add_u32 s14, s6, s14
    s_addc_u32 s15, s7, 0
    s_mov_b64 exec, 192
    v_mov_b32 v36, s14
    v_mov_b32 v37, s15
    v_mov_b32 v38, 6144
Lk1_bpD:
    s_mov_b64 exec, -1
    v_mul_u32_u24 v39, v39, v38
    v_add_co_u32 v36, vcc, v36, v39
    v_lshlrev_b32 v38, 7, v38
    s_cmp_lt_u32 s76, 2
    v_addc_co_u32 v37, vcc, 0, v37, vcc
    s_cbranch_scc1 Lk1_bpH
    v_mov_b32 v36, s42
    v_mov_b32 v37, s43
    v_mov_b32 v38, 0
Lk1_bpH:
    s_mov_b32 s96, 2
    s_mov_b32 s78, s42
    s_mov_b32 s79, s43
    s_mov_b32 s10, s40
    s_mov_b32 s11, s41
    s_mov_b32 s8, s44
    s_mov_b32 s9, s45
    s_mov_b32 s42, 0
    s_mov_b32 s43, 0x20000
    s_mov_b32 s4, s12
    s_mov_b32 s5, s13
    s_mov_b32 s6, 67108864
    s_mov_b32 s7, 0x20000
    s_mov_b32 s3, 7340032
    s_mul_i32 s14, s2, 9
    s_lshl_b32 s44, s56, 10
    s_add_u32 s65, s44, 37748736
    s_add_u32 s44, s44, 147456
    s_waitcnt vmcnt(10)
    s_barrier
    ds_read_b64_tr_b16 a[128:129], v12 offset:4096
    ds_read_b64_tr_b16 a[130:131], v12 offset:4608
    ds_read_b64_tr_b16 a[132:133], v12 offset:24576
    ds_read_b64_tr_b16 a[134:135], v12 offset:25088
    ds_read_b128 a[0:3], v11 offset:0
    ds_read_b128 a[32:35], v17 offset:0
    ds_read_b128 a[4:7], v11 offset:2048
    ds_read_b128 a[36:39], v17 offset:2048
    ds_read_b128 a[8:11], v11 offset:4096
    ds_read_b128 a[40:43], v17 offset:4096
    ds_read_b128 a[12:15], v11 offset:6144
    ds_read_b128 a[44:47], v17 offset:6144
    ds_read_b128 a[16:19], v11 offset:8192
    ds_read_b128 a[48:51], v17 offset:8192
    ds_read_b128 a[20:23], v11 offset:10240
    ds_read_b128 a[52:55], v17 offset:10240
    ds_read_b128 a[24:27], v11 offset:12288
    ds_read_b128 a[56:59], v17 offset:12288
    ds_read_b128 a[28:31], v11 offset:14336
    ds_read_b128 a[60:63], v17 offset:14336
    s_waitcnt lgkmcnt(0)
    v_mfma_f32_16x16x32_bf16 a[148:151], a[128:131], a[0:3], 0
    ds_read_b64_tr_b16 a[136:137], v13 offset:4096
    ds_read_b64_tr_b16 a[138:139], v13 offset:4608
    v_mfma_f32_16x16x32_bf16 a[148:151], a[132:135], a[32:35], a[148:151]
    ds_read_b64_tr_b16 a[140:141], v13 offset:24576
    ds_read_b64_tr_b16 a[142:143], v13 offset:25088
    v_mfma_f32_16x16x32_bf16 a[160:163], a[128:131], a[4:7], 0
    s_add_u32 m0, s53, 32768
    s_add_u32 s46, s48, 0
    v_mfma_f32_16x16x32_bf16 a[160:163], a[132:135], a[36:39], a[160:163]
    buffer_load_dwordx4 v4, s[16:19], s46 offen offset:0 lds
    v_mfma_f32_16x16x32_bf16 a[172:175], a[128:131], a[8:11], 0
    buffer_load_dwordx4 v5, s[16:19], s46 offen offset:1024 lds
    v_mfma_f32_16x16x32_bf16 a[172:175], a[132:135], a[40:43], a[172:175]
    buffer_load_dwordx4 v6, s[16:19], s46 offen offset:2048 lds
    v_mfma_f32_16x16x32_bf16 a[184:187], a[128:131], a[12:15], 0
    buffer_load_dwordx4 v7, s[16:19], s46 offen offset:3072 lds
    v_mfma_f32_16x16x32_bf16 a[184:187], a[132:135], a[44:47], a[184:187]
    v_mfma_f32_16x16x32_bf16 a[200:203], a[128:131], a[16:19], 0
    v_mfma_f32_16x16x32_bf16 a[200:203], a[132:135], a[48:51], a[200:203]
    v_mfma_f32_16x16x32_bf16 a[216:219], a[128:131], a[20:23], 0
    v_mfma_f32_16x16x32_bf16 a[216:219], a[132:135], a[52:55], a[216:219]
    v_mfma_f32_16x16x32_bf16 a[232:235], a[128:131], a[24:27], 0
    v_mfma_f32_16x16x32_bf16 a[232:235], a[132:135], a[56:59], a[232:235]
    v_mfma_f32_16x16x32_bf16 a[248:251], a[128:131], a[28:31], 0
    v_mfma_f32_16x16x32_bf16 a[248:251], a[132:135], a[60:63], a[248:251]
    s_waitcnt vmcnt(12) lgkmcnt(0)
    s_barrier
    v_mfma_f32_16x16x32_bf16 a[152:155], a[136:139], a[0:3], 0
    v_mfma_f32_16x16x32_bf16 a[152:155], a[140:143], a[32:35], a[152:155]
    ds_read_b64_tr_b16 a[128:129], v12 offset:0
    ds_read_b64_tr_b16 a[130:131], v12 offset:512
    v_mfma_f32_16x16x32_bf16 a[164:167], a[136:139], a[4:7], 0
    ds_read_b64_tr_b16 a[132:133], v12 offset:20480
    ds_read_b64_tr_b16 a[134:135], v12 offset:20992
    v_mfma_f32_16x16x32_bf16 a[164:167], a[140:143], a[36:39], a[164:167]
    s_add_u32 m0, s53, 40960
    s_add_u32 s46, s48, 131072
    v_mfma_f32_16x16x32_bf16 a[176:179], a[136:139], a[8:11], 0
    buffer_load_dwordx4 v4, s[16:19], s46 offen offset:0 lds
    v_mfma_f32_16x16x32_bf16 a[176:179], a[140:143], a[40:43], a[176:179]
    buffer_load_dwordx4 v5, s[16:19], s46 offen offset:1024 lds
    v_mfma_f32_16x16x32_bf16 a[188:191], a[136:139], a[12:15], 0
    buffer_load_dwordx4 v6, s[16:19], s46 offen offset:2048 lds
    v_mfma_f32_16x16x32_bf16 a[188:191], a[140:143], a[44:47], a[188:191]
    v_mfma_f32_16x16x32_bf16 a[204:207], a[136:139], a[16:19], 0
    v_mfma_f32_16x16x32_bf16 a[204:207], a[140:143], a[48:51], a[204:207]
    v_mfma_f32_16x16x32_bf16 a[220:223], a[136:139], a[20:23], 0
    v_mfma_f32_16x16x32_bf16 a[220:223], a[140:143], a[52:55], a[220:223]
    v_mfma_f32_16x16x32_bf16 a[236:239], a[136:139], a[24:27], 0
    v_mfma_f32_16x16x32_bf16 a[236:239], a[140:143], a[56:59], a[236:239]
    v_mfma_f32_16x16x32_bf16 a[252:255], a[136:139], a[28:31], 0
    v_mfma_f32_16x16x32_bf16 a[252:255], a[140:143], a[60:63], a[252:255]
    s_waitcnt lgkmcnt(0)
    v_mfma_f32_16x16x32_bf16 v[48:51], a[128:131], a[0:3], 0
    ds_read_b64_tr_b16 a[136:137], v13 offset:0
    ds_read_b64_tr_b16 a[138:139], v13 offset:512
    v_mfma_f32_16x16x32_bf16 v[48:51], a[132:135], a[32:35], v[48:51]
    ds_read_b64_tr_b16 a[140:141], v13 offset:20480
    ds_read_b64_tr_b16 a[142:143], v13 offset:20992
    v_mfma_f32_16x16x32_bf16 v[76:79], a[128:131], a[4:7], 0
    buffer_load_dwordx4 v7, s[16:19], s46 offen offset:3072 lds
    v_mfma_f32_16x16x32_bf16 v[76:79], a[132:135], a[36:39], v[76:79]
    s_add_u32 s48, s48, 128
    s_add_u32 m0, s54, 40960
    v_mfma_f32_16x16x32_bf16 v[104:107], a[128:131], a[8:11], 0
    s_add_u32 s47, s49, 229376
    v_mfma_f32_16x16x32_bf16 v[104:107], a[132:135], a[40:43], v[104:107]
    buffer_load_dwordx4 v8, s[20:23], s49 offen offset:0 nt lds
    v_mfma_f32_16x16x32_bf16 v[132:135], a[128:131], a[12:15], 0
    s_add_u32 m0, s54, 61440
    v_mfma_f32_16x16x32_bf16 v[132:135], a[132:135], a[44:47], v[132:135]
    buffer_load_dwordx4 v8, s[20:23], s47 offen offset:0 nt lds
    v_mfma_f32_16x16x32_bf16 v[160:163], a[128:131], a[16:19], 0
    v_mfma_f32_16x16x32_bf16 v[160:163], a[132:135], a[48:51], v[160:163]
    v_mfma_f32_16x16x32_bf16 v[184:187], a[128:131], a[20:23], 0
    v_mfma_f32_16x16x32_bf16 v[184:187], a[132:135], a[52:55], v[184:187]
    v_mfma_f32_16x16x32_bf16 v[208:211], a[128:131], a[24:27], 0
    v_mfma_f32_16x16x32_bf16 v[208:211], a[132:135], a[56:59], v[208:211]
    v_mfma_f32_16x16x32_bf16 v[232:235], a[128:131], a[28:31], 0
    v_mfma_f32_16x16x32_bf16 v[232:235], a[132:135], a[60:63], v[232:235]
    s_waitcnt vmcnt(16) lgkmcnt(0)
    s_barrier
    v_mfma_f32_16x16x32_bf16 v[52:55], a[136:139], a[0:3], 0
    v_mfma_f32_16x16x32_bf16 v[52:55], a[140:143], a[32:35], v[52:55]
    ds_read_b64_tr_b16 a[128:129], v12 offset:1024
    ds_read_b64_tr_b16 a[130:131], v12 offset:1536
    v_mfma_f32_16x16x32_bf16 v[80:83], a[136:139], a[4:7], 0
    ds_read_b64_tr_b16 a[132:133], v12 offset:21504
    ds_read_b64_tr_b16 a[134:135], v12 offset:22016
    v_mfma_f32_16x16x32_bf16 v[80:83], a[140:143], a[36:39], v[80:83]
    s_add_u32 m0, s54, 40960
    s_add_u32 s47, s49, 229376
    v_mfma_f32_16x16x32_bf16 v[108:111], a[136:139], a[8:11], 0
    buffer_load_dwordx4 v8, s[24:27], s49 offen offset:1024 nt lds
    v_mfma_f32_16x16x32_bf16 v[108:111], a[140:143], a[40:43], v[108:111]
    s_add_u32 m0, s54, 61440
    v_mfma_f32_16x16x32_bf16 v[136:139], a[136:139], a[12:15], 0
    buffer_load_dwordx4 v8, s[24:27], s47 offen offset:1024 nt lds
    v_mfma_f32_16x16x32_bf16 v[136:139], a[140:143], a[44:47], v[136:139]
    s_add_u32 s49, s47, 229376
    s_add_u32 m0, s53, 0
    v_mfma_f32_16x16x32_bf16 v[164:167], a[136:139], a[16:19], 0
    s_add_u32 s46, s48, 0
    v_mfma_f32_16x16x32_bf16 v[164:167], a[140:143], a[48:51], v[164:167]
    buffer_load_dwordx4 v4, s[16:19], s46 offen offset:0 lds
    v_mfma_f32_16x16x32_bf16 v[188:191], a[136:139], a[20:23], 0
    v_mfma_f32_16x16x32_bf16 v[188:191], a[140:143], a[52:55], v[188:191]
    v_mfma_f32_16x16x32_bf16 v[212:215], a[136:139], a[24:27], 0
    v_mfma_f32_16x16x32_bf16 v[212:215], a[140:143], a[56:59], v[212:215]
    v_mfma_f32_16x16x32_bf16 v[236:239], a[136:139], a[28:31], 0
    v_mfma_f32_16x16x32_bf16 v[236:239], a[140:143], a[60:63], v[236:239]
    s_waitcnt lgkmcnt(0)
    v_mfma_f32_16x16x32_bf16 v[56:59], a[128:131], a[0:3], 0
    ds_read_b64_tr_b16 a[136:137], v13 offset:1024
    ds_read_b64_tr_b16 a[138:139], v13 offset:1536
    v_mfma_f32_16x16x32_bf16 v[56:59], a[132:135], a[32:35], v[56:59]
    ds_read_b64_tr_b16 a[140:141], v13 offset:21504
    ds_read_b64_tr_b16 a[142:143], v13 offset:22016
    v_mfma_f32_16x16x32_bf16 v[84:87], a[128:131], a[4:7], 0
    buffer_load_dwordx4 v5, s[16:19], s46 offen offset:1024 lds
    v_mfma_f32_16x16x32_bf16 v[84:87], a[132:135], a[36:39], v[84:87]
    buffer_load_dwordx4 v6, s[16:19], s46 offen offset:2048 lds
    v_mfma_f32_16x16x32_bf16 v[112:115], a[128:131], a[8:11], 0
    buffer_load_dwordx4 v7, s[16:19], s46 offen offset:3072 lds
    v_mfma_f32_16x16x32_bf16 v[112:115], a[132:135], a[40:43], v[112:115]
    v_mfma_f32_16x16x32_bf16 v[140:143], a[128:131], a[12:15], 0
    v_mfma_f32_16x16x32_bf16 v[140:143], a[132:135], a[44:47], v[140:143]
    v_mfma_f32_16x16x32_bf16 v[168:171], a[128:131], a[16:19], 0
    v_mfma_f32_16x16x32_bf16 v[168:171], a[132:135], a[48:51], v[168:171]
    v_mfma_f32_16x16x32_bf16 v[192:195], a[128:131], a[20:23], 0
    v_mfma_f32_16x16x32_bf16 v[192:195], a[132:135], a[52:55], v[192:195]
    v_mfma_f32_16x16x32_bf16 v[216:219], a[128:131], a[24:27], 0
    v_mfma_f32_16x16x32_bf16 v[216:219], a[132:135], a[56:59], v[216:219]
    v_mfma_f32_16x16x32_bf16 v[240:243], a[128:131], a[28:31], 0
    v_mfma_f32_16x16x32_bf16 v[240:243], a[132:135], a[60:63], v[240:243]
    s_waitcnt vmcnt(12) lgkmcnt(0)
    s_barrier
    v_mfma_f32_16x16x32_bf16 v[60:63], a[136:139], a[0:3], 0
    v_mfma_f32_16x16x32_bf16 v[60:63], a[140:143], a[32:35], v[60:63]
    ds_read_b64_tr_b16 a[128:129], v12 offset:2048
    ds_read_b64_tr_b16 a[130:131], v12 offset:2560
    v_mfma_f32_16x16x32_bf16 v[88:91], a[136:139], a[4:7], 0
    ds_read_b64_tr_b16 a[132:133], v12 offset:22528
    ds_read_b64_tr_b16 a[134:135], v12 offset:23040
    v_mfma_f32_16x16x32_bf16 v[88:91], a[140:143], a[36:39], v[88:91]
    s_add_u32 m0, s54, 40960
    s_add_u32 s47, s50, s52
    v_mfma_f32_16x16x32_bf16 v[116:119], a[136:139], a[8:11], 0
    buffer_load_dwordx4 v9, s[28:31], s50 offen offset:2048 nt lds
    v_mfma_f32_16x16x32_bf16 v[116:119], a[140:143], a[40:43], v[116:119]
    s_add_u32 m0, s54, 61440
    ds_read_b128 a[64:67], v11 offset:32768
    v_mfma_f32_16x16x32_bf16 v[144:147], a[136:139], a[12:15], 0
    buffer_load_dwordx4 v9, s[28:31], s47 offen offset:2048 nt lds
    v_mfma_f32_16x16x32_bf16 v[144:147], a[140:143], a[44:47], v[144:147]
    s_add_u32 m0, s54, 40960
    s_add_u32 s47, s50, s52
    v_mfma_f32_16x16x32_bf16 v[172:175], a[136:139], a[16:19], 0
    buffer_load_dwordx4 v9, s[32:35], s50 offen offset:3072 nt lds
    v_mfma_f32_16x16x32_bf16 v[172:175], a[140:143], a[48:51], v[172:175]
    ds_read_b128 a[96:99], v17 offset:32768
    ds_read_b128 a[68:71], v11 offset:34816
    v_mfma_f32_16x16x32_bf16 v[196:199], a[136:139], a[20:23], 0
    ds_read_b128 a[100:103], v17 offset:34816
    v_mfma_f32_16x16x32_bf16 v[196:199], a[140:143], a[52:55], v[196:199]
    v_mfma_f32_16x16x32_bf16 v[220:223], a[136:139], a[24:27], 0
    v_mfma_f32_16x16x32_bf16 v[220:223], a[140:143], a[56:59], v[220:223]
    v_mfma_f32_16x16x32_bf16 v[244:247], a[136:139], a[28:31], 0
    v_mfma_f32_16x16x32_bf16 v[244:247], a[140:143], a[60:63], v[244:247]
    s_waitcnt lgkmcnt(4)
    v_mfma_f32_16x16x32_bf16 v[64:67], a[128:131], a[0:3], 0
    ds_read_b64_tr_b16 a[136:137], v13 offset:2048
    ds_read_b64_tr_b16 a[138:139], v13 offset:2560
    v_mfma_f32_16x16x32_bf16 v[64:67], a[132:135], a[32:35], v[64:67]
    ds_read_b64_tr_b16 a[140:141], v13 offset:22528
    ds_read_b64_tr_b16 a[142:143], v13 offset:23040
    v_mfma_f32_16x16x32_bf16 v[92:95], a[128:131], a[4:7], 0
    s_add_u32 m0, s54, 61440
    ds_read_b128 a[72:75], v11 offset:36864
    v_mfma_f32_16x16x32_bf16 v[92:95], a[132:135], a[36:39], v[92:95]
    buffer_load_dwordx4 v9, s[32:35], s47 offen offset:3072 nt lds
    v_mfma_f32_16x16x32_bf16 v[120:123], a[128:131], a[8:11], 0
    s_add_u32 s50, s47, s52
    s_add_u32 m0, s53, 8192
    v_mfma_f32_16x16x32_bf16 v[120:123], a[132:135], a[40:43], v[120:123]
    s_add_u32 s46, s48, 131072
    ds_read_b128 a[104:107], v17 offset:36864
    v_mfma_f32_16x16x32_bf16 v[148:151], a[128:131], a[12:15], 0
    buffer_load_dwordx4 v4, s[16:19], s46 offen offset:0 lds
    v_mfma_f32_16x16x32_bf16 v[148:151], a[132:135], a[44:47], v[148:151]
    buffer_load_dwordx4 v5, s[16:19], s46 offen offset:1024 lds
    v_mfma_f32_16x16x32_bf16 v[176:179], a[128:131], a[16:19], 0
    ds_read_b128 a[76:79], v11 offset:38912
    ds_read_b128 a[108:111], v17 offset:38912
    v_mfma_f32_16x16x32_bf16 v[176:179], a[132:135], a[48:51], v[176:179]
    v_mfma_f32_16x16x32_bf16 v[200:203], a[128:131], a[20:23], 0
    v_mfma_f32_16x16x32_bf16 v[200:203], a[132:135], a[52:55], v[200:203]
    v_mfma_f32_16x16x32_bf16 v[224:227], a[128:131], a[24:27], 0
    v_mfma_f32_16x16x32_bf16 v[224:227], a[132:135], a[56:59], v[224:227]
    v_mfma_f32_16x16x32_bf16 v[248:251], a[128:131], a[28:31], 0
    v_mfma_f32_16x16x32_bf16 v[248:251], a[132:135], a[60:63], v[248:251]
    s_waitcnt vmcnt(14) lgkmcnt(4)
    s_barrier
    v_mfma_f32_16x16x32_bf16 v[68:71], a[136:139], a[0:3], 0
    v_mfma_f32_16x16x32_bf16 v[68:71], a[140:143], a[32:35], v[68:71]
    ds_read_b64_tr_b16 a[128:129], v12 offset:3072
    ds_read_b64_tr_b16 a[130:131], v12 offset:3584
    v_mfma_f32_16x16x32_bf16 v[96:99], a[136:139], a[4:7], 0
    ds_read_b64_tr_b16 a[132:133], v12 offset:23552
    ds_read_b64_tr_b16 a[134:135], v12 offset:24064
    v_mfma_f32_16x16x32_bf16 v[96:99], a[140:143], a[36:39], v[96:99]
    buffer_load_dwordx4 v6, s[16:19], s46 offen offset:2048 lds
    v_mfma_f32_16x16x32_bf16 v[124:127], a[136:139], a[8:11], 0
    buffer_load_dwordx4 v7, s[16:19], s46 offen offset:3072 lds
    v_mfma_f32_16x16x32_bf16 v[124:127], a[140:143], a[40:43], v[124:127]
    s_add_u32 s48, s48, 128
    s_add_u32 m0, s54, 4096
    v_mfma_f32_16x16x32_bf16 v[152:155], a[136:139], a[12:15], 0
    s_add_u32 s47, s51, 196608
    ds_read_b128 a[80:83], v11 offset:40960
    v_mfma_f32_16x16x32_bf16 v[152:155], a[140:143], a[44:47], v[152:155]
    buffer_load_dwordx4 v10, s[36:39], s51 offen  nt lds
    v_mfma_f32_16x16x32_bf16 v[180:183], a[136:139], a[16:19], 0
    ds_read_b128 a[112:115], v17 offset:40960
    ds_read_b128 a[84:87], v11 offset:43008
    v_mfma_f32_16x16x32_bf16 v[180:183], a[140:143], a[48:51], v[180:183]
    ds_read_b128 a[116:119], v17 offset:43008
    v_mfma_f32_16x16x32_bf16 v[204:207], a[136:139], a[20:23], 0
    v_mfma_f32_16x16x32_bf16 v[204:207], a[140:143], a[52:55], v[204:207]
    v_mfma_f32_16x16x32_bf16 v[228:231], a[136:139], a[24:27], 0
    v_mfma_f32_16x16x32_bf16 v[228:231], a[140:143], a[56:59], v[228:231]
    v_mfma_f32_16x16x32_bf16 v[252:255], a[136:139], a[28:31], 0
    v_mfma_f32_16x16x32_bf16 v[252:255], a[140:143], a[60:63], v[252:255]
    s_waitcnt lgkmcnt(4)
    v_mfma_f32_16x16x32_bf16 v[72:75], a[128:131], a[0:3], 0
    ds_read_b64_tr_b16 a[136:137], v13 offset:3072
    ds_read_b64_tr_b16 a[138:139], v13 offset:3584
    v_mfma_f32_16x16x32_bf16 v[72:75], a[132:135], a[32:35], v[72:75]
    ds_read_b64_tr_b16 a[140:141], v13 offset:23552
    ds_read_b64_tr_b16 a[142:143], v13 offset:24064
    v_mfma_f32_16x16x32_bf16 v[100:103], a[128:131], a[4:7], 0
    s_add_u32 m0, s54, 24576
    ds_read_b128 a[88:91], v11 offset:45056
    v_mfma_f32_16x16x32_bf16 v[100:103], a[132:135], a[36:39], v[100:103]
    buffer_load_dwordx4 v10, s[36:39], s47 offen  nt lds
    v_mfma_f32_16x16x32_bf16 v[128:131], a[128:131], a[8:11], 0
    s_add_u32 s51, s47, 196608
    ds_read_b128 a[120:123], v17 offset:45056
    v_mfma_f32_16x16x32_bf16 v[128:131], a[132:135], a[40:43], v[128:131]
    ds_read_b128 a[92:95], v11 offset:47104
    ds_read_b128 a[124:127], v17 offset:47104
    v_mfma_f32_16x16x32_bf16 v[156:159], a[128:131], a[12:15], 0
    v_mfma_f32_16x16x32_bf16 v[156:159], a[132:135], a[44:47], v[156:159]
    v_mfma_f32_16x16x32_bf16 a[192:195], a[128:131], a[16:19], 0
    v_mfma_f32_16x16x32_bf16 a[192:195], a[132:135], a[48:51], a[192:195]
    v_mfma_f32_16x16x32_bf16 a[208:211], a[128:131], a[20:23], 0
    v_mfma_f32_16x16x32_bf16 a[208:211], a[132:135], a[52:55], a[208:211]
    v_mfma_f32_16x16x32_bf16 a[224:227], a[128:131], a[24:27], 0
    v_mfma_f32_16x16x32_bf16 a[224:227], a[132:135], a[56:59], a[224:227]
    v_mfma_f32_16x16x32_bf16 a[240:243], a[128:131], a[28:31], 0
    v_mfma_f32_16x16x32_bf16 a[240:243], a[132:135], a[60:63], a[240:243]
    s_waitcnt vmcnt(14) lgkmcnt(0)
    s_barrier
    v_mfma_f32_16x16x32_bf16 a[144:147], a[136:139], a[0:3], 0
    v_mfma_f32_16x16x32_bf16 a[144:147], a[140:143], a[32:35], a[144:147]
    ds_read_b64_tr_b16 a[128:129], v12 offset:45056
    ds_read_b64_tr_b16 a[130:131], v12 offset:45568
    v_mfma_f32_16x16x32_bf16 a[156:159], a[136:139], a[4:7], 0
    ds_read_b64_tr_b16 a[132:133], v14 offset:4096
    ds_read_b64_tr_b16 a[134:135], v14 offset:4608
    v_mfma_f32_16x16x32_bf16 a[156:159], a[140:143], a[36:39], a[156:159]
    s_add_u32 m0, s54, 0
    s_add_u32 s47, s49, 229376
    v_mfma_f32_16x16x32_bf16 a[168:171], a[136:139], a[8:11], 0
    buffer_load_dwordx4 v8, s[20:23], s49 offen offset:0 nt lds
    v_mfma_f32_16x16x32_bf16 a[168:171], a[140:143], a[40:43], a[168:171]
    s_lshl_b32 s72, s58, 7
    s_lshl_b32 s73, s56, 2
    v_mfma_f32_16x16x32_bf16 a[180:183], a[136:139], a[12:15], 0
    s_add_u32 s72, s72, s73
    s_add_u32 s72, s72, 50397184
    v_mfma_f32_16x16x32_bf16 a[180:183], a[140:143], a[44:47], a[180:183]
    s_lshl_b32 s62, s61, 10
    s_add_u32 s62, s62, s72
    v_mfma_f32_16x16x32_bf16 a[196:199], a[136:139], a[16:19], 0
    s_lshl_b32 s63, s98, 10
    s_add_u32 s63, s63, s72
    v_mfma_f32_16x16x32_bf16 a[196:199], a[140:143], a[48:51], a[196:199]
    s_lshl_b32 s67, s99, 10
    s_add_u32 s67, s67, s72
    v_mfma_f32_16x16x32_bf16 a[212:215], a[136:139], a[20:23], 0
    s_cmp_eq_u32 s59, 3
    s_cselect_b32 s63, s63, s62
    v_mfma_f32_16x16x32_bf16 a[212:215], a[140:143], a[52:55], a[212:215]
    s_cselect_b32 s67, s67, s62
    s_lshl_b32 s15, s2, 7
    v_mfma_f32_16x16x32_bf16 a[228:231], a[136:139], a[24:27], 0
    s_add_u32 s15, s15, s73
    s_add_u32 s15, s15, 50462720
    v_mfma_f32_16x16x32_bf16 a[228:231], a[140:143], a[56:59], a[228:231]
    v_mfma_f32_16x16x32_bf16 a[244:247], a[136:139], a[28:31], 0
    v_mfma_f32_16x16x32_bf16 a[244:247], a[140:143], a[60:63], a[244:247]
    s_waitcnt lgkmcnt(0)
    v_mfma_f32_16x16x32_bf16 a[148:151], a[128:131], a[64:67], a[148:151]
    ds_read_b64_tr_b16 a[136:137], v13 offset:45056
    ds_read_b64_tr_b16 a[138:139], v13 offset:45568
    v_mfma_f32_16x16x32_bf16 a[148:151], a[132:135], a[96:99], a[148:151]
    ds_read_b64_tr_b16 a[140:141], v15 offset:4096
    ds_read_b64_tr_b16 a[142:143], v15 offset:4608
    v_mfma_f32_16x16x32_bf16 a[160:163], a[128:131], a[68:71], a[160:163]
    s_add_u32 m0, s54, 20480
    v_mfma_f32_16x16x32_bf16 a[160:163], a[132:135], a[100:103], a[160:163]
    buffer_load_dwordx4 v8, s[20:23], s47 offen offset:0 nt lds
    v_mfma_f32_16x16x32_bf16 a[172:175], a[128:131], a[72:75], a[172:175]
    s_add_u32 m0, s53, 32768
    s_add_u32 s46, s48, 0
    v_mfma_f32_16x16x32_bf16 a[172:175], a[132:135], a[104:107], a[172:175]
    buffer_load_dwordx4 v4, s[16:19], s46 offen offset:0 lds
    v_mfma_f32_16x16x32_bf16 a[184:187], a[128:131], a[76:79], a[184:187]
    s_lshr_b32 s68, s2, 2
    s_lshl_b32 s68, s68, 7
    v_mfma_f32_16x16x32_bf16 a[184:187], a[132:135], a[108:111], a[184:187]
    s_and_b32 s72, s2, 3
    s_lshl_b32 s72, s72, 2
    v_mfma_f32_16x16x32_bf16 a[200:203], a[128:131], a[80:83], a[200:203]
    s_add_u32 s68, s68, s72
    s_add_u32 s68, s68, 50528256
    v_mfma_f32_16x16x32_bf16 a[200:203], a[132:135], a[112:115], a[200:203]
    s_lshr_b32 s69, s2, 3
    s_mul_i32 s69, s69, 5
    v_mfma_f32_16x16x32_bf16 a[216:219], a[128:131], a[84:87], a[216:219]
    s_lshr_b32 s69, s69, 3
    s_add_u32 s69, s69, 2
    v_mfma_f32_16x16x32_bf16 a[216:219], a[132:135], a[116:119], a[216:219]
    s_cmp_eq_u32 s56, 0
    s_cselect_b32 s68, s68, 67108864
    v_mfma_f32_16x16x32_bf16 a[232:235], a[128:131], a[88:91], a[232:235]
    s_cselect_b32 s69, s69, 1000
    s_add_u32 s72, s15, 32768
    v_mfma_f32_16x16x32_bf16 a[232:235], a[132:135], a[120:123], a[232:235]
    v_mov_b32 v20, 0
    v_mov_b32 v21, s62
    v_mfma_f32_16x16x32_bf16 a[248:251], a[128:131], a[92:95], a[248:251]
    v_mfma_f32_16x16x32_bf16 a[248:251], a[132:135], a[124:127], a[248:251]
    s_waitcnt vmcnt(13) lgkmcnt(0)
    s_barrier
    v_mfma_f32_16x16x32_bf16 a[152:155], a[136:139], a[64:67], a[152:155]
    ds_read_b64_tr_b16 a[128:129], v12 offset:40960
    ds_read_b64_tr_b16 a[130:131], v12 offset:41472
    v_mfma_f32_16x16x32_bf16 a[152:155], a[140:143], a[96:99], a[152:155]
    ds_read_b64_tr_b16 a[132:133], v14 offset:0
    ds_read_b64_tr_b16 a[134:135], v14 offset:512
    v_mfma_f32_16x16x32_bf16 a[164:167], a[136:139], a[68:71], a[164:167]
    s_add_u32 m0, s54, 0
    s_add_u32 s47, s49, 229376
    v_mfma_f32_16x16x32_bf16 a[164:167], a[140:143], a[100:103], a[164:167]
    buffer_load_dwordx4 v8, s[24:27], s49 offen offset:1024 nt lds
    v_mfma_f32_16x16x32_bf16 a[176:179], a[136:139], a[72:75], a[176:179]
    s_add_u32 m0, s53, 32768
    ds_read_b128 a[0:3], v11 offset:0
    v_mfma_f32_16x16x32_bf16 a[176:179], a[140:143], a[104:107], a[176:179]
    buffer_load_dwordx4 v5, s[16:19], s46 offen offset:1024 lds
    v_mfma_f32_16x16x32_bf16 a[188:191], a[136:139], a[76:79], a[188:191]
    v_writelane_b32 v21, s63, 1
    v_writelane_b32 v21, s67, 2
    v_mfma_f32_16x16x32_bf16 a[188:191], a[140:143], a[108:111], a[188:191]
    v_writelane_b32 v21, s15, 3
    v_writelane_b32 v21, s72, 4
    v_mfma_f32_16x16x32_bf16 a[204:207], a[136:139], a[80:83], a[204:207]
    v_writelane_b32 v21, s68, 5
    ds_read_b128 a[32:35], v17 offset:0
    v_mfma_f32_16x16x32_bf16 a[204:207], a[140:143], a[112:115], a[204:207]
    s_mov_b64 exec, 63
    buffer_store_dword v20, v21, s[4:7], 0 offen sc1
    s_mov_b64 exec, -1
    v_mfma_f32_16x16x32_bf16 a[220:223], a[136:139], a[84:87], a[220:223]
    v_mfma_f32_16x16x32_bf16 a[220:223], a[140:143], a[116:119], a[220:223]
    v_mfma_f32_16x16x32_bf16 a[236:239], a[136:139], a[88:91], a[236:239]
    v_mfma_f32_16x16x32_bf16 a[236:239], a[140:143], a[120:123], a[236:239]
    v_mfma_f32_16x16x32_bf16 a[252:255], a[136:139], a[92:95], a[252:255]
    v_mfma_f32_16x16x32_bf16 a[252:255], a[140:143], a[124:127], a[252:255]
    s_mov_b32 s55, 0
Lk1_loop:
    s_waitcnt lgkmcnt(2)
    v_mfma_f32_16x16x32_bf16 v[48:51], a[128:131], a[64:67], v[48:51]
    ds_read_b64_tr_b16 a[136:137], v13 offset:40960
    ds_read_b64_tr_b16 a[138:139], v13 offset:41472
    v_mfma_f32_16x16x32_bf16 v[48:51], a[132:135], a[96:99], v[48:51]
    ds_read_b64_tr_b16 a[140:141], v15 offset:0
    ds_read_b64_tr_b16 a[142:143], v15 offset:512
    v_mfma_f32_16x16x32_bf16 v[76:79], a[128:131], a[68:71], v[76:79]
    s_add_u32 m0, s54, 20480
    ds_read_b128 a[4:7], v11 offset:2048
    v_mfma_f32_16x16x32_bf16 v[76:79], a[132:135], a[100:103], v[76:79]
    buffer_load_dwordx4 v8, s[24:27], s47 offen offset:1024 nt lds
    v_mfma_f32_16x16x32_bf16 v[104:107], a[128:131], a[72:75], v[104:107]
    s_add_u32 s49, s47, 229376
    s_add_u32 m0, s53, 32768
    v_mfma_f32_16x16x32_bf16 v[104:107], a[132:135], a[104:107], v[104:107]
    buffer_load_dwordx4 v6, s[16:19], s46 offen offset:2048 lds
    v_mfma_f32_16x16x32_bf16 v[132:135], a[128:131], a[76:79], v[132:135]
    s_sub_u32 s69, s69, 1
    s_cbranch_scc1 Lf_zb1
Lf_nb1:
    ds_read_b128 a[36:39], v17 offset:2048
    v_mfma_f32_16x16x32_bf16 v[132:135], a[132:135], a[108:111], v[132:135]
    v_mfma_f32_16x16x32_bf16 v[160:163], a[128:131], a[80:83], v[160:163]
    v_mfma_f32_16x16x32_bf16 v[160:163], a[132:135], a[112:115], v[160:163]
    v_mfma_f32_16x16x32_bf16 v[184:187], a[128:131], a[84:87], v[184:187]
    v_mfma_f32_16x16x32_bf16 v[184:187], a[132:135], a[116:119], v[184:187]
    v_mfma_f32_16x16x32_bf16 v[208:211], a[128:131], a[88:91], v[208:211]
    v_mfma_f32_16x16x32_bf16 v[208:211], a[132:135], a[120:123], v[208:211]
    v_mfma_f32_16x16x32_bf16 v[232:235], a[128:131], a[92:95], v[232:235]
    v_mfma_f32_16x16x32_bf16 v[232:235], a[132:135], a[124:127], v[232:235]
    s_waitcnt lgkmcnt(2)
    v_mfma_f32_16x16x32_bf16 v[52:55], a[136:139], a[64:67], v[52:55]
    ds_read_b64_tr_b16 a[128:129], v12 offset:41984
    ds_read_b64_tr_b16 a[130:131], v12 offset:42496
    v_mfma_f32_16x16x32_bf16 v[52:55], a[140:143], a[96:99], v[52:55]
    ds_read_b64_tr_b16 a[132:133], v14 offset:1024
    ds_read_b64_tr_b16 a[134:135], v14 offset:1536
    v_mfma_f32_16x16x32_bf16 v[80:83], a[136:139], a[68:71], v[80:83]
    s_add_u32 m0, s54, 0
    s_add_u32 s47, s50, s52
    v_mfma_f32_16x16x32_bf16 v[80:83], a[140:143], a[100:103], v[80:83]
    buffer_load_dwordx4 v9, s[28:31], s50 offen offset:2048 nt lds
    v_mfma_f32_16x16x32_bf16 v[108:111], a[136:139], a[72:75], v[108:111]
    s_add_u32 m0, s53, 32768
    ds_read_b128 a[8:11], v11 offset:4096
    v_mfma_f32_16x16x32_bf16 v[108:111], a[140:143], a[104:107], v[108:111]
    buffer_load_dwordx4 v7, s[16:19], s46 offen offset:3072 lds
    v_mfma_f32_16x16x32_bf16 v[136:139], a[136:139], a[76:79], v[136:139]
    ds_read_b128 a[40:43], v17 offset:4096
    v_mfma_f32_16x16x32_bf16 v[136:139], a[140:143], a[108:111], v[136:139]
    v_mfma_f32_16x16x32_bf16 v[164:167], a[136:139], a[80:83], v[164:167]
    v_mfma_f32_16x16x32_bf16 v[164:167], a[140:143], a[112:115], v[164:167]
    v_mfma_f32_16x16x32_bf16 v[188:191], a[136:139], a[84:87], v[188:191]
    v_mfma_f32_16x16x32_bf16 v[188:191], a[140:143], a[116:119], v[188:191]
    v_mfma_f32_16x16x32_bf16 v[212:215], a[136:139], a[88:91], v[212:215]
    v_mfma_f32_16x16x32_bf16 v[212:215], a[140:143], a[120:123], v[212:215]
    v_mfma_f32_16x16x32_bf16 v[236:239], a[136:139], a[92:95], v[236:239]
    v_mfma_f32_16x16x32_bf16 v[236:239], a[140:143], a[124:127], v[236:239]
    s_waitcnt lgkmcnt(2)
    v_mfma_f32_16x16x32_bf16 v[56:59], a[128:131], a[64:67], v[56:59]
    ds_read_b64_tr_b16 a[136:137], v13 offset:41984
    ds_read_b64_tr_b16 a[138:139], v13 offset:42496
    v_mfma_f32_16x16x32_bf16 v[56:59], a[132:135], a[96:99], v[56:59]
    ds_read_b64_tr_b16 a[140:141], v15 offset:1024
    ds_read_b64_tr_b16 a[142:143], v15 offset:1536
    v_mfma_f32_16x16x32_bf16 v[84:87], a[128:131], a[68:71], v[84:87]
    s_add_u32 m0, s54, 20480
    ds_read_b128 a[12:15], v11 offset:6144
    v_mfma_f32_16x16x32_bf16 v[84:87], a[132:135], a[100:103], v[84:87]
    buffer_load_dwordx4 v9, s[28:31], s47 offen offset:2048 nt lds
    v_mfma_f32_16x16x32_bf16 v[112:115], a[128:131], a[72:75], v[112:115]
    s_cmp_lt_u32 s14, 512
    s_cselect_b32 s40, s8, s10
    v_mfma_f32_16x16x32_bf16 v[112:115], a[132:135], a[104:107], v[112:115]
    s_cselect_b32 s41, s9, s11
    s_cselect_b32 s42, 2097152, s3
    v_mfma_f32_16x16x32_bf16 v[140:143], a[128:131], a[76:79], v[140:143]
    s_cselect_b32 s72, 0, 512
    s_sub_u32 s72, s14, s72
    v_mfma_f32_16x16x32_bf16 v[140:143], a[132:135], a[108:111], v[140:143]
    s_and_b32 s73, s72, 15
    s_lshl_b32 s73, s73, 7
    v_mfma_f32_16x16x32_bf16 v[168:171], a[128:131], a[80:83], v[168:171]
    s_lshr_b32 s72, s72, 4
    s_lshl_b32 s72, s72, 16
    v_mfma_f32_16x16x32_bf16 v[168:171], a[132:135], a[112:115], v[168:171]
    s_add_u32 s72, s72, s73
    s_lshl_b32 s76, s14, 12
    v_mfma_f32_16x16x32_bf16 v[192:195], a[128:131], a[84:87], v[192:195]
    s_add_u32 s76, s76, s65
    s_add_u32 m0, s44, 0
    v_mfma_f32_16x16x32_bf16 v[192:195], a[132:135], a[116:119], v[192:195]
    s_add_u32 s14, s14, 1
    ds_read_b128 a[44:47], v17 offset:6144
    v_mfma_f32_16x16x32_bf16 v[216:219], a[128:131], a[88:91], v[216:219]
    buffer_load_dwordx4 v16, s[40:43], s72 offen nt lds
    v_mfma_f32_16x16x32_bf16 v[216:219], a[132:135], a[120:123], v[216:219]
    v_mfma_f32_16x16x32_bf16 v[240:243], a[128:131], a[92:95], v[240:243]
    v_mfma_f32_16x16x32_bf16 v[240:243], a[132:135], a[124:127], v[240:243]
    s_waitcnt vmcnt(11) lgkmcnt(0)
    s_barrier
    v_mfma_f32_16x16x32_bf16 v[60:63], a[136:139], a[64:67], v[60:63]
    v_mfma_f32_16x16x32_bf16 v[60:63], a[140:143], a[96:99], v[60:63]
    ds_read_b64_tr_b16 a[128:129], v12 offset:43008
    ds_read_b64_tr_b16 a[130:131], v12 offset:43520
    v_mfma_f32_16x16x32_bf16 v[88:91], a[136:139], a[68:71], v[88:91]
    ds_read_b64_tr_b16 a[132:133], v14 offset:2048
    ds_read_b64_tr_b16 a[134:135], v14 offset:2560
    v_mfma_f32_16x16x32_bf16 v[88:91], a[140:143], a[100:103], v[88:91]
    s_add_u32 m0, s54, 0
    s_add_u32 s47, s50, s52
    v_mfma_f32_16x16x32_bf16 v[116:119], a[136:139], a[72:75], v[116:119]
    buffer_load_dwordx4 v9, s[32:35], s50 offen offset:3072 nt lds
    v_mfma_f32_16x16x32_bf16 v[116:119], a[140:143], a[104:107], v[116:119]
    s_add_u32 m0, s53, 40960
    s_add_u32 s46, s48, 131072
    v_mfma_f32_16x16x32_bf16 v[144:147], a[136:139], a[76:79], v[144:147]
    buffer_load_dwordx4 v4, s[16:19], s46 offen offset:0 lds
    v_mfma_f32_16x16x32_bf16 v[144:147], a[140:143], a[108:111], v[144:147]
    ds_read_b128 a[16:19], v11 offset:8192
    ds_read_b128 a[48:51], v17 offset:8192
    v_mfma_f32_16x16x32_bf16 v[172:175], a[136:139], a[80:83], v[172:175]
    v_mfma_f32_16x16x32_bf16 v[172:175], a[140:143], a[112:115], v[172:175]
    v_mfma_f32_16x16x32_bf16 v[196:199], a[136:139], a[84:87], v[196:199]
    v_mfma_f32_16x16x32_bf16 v[196:199], a[140:143], a[116:119], v[196:199]
    v_mfma_f32_16x16x32_bf16 v[220:223], a[136:139], a[88:91], v[220:223]
    v_mfma_f32_16x16x32_bf16 v[220:223], a[140:143], a[120:123], v[220:223]
    v_mfma_f32_16x16x32_bf16 v[244:247], a[136:139], a[92:95], v[244:247]
    v_mfma_f32_16x16x32_bf16 v[244:247], a[140:143], a[124:127], v[244:247]
    s_waitcnt lgkmcnt(2)
    v_mfma_f32_16x16x32_bf16 v[64:67], a[128:131], a[64:67], v[64:67]
    ds_read_b64_tr_b16 a[136:137], v13 offset:43008
    ds_read_b64_tr_b16 a[138:139], v13 offset:43520
    v_mfma_f32_16x16x32_bf16 v[64:67], a[132:135], a[96:99], v[64:67]
    ds_read_b64_tr_b16 a[140:141], v15 offset:2048
    ds_read_b64_tr_b16 a[142:143], v15 offset:2560
    v_mfma_f32_16x16x32_bf16 v[92:95], a[128:131], a[68:71], v[92:95]
    s_add_u32 m0, s54, 20480
    ds_read_b128 a[20:23], v11 offset:10240
    v_mfma_f32_16x16x32_bf16 v[92:95], a[132:135], a[100:103], v[92:95]
    buffer_load_dwordx4 v9, s[32:35], s47 offen offset:3072 nt lds
    v_mfma_f32_16x16x32_bf16 v[120:123], a[128:131], a[72:75], v[120:123]
    s_add_u32 s50, s47, s52
    s_add_u32 m0, s53, 40960
    v_mfma_f32_16x16x32_bf16 v[120:123], a[132:135], a[104:107], v[120:123]
    buffer_load_dwordx4 v5, s[16:19], s46 offen offset:1024 lds
    v_mfma_f32_16x16x32_bf16 v[148:151], a[128:131], a[76:79], v[148:151]
    ds_read_b128 a[52:55], v17 offset:10240
    v_mfma_f32_16x16x32_bf16 v[148:151], a[132:135], a[108:111], v[148:151]
    v_mfma_f32_16x16x32_bf16 v[176:179], a[128:131], a[80:83], v[176:179]
    v_mfma_f32_16x16x32_bf16 v[176:179], a[132:135], a[112:115], v[176:179]
    v_mfma_f32_16x16x32_bf16 v[200:203], a[128:131], a[84:87], v[200:203]
    v_mfma_f32_16x16x32_bf16 v[200:203], a[132:135], a[116:119], v[200:203]
    v_mfma_f32_16x16x32_bf16 v[224:227], a[128:131], a[88:91], v[224:227]
    v_mfma_f32_16x16x32_bf16 v[224:227], a[132:135], a[120:123], v[224:227]
    v_mfma_f32_16x16x32_bf16 v[248:251], a[128:131], a[92:95], v[248:251]
    v_mfma_f32_16x16x32_bf16 v[248:251], a[132:135], a[124:127], v[248:251]
    s_waitcnt lgkmcnt(2)
    v_mfma_f32_16x16x32_bf16 v[68:71], a[136:139], a[64:67], v[68:71]
    ds_read_b64_tr_b16 a[128:129], v12 offset:44032
    ds_read_b64_tr_b16 a[130:131], v12 offset:44544
    v_mfma_f32_16x16x32_bf16 v[68:71], a[140:143], a[96:99], v[68:71]
    ds_read_b64_tr_b16 a[132:133], v14 offset:3072
    ds_read_b64_tr_b16 a[134:135], v14 offset:3584
    v_mfma_f32_16x16x32_bf16 v[96:99], a[136:139], a[68:71], v[96:99]
    s_add_u32 m0, s54, 45056
    s_add_u32 s47, s51, 196608
    v_mfma_f32_16x16x32_bf16 v[96:99], a[140:143], a[100:103], v[96:99]
    buffer_load_dwordx4 v10, s[36:39], s51 offen  nt lds
    v_mfma_f32_16x16x32_bf16 v[124:127], a[136:139], a[72:75], v[124:127]
    s_add_u32 m0, s53, 40960
    ds_read_b128 a[24:27], v11 offset:12288
    v_mfma_f32_16x16x32_bf16 v[124:127], a[140:143], a[104:107], v[124:127]
    buffer_load_dwordx4 v6, s[16:19], s46 offen offset:2048 lds
    v_mfma_f32_16x16x32_bf16 v[152:155], a[136:139], a[76:79], v[152:155]
    s_sub_u32 s69, s69, 1
    s_cbranch_scc1 Lf_zb2
Lf_nb2:
    ds_read_b128 a[56:59], v17 offset:12288
    v_mfma_f32_16x16x32_bf16 v[152:155], a[140:143], a[108:111], v[152:155]
    v_mfma_f32_16x16x32_bf16 v[180:183], a[136:139], a[80:83], v[180:183]
    v_mfma_f32_16x16x32_bf16 v[180:183], a[140:143], a[112:115], v[180:183]
    v_mfma_f32_16x16x32_bf16 v[204:207], a[136:139], a[84:87], v[204:207]
    v_mfma_f32_16x16x32_bf16 v[204:207], a[140:143], a[116:119], v[204:207]
    v_mfma_f32_16x16x32_bf16 v[228:231], a[136:139], a[88:91], v[228:231]
    v_mfma_f32_16x16x32_bf16 v[228:231], a[140:143], a[120:123], v[228:231]
    v_mfma_f32_16x16x32_bf16 v[252:255], a[136:139], a[92:95], v[252:255]
    v_mfma_f32_16x16x32_bf16 v[252:255], a[140:143], a[124:127], v[252:255]
    s_waitcnt lgkmcnt(2)
    v_mfma_f32_16x16x32_bf16 v[72:75], a[128:131], a[64:67], v[72:75]
    ds_read_b64_tr_b16 a[136:137], v13 offset:44032
    ds_read_b64_tr_b16 a[138:139], v13 offset:44544
    v_mfma_f32_16x16x32_bf16 v[72:75], a[132:135], a[96:99], v[72:75]
    ds_read_b64_tr_b16 a[140:141], v15 offset:3072
    ds_read_b64_tr_b16 a[142:143], v15 offset:3584
    v_mfma_f32_16x16x32_bf16 v[100:103], a[128:131], a[68:71], v[100:103]
    s_add_u32 m0, s54, 65536
    ds_read_b128 a[28:31], v11 offset:14336
    v_mfma_f32_16x16x32_bf16 v[100:103], a[132:135], a[100:103], v[100:103]
    buffer_load_dwordx4 v10, s[36:39], s47 offen  nt lds
    v_mfma_f32_16x16x32_bf16 v[128:131], a[128:131], a[72:75], v[128:131]
    s_add_u32 s51, s47, 196608
    s_add_u32 m0, s53, 40960
    v_mfma_f32_16x16x32_bf16 v[128:131], a[132:135], a[104:107], v[128:131]
    buffer_load_dwordx4 v7, s[16:19], s46 offen offset:3072 lds
    v_mfma_f32_16x16x32_bf16 v[156:159], a[128:131], a[76:79], v[156:159]
    s_add_u32 s48, s48, 128
    ds_read_b128 a[60:63], v17 offset:14336
    v_mfma_f32_16x16x32_bf16 v[156:159], a[132:135], a[108:111], v[156:159]
    v_mfma_f32_16x16x32_bf16 a[192:195], a[128:131], a[80:83], a[192:195]
    v_mfma_f32_16x16x32_bf16 a[192:195], a[132:135], a[112:115], a[192:195]
    v_mfma_f32_16x16x32_bf16 a[208:211], a[128:131], a[84:87], a[208:211]
    v_mfma_f32_16x16x32_bf16 a[208:211], a[132:135], a[116:119], a[208:211]
    v_mfma_f32_16x16x32_bf16 a[224:227], a[128:131], a[88:91], a[224:227]
    v_mfma_f32_16x16x32_bf16 a[224:227], a[132:135], a[120:123], a[224:227]
    v_mfma_f32_16x16x32_bf16 a[240:243], a[128:131], a[92:95], a[240:243]
    v_mfma_f32_16x16x32_bf16 a[240:243], a[132:135], a[124:127], a[240:243]
    s_waitcnt vmcnt(10) lgkmcnt(0)
    s_barrier
    v_mfma_f32_16x16x32_bf16 a[144:147], a[136:139], a[64:67], a[144:147]
    v_mfma_f32_16x16x32_bf16 a[144:147], a[140:143], a[96:99], a[144:147]
    ds_read_b64_tr_b16 a[128:129], v12 offset:4096
    ds_read_b64_tr_b16 a[130:131], v12 offset:4608
    v_mfma_f32_16x16x32_bf16 a[156:159], a[136:139], a[68:71], a[156:159]
    ds_read_b64_tr_b16 a[132:133], v12 offset:24576
    ds_read_b64_tr_b16 a[134:135], v12 offset:25088
    v_mfma_f32_16x16x32_bf16 a[156:159], a[140:143], a[100:103], a[156:159]
    s_add_u32 m0, s54, 40960
    s_add_u32 s47, s49, 229376
    v_mfma_f32_16x16x32_bf16 a[168:171], a[136:139], a[72:75], a[168:171]
    buffer_load_dwordx4 v8, s[20:23], s49 offen offset:0 nt lds
    v_mfma_f32_16x16x32_bf16 a[168:171], a[140:143], a[104:107], a[168:171]
    s_and_b32 s96, s96, 7
    v_mul_lo_u32 v39, v38, s96
    v_mfma_f32_16x16x32_bf16 a[180:183], a[136:139], a[76:79], a[180:183]
    v_add_co_u32 v40, vcc, v36, v39
    s_add_u32 s96, s96, 1
    v_mfma_f32_16x16x32_bf16 a[180:183], a[140:143], a[108:111], a[180:183]
    s_nop 1
    v_addc_co_u32 v41, vcc, 0, v37, vcc
    v_mfma_f32_16x16x32_bf16 a[196:199], a[136:139], a[80:83], a[196:199]
    s_mov_b64 exec, 0x3ff
    global_load_dword v1, v[40:41], off
    s_mov_b64 exec, -1
    v_mfma_f32_16x16x32_bf16 a[196:199], a[140:143], a[112:115], a[196:199]
    v_mfma_f32_16x16x32_bf16 a[212:215], a[136:139], a[84:87], a[212:215]
    v_mfma_f32_16x16x32_bf16 a[212:215], a[140:143], a[116:119], a[212:215]
    v_mfma_f32_16x16x32_bf16 a[228:231], a[136:139], a[88:91], a[228:231]
    v_mfma_f32_16x16x32_bf16 a[228:231], a[140:143], a[120:123], a[228:231]
    v_mfma_f32_16x16x32_bf16 a[244:247], a[136:139], a[92:95], a[244:247]
    v_mfma_f32_16x16x32_bf16 a[244:247], a[140:143], a[124:127], a[244:247]
    s_waitcnt lgkmcnt(0)
    v_mfma_f32_16x16x32_bf16 a[148:151], a[128:131], a[0:3], a[148:151]
    ds_read_b64_tr_b16 a[136:137], v13 offset:4096
    ds_read_b64_tr_b16 a[138:139], v13 offset:4608
    v_mfma_f32_16x16x32_bf16 a[148:151], a[132:135], a[32:35], a[148:151]
    ds_read_b64_tr_b16 a[140:141], v13 offset:24576
    ds_read_b64_tr_b16 a[142:143], v13 offset:25088
    v_mfma_f32_16x16x32_bf16 a[160:163], a[128:131], a[4:7], a[160:163]
    s_add_u32 m0, s54, 61440
    v_mfma_f32_16x16x32_bf16 a[160:163], a[132:135], a[36:39], a[160:163]
    buffer_load_dwordx4 v8, s[20:23], s47 offen offset:0 nt lds
    v_mfma_f32_16x16x32_bf16 a[172:175], a[128:131], a[8:11], a[172:175]
    s_add_u32 m0, s53, 0
    s_add_u32 s46, s48, 0
    v_mfma_f32_16x16x32_bf16 a[172:175], a[132:135], a[40:43], a[172:175]
    buffer_load_dwordx4 v4, s[16:19], s46 offen offset:0 lds
    v_mfma_f32_16x16x32_bf16 a[184:187], a[128:131], a[12:15], a[184:187]
    v_mfma_f32_16x16x32_bf16 a[184:187], a[132:135], a[44:47], a[184:187]
    v_mfma_f32_16x16x32_bf16 a[200:203], a[128:131], a[16:19], a[200:203]
    v_mfma_f32_16x16x32_bf16 a[200:203], a[132:135], a[48:51], a[200:203]
    v_mfma_f32_16x16x32_bf16 a[216:219], a[128:131], a[20:23], a[216:219]
    v_mfma_f32_16x16x32_bf16 a[216:219], a[132:135], a[52:55], a[216:219]
    v_mfma_f32_16x16x32_bf16 a[232:235], a[128:131], a[24:27], a[232:235]
    v_mfma_f32_16x16x32_bf16 a[232:235], a[132:135], a[56:59], a[232:235]
    v_mfma_f32_16x16x32_bf16 a[248:251], a[128:131], a[28:31], a[248:251]
    v_mfma_f32_16x16x32_bf16 a[248:251], a[132:135], a[60:63], a[248:251]
    s_waitcnt lgkmcnt(0)
    v_mfma_f32_16x16x32_bf16 a[152:155], a[136:139], a[0:3], a[152:155]
    ds_read_b64_tr_b16 a[128:129], v12 offset:0
    ds_read_b64_tr_b16 a[130:131], v12 offset:512
    v_mfma_f32_16x16x32_bf16 a[152:155], a[140:143], a[32:35], a[152:155]
    ds_read_b64_tr_b16 a[132:133], v12 offset:20480
    ds_read_b64_tr_b16 a[134:135], v12 offset:20992
    v_mfma_f32_16x16x32_bf16 a[164:167], a[136:139], a[4:7], a[164:167]
    s_add_u32 m0, s54, 40960
    s_add_u32 s47, s49, 229376
    v_mfma_f32_16x16x32_bf16 a[164:167], a[140:143], a[36:39], a[164:167]
    buffer_load_dwordx4 v8, s[24:27], s49 offen offset:1024 nt lds
    v_mfma_f32_16x16x32_bf16 a[176:179], a[136:139], a[8:11], a[176:179]
    s_add_u32 m0, s53, 0
    ds_read_b128 a[64:67], v11 offset:32768
    v_mfma_f32_16x16x32_bf16 a[176:179], a[140:143], a[40:43], a[176:179]
    buffer_load_dwordx4 v5, s[16:19], s46 offen offset:1024 lds
    v_mfma_f32_16x16x32_bf16 a[188:191], a[136:139], a[12:15], a[188:191]
    ds_read_b128 a[96:99], v17 offset:32768
    v_mfma_f32_16x16x32_bf16 a[188:191], a[140:143], a[44:47], a[188:191]
    v_mfma_f32_16x16x32_bf16 a[204:207], a[136:139], a[16:19], a[204:207]
    v_mfma_f32_16x16x32_bf16 a[204:207], a[140:143], a[48:51], a[204:207]
    v_mfma_f32_16x16x32_bf16 a[220:223], a[136:139], a[20:23], a[220:223]
    v_mfma_f32_16x16x32_bf16 a[220:223], a[140:143], a[52:55], a[220:223]
    v_mfma_f32_16x16x32_bf16 a[236:239], a[136:139], a[24:27], a[236:239]
    v_mfma_f32_16x16x32_bf16 a[236:239], a[140:143], a[56:59], a[236:239]
    v_mfma_f32_16x16x32_bf16 a[252:255], a[136:139], a[28:31], a[252:255]
    v_mfma_f32_16x16x32_bf16 a[252:255], a[140:143], a[60:63], a[252:255]
    s_waitcnt lgkmcnt(2)
    v_mfma_f32_16x16x32_bf16 v[48:51], a[128:131], a[0:3], v[48:51]
    ds_read_b64_tr_b16 a[136:137], v13 offset:0
    ds_read_b64_tr_b16 a[138:139], v13 offset:512
    v_mfma_f32_16x16x32_bf16 v[48:51], a[132:135], a[32:35], v[48:51]
    ds_read_b64_tr_b16 a[140:141], v13 offset:20480
    ds_read_b64_tr_b16 a[142:143], v13 offset:20992
    v_mfma_f32_16x16x32_bf16 v[76:79], a[128:131], a[4:7], v[76:79]
    s_add_u32 m0, s54, 61440
    ds_read_b128 a[68:71], v11 offset:34816
    v_mfma_f32_16x16x32_bf16 v[76:79], a[132:135], a[36:39], v[76:79]
    buffer_load_dwordx4 v8, s[24:27], s47 offen offset:1024 nt lds
    v_mfma_f32_16x16x32_bf16 v[104:107], a[128:131], a[8:11], v[104:107]
    s_add_u32 s49, s47, 229376
    s_add_u32 m0, s53, 0
    v_mfma_f32_16x16x32_bf16 v[104:107], a[132:135], a[40:43], v[104:107]
    buffer_load_dwordx4 v6, s[16:19], s46 offen offset:2048 lds
    v_mfma_f32_16x16x32_bf16 v[132:135], a[128:131], a[12:15], v[132:135]
    s_sub_u32 s69, s69, 1
    s_cbranch_scc1 Lf_zb3
Lf_nb3:
    ds_read_b128 a[100:103], v17 offset:34816
    v_mfma_f32_16x16x32_bf16 v[132:135], a[132:135], a[44:47], v[132:135]
    v_mfma_f32_16x16x32_bf16 v[160:163], a[128:131], a[16:19], v[160:163]
    v_mfma_f32_16x16x32_bf16 v[160:163], a[132:135], a[48:51], v[160:163]
    v_mfma_f32_16x16x32_bf16 v[184:187], a[128:131], a[20:23], v[184:187]
    v_mfma_f32_16x16x32_bf16 v[184:187], a[132:135], a[52:55], v[184:187]
    v_mfma_f32_16x16x32_bf16 v[208:211], a[128:131], a[24:27], v[208:211]
    v_mfma_f32_16x16x32_bf16 v[208:211], a[132:135], a[56:59], v[208:211]
    v_mfma_f32_16x16x32_bf16 v[232:235], a[128:131], a[28:31], v[232:235]
    v_mfma_f32_16x16x32_bf16 v[232:235], a[132:135], a[60:63], v[232:235]
    s_waitcnt lgkmcnt(2)
    v_mfma_f32_16x16x32_bf16 v[52:55], a[136:139], a[0:3], v[52:55]
    ds_read_b64_tr_b16 a[128:129], v12 offset:1024
    ds_read_b64_tr_b16 a[130:131], v12 offset:1536
    v_mfma_f32_16x16x32_bf16 v[52:55], a[140:143], a[32:35], v[52:55]
    ds_read_b64_tr_b16 a[132:133], v12 offset:21504
    ds_read_b64_tr_b16 a[134:135], v12 offset:22016
    v_mfma_f32_16x16x32_bf16 v[80:83], a[136:139], a[4:7], v[80:83]
    s_add_u32 m0, s54, 40960
    s_add_u32 s47, s50, s52
    v_mfma_f32_16x16x32_bf16 v[80:83], a[140:143], a[36:39], v[80:83]
    buffer_load_dwordx4 v9, s[28:31], s50 offen offset:2048 nt lds
    v_mfma_f32_16x16x32_bf16 v[108:111], a[136:139], a[8:11], v[108:111]
    s_add_u32 m0, s53, 0
    ds_read_b128 a[72:75], v11 offset:36864
    v_mfma_f32_16x16x32_bf16 v[108:111], a[140:143], a[40:43], v[108:111]
    buffer_load_dwordx4 v7, s[16:19], s46 offen offset:3072 lds
    v_mfma_f32_16x16x32_bf16 v[136:139], a[136:139], a[12:15], v[136:139]
    ds_read_b128 a[104:107], v17 offset:36864
    v_mfma_f32_16x16x32_bf16 v[136:139], a[140:143], a[44:47], v[136:139]
    v_mfma_f32_16x16x32_bf16 v[164:167], a[136:139], a[16:19], v[164:167]
    v_mfma_f32_16x16x32_bf16 v[164:167], a[140:143], a[48:51], v[164:167]
    v_mfma_f32_16x16x32_bf16 v[188:191], a[136:139], a[20:23], v[188:191]
    v_mfma_f32_16x16x32_bf16 v[188:191], a[140:143], a[52:55], v[188:191]
    v_mfma_f32_16x16x32_bf16 v[212:215], a[136:139], a[24:27], v[212:215]
    v_mfma_f32_16x16x32_bf16 v[212:215], a[140:143], a[56:59], v[212:215]
    v_mfma_f32_16x16x32_bf16 v[236:239], a[136:139], a[28:31], v[236:239]
    v_mfma_f32_16x16x32_bf16 v[236:239], a[140:143], a[60:63], v[236:239]
    s_waitcnt lgkmcnt(2)
    v_mfma_f32_16x16x32_bf16 v[56:59], a[128:131], a[0:3], v[56:59]
    ds_read_b64_tr_b16 a[136:137], v13 offset:1024
    ds_read_b64_tr_b16 a[138:139], v13 offset:1536
    v_mfma_f32_16x16x32_bf16 v[56:59], a[132:135], a[32:35], v[56:59]
    ds_read_b64_tr_b16 a[140:141], v13 offset:21504
    ds_read_b64_tr_b16 a[142:143], v13 offset:22016
    v_mfma_f32_16x16x32_bf16 v[84:87], a[128:131], a[4:7], v[84:87]
    s_add_u32 m0, s54, 61440
    ds_read_b128 a[76:79], v11 offset:38912
    v_mfma_f32_16x16x32_bf16 v[84:87], a[132:135], a[36:39], v[84:87]
    buffer_load_dwordx4 v9, s[28:31], s47 offen offset:2048 nt lds
    v_mfma_f32_16x16x32_bf16 v[112:115], a[128:131], a[8:11], v[112:115]
    s_cmp_lt_u32 s14, 512
    s_cselect_b32 s40, s8, s10
    v_mfma_f32_16x16x32_bf16 v[112:115], a[132:135], a[40:43], v[112:115]
    s_cselect_b32 s41, s9, s11
    s_cselect_b32 s42, 2097152, s3
    v_mfma_f32_16x16x32_bf16 v[140:143], a[128:131], a[12:15], v[140:143]
    s_cselect_b32 s72, 0, 512
    s_sub_u32 s72, s14, s72
    v_mfma_f32_16x16x32_bf16 v[140:143], a[132:135], a[44:47], v[140:143]
    s_and_b32 s73, s72, 15
    s_lshl_b32 s73, s73, 7
    v_mfma_f32_16x16x32_bf16 v[168:171], a[128:131], a[16:19], v[168:171]
    s_lshr_b32 s72, s72, 4
    s_lshl_b32 s72, s72, 16
    v_mfma_f32_16x16x32_bf16 v[168:171], a[132:135], a[48:51], v[168:171]
    s_add_u32 s72, s72, s73
    s_lshl_b32 s77, s14, 12
    v_mfma_f32_16x16x32_bf16 v[192:195], a[128:131], a[20:23], v[192:195]
    s_add_u32 s77, s77, s65
    s_add_u32 m0, s44, 4096
    v_mfma_f32_16x16x32_bf16 v[192:195], a[132:135], a[52:55], v[192:195]
    s_add_u32 s14, s14, 1
    ds_read_b128 a[108:111], v17 offset:38912
    v_mfma_f32_16x16x32_bf16 v[216:219], a[128:131], a[24:27], v[216:219]
    buffer_load_dwordx4 v16, s[40:43], s72 offen nt lds
    v_mfma_f32_16x16x32_bf16 v[216:219], a[132:135], a[56:59], v[216:219]
    v_mfma_f32_16x16x32_bf16 v[240:243], a[128:131], a[28:31], v[240:243]
    v_mfma_f32_16x16x32_bf16 v[240:243], a[132:135], a[60:63], v[240:243]
    s_waitcnt vmcnt(12) lgkmcnt(0)
    s_barrier
    v_mfma_f32_16x16x32_bf16 v[60:63], a[136:139], a[0:3], v[60:63]
    v_mfma_f32_16x16x32_bf16 v[60:63], a[140:143], a[32:35], v[60:63]
    ds_read_b64_tr_b16 a[128:129], v12 offset:2048
    ds_read_b64_tr_b16 a[130:131], v12 offset:2560
    v_mfma_f32_16x16x32_bf16 v[88:91], a[136:139], a[4:7], v[88:91]
    ds_read_b64_tr_b16 a[132:133], v12 offset:22528
    ds_read_b64_tr_b16 a[134:135], v12 offset:23040
    v_mfma_f32_16x16x32_bf16 v[88:91], a[140:143], a[36:39], v[88:91]
    s_add_u32 m0, s54, 40960
    s_add_u32 s47, s50, s52
    v_mfma_f32_16x16x32_bf16 v[116:119], a[136:139], a[8:11], v[116:119]
    buffer_load_dwordx4 v9, s[32:35], s50 offen offset:3072 nt lds
    v_mfma_f32_16x16x32_bf16 v[116:119], a[140:143], a[40:43], v[116:119]
    s_add_u32 m0, s53, 8192
    s_add_u32 s46, s48, 131072
    v_mfma_f32_16x16x32_bf16 v[144:147], a[136:139], a[12:15], v[144:147]
    buffer_load_dwordx4 v4, s[16:19], s46 offen offset:0 lds
    v_mfma_f32_16x16x32_bf16 v[144:147], a[140:143], a[44:47], v[144:147]
    ds_read_b128 a[80:83], v11 offset:40960
    ds_read_b128 a[112:115], v17 offset:40960
    v_mfma_f32_16x16x32_bf16 v[172:175], a[136:139], a[16:19], v[172:175]
    ds_read_b64_tr_b16 v[24:25], v18 offset:0
    ds_read_b64_tr_b16 v[26:27], v18 offset:512
    v_mfma_f32_16x16x32_bf16 v[172:175], a[140:143], a[48:51], v[172:175]
    v_mfma_f32_16x16x32_bf16 v[196:199], a[136:139], a[20:23], v[196:199]
    v_mfma_f32_16x16x32_bf16 v[196:199], a[140:143], a[52:55], v[196:199]
    v_mfma_f32_16x16x32_bf16 v[220:223], a[136:139], a[24:27], v[220:223]
    v_mfma_f32_16x16x32_bf16 v[220:223], a[140:143], a[56:59], v[220:223]
    v_mfma_f32_16x16x32_bf16 v[244:247], a[136:139], a[28:31], v[244:247]
    v_mfma_f32_16x16x32_bf16 v[244:247], a[140:143], a[60:63], v[244:247]
    s_waitcnt lgkmcnt(0)
    v_mfma_f32_16x16x32_bf16 v[64:67], a[128:131], a[0:3], v[64:67]
    ds_read_b64_tr_b16 a[136:137], v13 offset:2048
    ds_read_b64_tr_b16 a[138:139], v13 offset:2560
    v_mfma_f32_16x16x32_bf16 v[64:67], a[132:135], a[32:35], v[64:67]
    ds_read_b64_tr_b16 a[140:141], v13 offset:22528
    ds_read_b64_tr_b16 a[142:143], v13 offset:23040
    v_mfma_f32_16x16x32_bf16 v[92:95], a[128:131], a[4:7], v[92:95]
    s_add_u32 m0, s54, 61440
    ds_read_b128 a[84:87], v11 offset:43008
    v_mfma_f32_16x16x32_bf16 v[92:95], a[132:135], a[36:39], v[92:95]
    buffer_load_dwordx4 v9, s[32:35], s47 offen offset:3072 nt lds
    v_mfma_f32_16x16x32_bf16 v[120:123], a[128:131], a[8:11], v[120:123]
    s_add_u32 s50, s47, s52
    s_add_u32 m0, s53, 8192
    v_mfma_f32_16x16x32_bf16 v[120:123], a[132:135], a[40:43], v[120:123]
    buffer_load_dwordx4 v5, s[16:19], s46 offen offset:1024 lds
    v_mfma_f32_16x16x32_bf16 v[148:151], a[128:131], a[12:15], v[148:151]
    buffer_store_dwordx4 v[24:27], v19, s[4:7], s76 offen sc1
    v_mfma_f32_16x16x32_bf16 v[148:151], a[132:135], a[44:47], v[148:151]
    ds_read_b128 a[116:119], v17 offset:43008
    v_mfma_f32_16x16x32_bf16 v[176:179], a[128:131], a[16:19], v[176:179]
    v_mfma_f32_16x16x32_bf16 v[176:179], a[132:135], a[48:51], v[176:179]
    v_mfma_f32_16x16x32_bf16 v[200:203], a[128:131], a[20:23], v[200:203]
    v_mfma_f32_16x16x32_bf16 v[200:203], a[132:135], a[52:55], v[200:203]
    v_mfma_f32_16x16x32_bf16 v[224:227], a[128:131], a[24:27], v[224:227]
    v_mfma_f32_16x16x32_bf16 v[224:227], a[132:135], a[56:59], v[224:227]
    v_mfma_f32_16x16x32_bf16 v[248:251], a[128:131], a[28:31], v[248:251]
    v_mfma_f32_16x16x32_bf16 v[248:251], a[132:135], a[60:63], v[248:251]
    s_waitcnt lgkmcnt(2)
    v_mfma_f32_16x16x32_bf16 v[68:71], a[136:139], a[0:3], v[68:71]
    ds_read_b64_tr_b16 a[128:129], v12 offset:3072
    ds_read_b64_tr_b16 a[130:131], v12 offset:3584
    v_mfma_f32_16x16x32_bf16 v[68:71], a[140:143], a[32:35], v[68:71]
    ds_read_b64_tr_b16 a[132:133], v12 offset:23552
    ds_read_b64_tr_b16 a[134:135], v12 offset:24064
    v_mfma_f32_16x16x32_bf16 v[96:99], a[136:139], a[4:7], v[96:99]
    s_add_u32 m0, s54, 4096
    s_add_u32 s47, s51, 196608
    v_mfma_f32_16x16x32_bf16 v[96:99], a[140:143], a[36:39], v[96:99]
    buffer_load_dwordx4 v10, s[36:39], s51 offen  nt lds
    v_mfma_f32_16x16x32_bf16 v[124:127], a[136:139], a[8:11], v[124:127]
    s_add_u32 m0, s53, 8192
    ds_read_b128 a[88:91], v11 offset:45056
    v_mfma_f32_16x16x32_bf16 v[124:127], a[140:143], a[40:43], v[124:127]
    buffer_load_dwordx4 v6, s[16:19], s46 offen offset:2048 lds
    v_mfma_f32_16x16x32_bf16 v[152:155], a[136:139], a[12:15], v[152:155]
    s_sub_u32 s69, s69, 1
    s_cbranch_scc1 Lf_zb4
Lf_nb4:
    ds_read_b128 a[120:123], v17 offset:45056
    v_mfma_f32_16x16x32_bf16 v[152:155], a[140:143], a[44:47], v[152:155]
    v_mfma_f32_16x16x32_bf16 v[180:183], a[136:139], a[16:19], v[180:183]
    v_mfma_f32_16x16x32_bf16 v[180:183], a[140:143], a[48:51], v[180:183]
    v_mfma_f32_16x16x32_bf16 v[204:207], a[136:139], a[20:23], v[204:207]
    v_mfma_f32_16x16x32_bf16 v[204:207], a[140:143], a[52:55], v[204:207]
    v_mfma_f32_16x16x32_bf16 v[228:231], a[136:139], a[24:27], v[228:231]
    v_mfma_f32_16x16x32_bf16 v[228:231], a[140:143], a[56:59], v[228:231]
    v_mfma_f32_16x16x32_bf16 v[252:255], a[136:139], a[28:31], v[252:255]
    v_mfma_f32_16x16x32_bf16 v[252:255], a[140:143], a[60:63], v[252:255]
    s_waitcnt lgkmcnt(2)
    v_mfma_f32_16x16x32_bf16 v[72:75], a[128:131], a[0:3], v[72:75]
    ds_read_b64_tr_b16 a[136:137], v13 offset:3072
    ds_read_b64_tr_b16 a[138:139], v13 offset:3584
    v_mfma_f32_16x16x32_bf16 v[72:75], a[132:135], a[32:35], v[72:75]
    ds_read_b64_tr_b16 a[140:141], v13 offset:23552
    ds_read_b64_tr_b16 a[142:143], v13 offset:24064
    v_mfma_f32_16x16x32_bf16 v[100:103], a[128:131], a[4:7], v[100:103]
    s_add_u32 m0, s54, 24576
    ds_read_b128 a[92:95], v11 offset:47104
    v_mfma_f32_16x16x32_bf16 v[100:103], a[132:135], a[36:39], v[100:103]
    buffer_load_dwordx4 v10, s[36:39], s47 offen  nt lds
    v_mfma_f32_16x16x32_bf16 v[128:131], a[128:131], a[8:11], v[128:131]
    s_add_u32 s51, s47, 196608
    s_add_u32 m0, s53, 8192
    v_mfma_f32_16x16x32_bf16 v[128:131], a[132:135], a[40:43], v[128:131]
    buffer_load_dwordx4 v7, s[16:19], s46 offen offset:3072 lds
    v_mfma_f32_16x16x32_bf16 v[156:159], a[128:131], a[12:15], v[156:159]
    s_add_u32 s48, s48, 128
    ds_read_b128 a[124:127], v17 offset:47104
    v_mfma_f32_16x16x32_bf16 v[156:159], a[132:135], a[44:47], v[156:159]
    v_mfma_f32_16x16x32_bf16 a[192:195], a[128:131], a[16:19], a[192:195]
    v_mfma_f32_16x16x32_bf16 a[192:195], a[132:135], a[48:51], a[192:195]
    v_mfma_f32_16x16x32_bf16 a[208:211], a[128:131], a[20:23], a[208:211]
    v_mfma_f32_16x16x32_bf16 a[208:211], a[132:135], a[52:55], a[208:211]
    v_mfma_f32_16x16x32_bf16 a[224:227], a[128:131], a[24:27], a[224:227]
    v_mfma_f32_16x16x32_bf16 a[224:227], a[132:135], a[56:59], a[224:227]
    v_mfma_f32_16x16x32_bf16 a[240:243], a[128:131], a[28:31], a[240:243]
    v_mfma_f32_16x16x32_bf16 a[240:243], a[132:135], a[60:63], a[240:243]
    s_waitcnt vmcnt(11) lgkmcnt(0)
    s_barrier
    v_mfma_f32_16x16x32_bf16 a[144:147], a[136:139], a[0:3], a[144:147]
    v_mfma_f32_16x16x32_bf16 a[144:147], a[140:143], a[32:35], a[144:147]
    ds_read_b64_tr_b16 a[128:129], v12 offset:45056
    ds_read_b64_tr_b16 a[130:131], v12 offset:45568
    v_mfma_f32_16x16x32_bf16 a[156:159], a[136:139], a[4:7], a[156:159]
    ds_read_b64_tr_b16 a[132:133], v14 offset:4096
    ds_read_b64_tr_b16 a[134:135], v14 offset:4608
    v_mfma_f32_16x16x32_bf16 a[156:159], a[140:143], a[36:39], a[156:159]
    s_add_u32 m0, s54, 0
    s_add_u32 s47, s49, 229376
    v_mfma_f32_16x16x32_bf16 a[168:171], a[136:139], a[8:11], a[168:171]
    buffer_load_dwordx4 v8, s[20:23], s49 offen offset:0 nt lds
    v_mfma_f32_16x16x32_bf16 a[168:171], a[140:143], a[40:43], a[168:171]
    v_mfma_f32_16x16x32_bf16 a[180:183], a[136:139], a[12:15], a[180:183]
    v_mfma_f32_16x16x32_bf16 a[180:183], a[140:143], a[44:47], a[180:183]
    v_mfma_f32_16x16x32_bf16 a[196:199], a[136:139], a[16:19], a[196:199]
    v_mfma_f32_16x16x32_bf16 a[196:199], a[140:143], a[48:51], a[196:199]
    v_mfma_f32_16x16x32_bf16 a[212:215], a[136:139], a[20:23], a[212:215]
    v_mfma_f32_16x16x32_bf16 a[212:215], a[140:143], a[52:55], a[212:215]
    v_mfma_f32_16x16x32_bf16 a[228:231], a[136:139], a[24:27], a[228:231]
    v_mfma_f32_16x16x32_bf16 a[228:231], a[140:143], a[56:59], a[228:231]
    v_mfma_f32_16x16x32_bf16 a[244:247], a[136:139], a[28:31], a[244:247]
    v_mfma_f32_16x16x32_bf16 a[244:247], a[140:143], a[60:63], a[244:247]
    s_waitcnt lgkmcnt(0)
    v_mfma_f32_16x16x32_bf16 a[148:151], a[128:131], a[64:67], a[148:151]
    ds_read_b64_tr_b16 a[136:137], v13 offset:45056
    ds_read_b64_tr_b16 a[138:139], v13 offset:45568
    v_mfma_f32_16x16x32_bf16 a[148:151], a[132:135], a[96:99], a[148:151]
    ds_read_b64_tr_b16 a[140:141], v15 offset:4096
    ds_read_b64_tr_b16 a[142:143], v15 offset:4608
    v_mfma_f32_16x16x32_bf16 a[160:163], a[128:131], a[68:71], a[160:163]
    s_add_u32 m0, s54, 20480
    v_mfma_f32_16x16x32_bf16 a[160:163], a[132:135], a[100:103], a[160:163]
    buffer_load_dwordx4 v8, s[20:23], s47 offen offset:0 nt lds
    v_mfma_f32_16x16x32_bf16 a[172:175], a[128:131], a[72:75], a[172:175]
    s_add_u32 m0, s53, 32768
    s_add_u32 s46, s48, 0
    v_mfma_f32_16x16x32_bf16 a[172:175], a[132:135], a[104:107], a[172:175]
    buffer_load_dwordx4 v4, s[16:19], s46 offen offset:0 lds
    v_mfma_f32_16x16x32_bf16 a[184:187], a[128:131], a[76:79], a[184:187]
    v_mfma_f32_16x16x32_bf16 a[184:187], a[132:135], a[108:111], a[184:187]
    v_mfma_f32_16x16x32_bf16 a[200:203], a[128:131], a[80:83], a[200:203]
    v_mfma_f32_16x16x32_bf16 a[200:203], a[132:135], a[112:115], a[200:203]
    v_mfma_f32_16x16x32_bf16 a[216:219], a[128:131], a[84:87], a[216:219]
    v_mfma_f32_16x16x32_bf16 a[216:219], a[132:135], a[116:119], a[216:219]
    v_mfma_f32_16x16x32_bf16 a[232:235], a[128:131], a[88:91], a[232:235]
    v_mfma_f32_16x16x32_bf16 a[232:235], a[132:135], a[120:123], a[232:235]
    v_mfma_f32_16x16x32_bf16 a[248:251], a[128:131], a[92:95], a[248:251]
    v_mfma_f32_16x16x32_bf16 a[248:251], a[132:135], a[124:127], a[248:251]
    s_waitcnt lgkmcnt(0)
    v_mfma_f32_16x16x32_bf16 a[152:155], a[136:139], a[64:67], a[152:155]
    ds_read_b64_tr_b16 a[128:129], v12 offset:40960
    ds_read_b64_tr_b16 a[130:131], v12 offset:41472
    v_mfma_f32_16x16x32_bf16 a[152:155], a[140:143], a[96:99], a[152:155]
    ds_read_b64_tr_b16 a[132:133], v14 offset:0
    ds_read_b64_tr_b16 a[134:135], v14 offset:512
    v_mfma_f32_16x16x32_bf16 a[164:167], a[136:139], a[68:71], a[164:167]
    s_add_u32 m0, s54, 0
    s_add_u32 s47, s49, 229376
    v_mfma_f32_16x16x32_bf16 a[164:167], a[140:143], a[100:103], a[164:167]
    buffer_load_dwordx4 v8, s[24:27], s49 offen offset:1024 nt lds
    v_mfma_f32_16x16x32_bf16 a[176:179], a[136:139], a[72:75], a[176:179]
    s_add_u32 m0, s53, 32768
    ds_read_b128 a[0:3], v11 offset:0
    v_mfma_f32_16x16x32_bf16 a[176:179], a[140:143], a[104:107], a[176:179]
    buffer_load_dwordx4 v5, s[16:19], s46 offen offset:1024 lds
    v_mfma_f32_16x16x32_bf16 a[188:191], a[136:139], a[76:79], a[188:191]
    ds_read_b128 a[32:35], v17 offset:0
    v_mfma_f32_16x16x32_bf16 a[188:191], a[140:143], a[108:111], a[188:191]
    v_mfma_f32_16x16x32_bf16 a[204:207], a[136:139], a[80:83], a[204:207]
    v_mfma_f32_16x16x32_bf16 a[204:207], a[140:143], a[112:115], a[204:207]
    v_mfma_f32_16x16x32_bf16 a[220:223], a[136:139], a[84:87], a[220:223]
    v_mfma_f32_16x16x32_bf16 a[220:223], a[140:143], a[116:119], a[220:223]
    v_mfma_f32_16x16x32_bf16 a[236:239], a[136:139], a[88:91], a[236:239]
    v_mfma_f32_16x16x32_bf16 a[236:239], a[140:143], a[120:123], a[236:239]
    v_mfma_f32_16x16x32_bf16 a[252:255], a[136:139], a[92:95], a[252:255]
    v_mfma_f32_16x16x32_bf16 a[252:255], a[140:143], a[124:127], a[252:255]
    s_waitcnt lgkmcnt(2)
    v_mfma_f32_16x16x32_bf16 v[48:51], a[128:131], a[64:67], v[48:51]
    ds_read_b64_tr_b16 a[136:137], v13 offset:40960
    ds_read_b64_tr_b16 a[138:139], v13 offset:41472
    v_mfma_f32_16x16x32_bf16 v[48:51], a[132:135], a[96:99], v[48:51]
    ds_read_b64_tr_b16 a[140:141], v15 offset:0
    ds_read_b64_tr_b16 a[142:143], v15 offset:512
    v_mfma_f32_16x16x32_bf16 v[76:79], a[128:131], a[68:71], v[76:79]
    s_add_u32 m0, s54, 20480
    ds_read_b128 a[4:7], v11 offset:2048
    v_mfma_f32_16x16x32_bf16 v[76:79], a[132:135], a[100:103], v[76:79]
    buffer_load_dwordx4 v8, s[24:27], s47 offen offset:1024 nt lds
    v_mfma_f32_16x16x32_bf16 v[104:107], a[128:131], a[72:75], v[104:107]
    s_add_u32 s49, s47, 229376
    s_add_u32 m0, s53, 32768
    v_mfma_f32_16x16x32_bf16 v[104:107], a[132:135], a[104:107], v[104:107]
    buffer_load_dwordx4 v6, s[16:19], s46 offen offset:2048 lds
    v_mfma_f32_16x16x32_bf16 v[132:135], a[128:131], a[76:79], v[132:135]
    s_sub_u32 s69, s69, 1
    s_cbranch_scc1 Lf_zb5
Lf_nb5:
    ds_read_b128 a[36:39], v17 offset:2048
    v_mfma_f32_16x16x32_bf16 v[132:135], a[132:135], a[108:111], v[132:135]
    v_mfma_f32_16x16x32_bf16 v[160:163], a[128:131], a[80:83], v[160:163]
    v_mfma_f32_16x16x32_bf16 v[160:163], a[132:135], a[112:115], v[160:163]
    v_mfma_f32_16x16x32_bf16 v[184:187], a[128:131], a[84:87], v[184:187]
    v_mfma_f32_16x16x32_bf16 v[184:187], a[132:135], a[116:119], v[184:187]
    v_mfma_f32_16x16x32_bf16 v[208:211], a[128:131], a[88:91], v[208:211]
    v_mfma_f32_16x16x32_bf16 v[208:211], a[132:135], a[120:123], v[208:211]
    v_mfma_f32_16x16x32_bf16 v[232:235], a[128:131], a[92:95], v[232:235]
    v_mfma_f32_16x16x32_bf16 v[232:235], a[132:135], a[124:127], v[232:235]
    s_waitcnt lgkmcnt(2)
    v_mfma_f32_16x16x32_bf16 v[52:55], a[136:139], a[64:67], v[52:55]
    ds_read_b64_tr_b16 a[128:129], v12 offset:41984
    ds_read_b64_tr_b16 a[130:131], v12 offset:42496
    v_mfma_f32_16x16x32_bf16 v[52:55], a[140:143], a[96:99], v[52:55]
    ds_read_b64_tr_b16 a[132:133], v14 offset:1024
    ds_read_b64_tr_b16 a[134:135], v14 offset:1536
    v_mfma_f32_16x16x32_bf16 v[80:83], a[136:139], a[68:71], v[80:83]
    s_add_u32 m0, s54, 0
    s_add_u32 s47, s50, s52
    v_mfma_f32_16x16x32_bf16 v[80:83], a[140:143], a[100:103], v[80:83]
    buffer_load_dwordx4 v9, s[28:31], s50 offen offset:2048 nt lds
    v_mfma_f32_16x16x32_bf16 v[108:111], a[136:139], a[72:75], v[108:111]
    s_add_u32 m0, s53, 32768
    ds_read_b128 a[8:11], v11 offset:4096
    v_mfma_f32_16x16x32_bf16 v[108:111], a[140:143], a[104:107], v[108:111]
    buffer_load_dwordx4 v7, s[16:19], s46 offen offset:3072 lds
    v_mfma_f32_16x16x32_bf16 v[136:139], a[136:139], a[76:79], v[136:139]
    ds_read_b128 a[40:43], v17 offset:4096
    v_mfma_f32_16x16x32_bf16 v[136:139], a[140:143], a[108:111], v[136:139]
    v_mfma_f32_16x16x32_bf16 v[164:167], a[136:139], a[80:83], v[164:167]
    v_mfma_f32_16x16x32_bf16 v[164:167], a[140:143], a[112:115], v[164:167]
    v_mfma_f32_16x16x32_bf16 v[188:191], a[136:139], a[84:87], v[188:191]
    v_mfma_f32_16x16x32_bf16 v[188:191], a[140:143], a[116:119], v[188:191]
    v_mfma_f32_16x16x32_bf16 v[212:215], a[136:139], a[88:91], v[212:215]
    v_mfma_f32_16x16x32_bf16 v[212:215], a[140:143], a[120:123], v[212:215]
    v_mfma_f32_16x16x32_bf16 v[236:239], a[136:139], a[92:95], v[236:239]
    v_mfma_f32_16x16x32_bf16 v[236:239], a[140:143], a[124:127], v[236:239]
    s_waitcnt lgkmcnt(2)
    v_mfma_f32_16x16x32_bf16 v[56:59], a[128:131], a[64:67], v[56:59]
    ds_read_b64_tr_b16 a[136:137], v13 offset:41984
    ds_read_b64_tr_b16 a[138:139], v13 offset:42496
    v_mfma_f32_16x16x32_bf16 v[56:59], a[132:135], a[96:99], v[56:59]
    ds_read_b64_tr_b16 a[140:141], v15 offset:1024
    ds_read_b64_tr_b16 a[142:143], v15 offset:1536
    v_mfma_f32_16x16x32_bf16 v[84:87], a[128:131], a[68:71], v[84:87]
    s_add_u32 m0, s54, 20480
    ds_read_b128 a[12:15], v11 offset:6144
    v_mfma_f32_16x16x32_bf16 v[84:87], a[132:135], a[100:103], v[84:87]
    buffer_load_dwordx4 v9, s[28:31], s47 offen offset:2048 nt lds
    v_mfma_f32_16x16x32_bf16 v[112:115], a[128:131], a[72:75], v[112:115]
    s_cmp_lt_u32 s14, 512
    s_cselect_b32 s40, s8, s10
    v_mfma_f32_16x16x32_bf16 v[112:115], a[132:135], a[104:107], v[112:115]
    s_cselect_b32 s41, s9, s11
    s_cselect_b32 s42, 2097152, s3
    v_mfma_f32_16x16x32_bf16 v[140:143], a[128:131], a[76:79], v[140:143]
    s_cselect_b32 s72, 0, 512
    s_sub_u32 s72, s14, s72
    v_mfma_f32_16x16x32_bf16 v[140:143], a[132:135], a[108:111], v[140:143]
    s_and_b32 s73, s72, 15
    s_lshl_b32 s73, s73, 7
    v_mfma_f32_16x16x32_bf16 v[168:171], a[128:131], a[80:83], v[168:171]
    s_lshr_b32 s72, s72, 4
    s_lshl_b32 s72, s72, 16
    v_mfma_f32_16x16x32_bf16 v[168:171], a[132:135], a[112:115], v[168:171]
    s_add_u32 s72, s72, s73
    s_lshl_b32 s76, s14, 12
    v_mfma_f32_16x16x32_bf16 v[192:195], a[128:131], a[84:87], v[192:195]
    s_add_u32 s76, s76, s65
    s_add_u32 m0, s44, 0
    v_mfma_f32_16x16x32_bf16 v[192:195], a[132:135], a[116:119], v[192:195]
    s_add_u32 s14, s14, 1
    ds_read_b128 a[44:47], v17 offset:6144
    v_mfma_f32_16x16x32_bf16 v[216:219], a[128:131], a[88:91], v[216:219]
    buffer_load_dwordx4 v16, s[40:43], s72 offen nt lds
    v_mfma_f32_16x16x32_bf16 v[216:219], a[132:135], a[120:123], v[216:219]
    v_mfma_f32_16x16x32_bf16 v[240:243], a[128:131], a[92:95], v[240:243]
    v_mfma_f32_16x16x32_bf16 v[240:243], a[132:135], a[124:127], v[240:243]
    s_waitcnt vmcnt(11) lgkmcnt(0)
    s_barrier
    v_mfma_f32_16x16x32_bf16 v[60:63], a[136:139], a[64:67], v[60:63]
    v_mfma_f32_16x16x32_bf16 v[60:63], a[140:143], a[96:99], v[60:63]
    ds_read_b64_tr_b16 a[128:129], v12 offset:43008
    ds_read_b64_tr_b16 a[130:131], v12 offset:43520
    v_mfma_f32_16x16x32_bf16 v[88:91], a[136:139], a[68:71], v[88:91]
    ds_read_b64_tr_b16 a[132:133], v14 offset:2048
    ds_read_b64_tr_b16 a[134:135], v14 offset:2560
    v_mfma_f32_16x16x32_bf16 v[88:91], a[140:143], a[100:103], v[88:91]
    s_add_u32 m0, s54, 0
    s_add_u32 s47, s50, s52
    v_mfma_f32_16x16x32_bf16 v[116:119], a[136:139], a[72:75], v[116:119]
    buffer_load_dwordx4 v9, s[32:35], s50 offen offset:3072 nt lds
    v_mfma_f32_16x16x32_bf16 v[116:119], a[140:143], a[104:107], v[116:119]
    s_add_u32 m0, s53, 40960
    s_add_u32 s46, s48, 131072
    v_mfma_f32_16x16x32_bf16 v[144:147], a[136:139], a[76:79], v[144:147]
    buffer_load_dwordx4 v4, s[16:19], s46 offen offset:0 lds
    v_mfma_f32_16x16x32_bf16 v[144:147], a[140:143], a[108:111], v[144:147]
    ds_read_b128 a[16:19], v11 offset:8192
    ds_read_b128 a[48:51], v17 offset:8192
    v_mfma_f32_16x16x32_bf16 v[172:175], a[136:139], a[80:83], v[172:175]
    ds_read_b64_tr_b16 v[24:25], v18 offset:4096
    ds_read_b64_tr_b16 v[26:27], v18 offset:4608
    v_mfma_f32_16x16x32_bf16 v[172:175], a[140:143], a[112:115], v[172:175]
    v_mfma_f32_16x16x32_bf16 v[196:199], a[136:139], a[84:87], v[196:199]
    v_mfma_f32_16x16x32_bf16 v[196:199], a[140:143], a[116:119], v[196:199]
    v_mfma_f32_16x16x32_bf16 v[220:223], a[136:139], a[88:91], v[220:223]
    v_mfma_f32_16x16x32_bf16 v[220:223], a[140:143], a[120:123], v[220:223]
    v_mfma_f32_16x16x32_bf16 v[244:247], a[136:139], a[92:95], v[244:247]
    v_mfma_f32_16x16x32_bf16 v[244:247], a[140:143], a[124:127], v[244:247]
    s_waitcnt lgkmcnt(0)
    v_mfma_f32_16x16x32_bf16 v[64:67], a[128:131], a[64:67], v[64:67]
    ds_read_b64_tr_b16 a[136:137], v13 offset:43008
    ds_read_b64_tr_b16 a[138:139], v13 offset:43520
    v_mfma_f32_16x16x32_bf16 v[64:67], a[132:135], a[96:99], v[64:67]
    ds_read_b64_tr_b16 a[140:141], v15 offset:2048
    ds_read_b64_tr_b16 a[142:143], v15 offset:2560
    v_mfma_f32_16x16x32_bf16 v[92:95], a[128:131], a[68:71], v[92:95]
    s_add_u32 m0, s54, 20480
    ds_read_b128 a[20:23], v11 offset:10240
    v_mfma_f32_16x16x32_bf16 v[92:95], a[132:135], a[100:103], v[92:95]
    buffer_load_dwordx4 v9, s[32:35], s47 offen offset:3072 nt lds
    v_mfma_f32_16x16x32_bf16 v[120:123], a[128:131], a[72:75], v[120:123]
    s_add_u32 s50, s47, s52
    s_add_u32 m0, s53, 40960
    v_mfma_f32_16x16x32_bf16 v[120:123], a[132:135], a[104:107], v[120:123]
    buffer_load_dwordx4 v5, s[16:19], s46 offen offset:1024 lds
    v_mfma_f32_16x16x32_bf16 v[148:151], a[128:131], a[76:79], v[148:151]
    buffer_store_dwordx4 v[24:27], v19, s[4:7], s77 offen sc1
    v_mfma_f32_16x16x32_bf16 v[148:151], a[132:135], a[108:111], v[148:151]
    ds_read_b128 a[52:55], v17 offset:10240
    v_mfma_f32_16x16x32_bf16 v[176:179], a[128:131], a[80:83], v[176:179]
    v_mfma_f32_16x16x32_bf16 v[176:179], a[132:135], a[112:115], v[176:179]
    v_mfma_f32_16x16x32_bf16 v[200:203], a[128:131], a[84:87], v[200:203]
    v_mfma_f32_16x16x32_bf16 v[200:203], a[132:135], a[116:119], v[200:203]
    v_mfma_f32_16x16x32_bf16 v[224:227], a[128:131], a[88:91], v[224:227]
    v_mfma_f32_16x16x32_bf16 v[224:227], a[132:135], a[120:123], v[224:227]
    v_mfma_f32_16x16x32_bf16 v[248:251], a[128:131], a[92:95], v[248:251]
    v_mfma_f32_16x16x32_bf16 v[248:251], a[132:135], a[124:127], v[248:251]
    s_waitcnt lgkmcnt(2)
    v_mfma_f32_16x16x32_bf16 v[68:71], a[136:139], a[64:67], v[68:71]
    ds_read_b64_tr_b16 a[128:129], v12 offset:44032
    ds_read_b64_tr_b16 a[130:131], v12 offset:44544
    v_mfma_f32_16x16x32_bf16 v[68:71], a[140:143], a[96:99], v[68:71]
    ds_read_b64_tr_b16 a[132:133], v14 offset:3072
    ds_read_b64_tr_b16 a[134:135], v14 offset:3584
    v_mfma_f32_16x16x32_bf16 v[96:99], a[136:139], a[68:71], v[96:99]
    s_add_u32 m0, s54, 45056
    s_add_u32 s47, s51, 196608
    v_mfma_f32_16x16x32_bf16 v[96:99], a[140:143], a[100:103], v[96:99]
    buffer_load_dwordx4 v10, s[36:39], s51 offen  nt lds
    v_mfma_f32_16x16x32_bf16 v[124:127], a[136:139], a[72:75], v[124:127]
    s_add_u32 m0, s53, 40960
    ds_read_b128 a[24:27], v11 offset:12288
    v_mfma_f32_16x16x32_bf16 v[124:127], a[140:143], a[104:107], v[124:127]
    buffer_load_dwordx4 v6, s[16:19], s46 offen offset:2048 lds
    v_mfma_f32_16x16x32_bf16 v[152:155], a[136:139], a[76:79], v[152:155]
    s_sub_u32 s69, s69, 1
    s_cbranch_scc1 Lf_zb6
Lf_nb6:
    ds_read_b128 a[56:59], v17 offset:12288
    v_mfma_f32_16x16x32_bf16 v[152:155], a[140:143], a[108:111], v[152:155]
    v_mfma_f32_16x16x32_bf16 v[180:183], a[136:139], a[80:83], v[180:183]
    v_mfma_f32_16x16x32_bf16 v[180:183], a[140:143], a[112:115], v[180:183]
    v_mfma_f32_16x16x32_bf16 v[204:207], a[136:139], a[84:87], v[204:207]
    v_mfma_f32_16x16x32_bf16 v[204:207], a[140:143], a[116:119], v[204:207]
    v_mfma_f32_16x16x32_bf16 v[228:231], a[136:139], a[88:91], v[228:231]
    v_mfma_f32_16x16x32_bf16 v[228:231], a[140:143], a[120:123], v[228:231]
    v_mfma_f32_16x16x32_bf16 v[252:255], a[136:139], a[92:95], v[252:255]
    v_mfma_f32_16x16x32_bf16 v[252:255], a[140:143], a[124:127], v[252:255]
    s_waitcnt lgkmcnt(2)
    v_mfma_f32_16x16x32_bf16 v[72:75], a[128:131], a[64:67], v[72:75]
    ds_read_b64_tr_b16 a[136:137], v13 offset:44032
    ds_read_b64_tr_b16 a[138:139], v13 offset:44544
    v_mfma_f32_16x16x32_bf16 v[72:75], a[132:135], a[96:99], v[72:75]
    ds_read_b64_tr_b16 a[140:141], v15 offset:3072
    ds_read_b64_tr_b16 a[142:143], v15 offset:3584
    v_mfma_f32_16x16x32_bf16 v[100:103], a[128:131], a[68:71], v[100:103]
    s_add_u32 m0, s54, 65536
    ds_read_b128 a[28:31], v11 offset:14336
    v_mfma_f32_16x16x32_bf16 v[100:103], a[132:135], a[100:103], v[100:103]
    buffer_load_dwordx4 v10, s[36:39], s47 offen  nt lds
    v_mfma_f32_16x16x32_bf16 v[128:131], a[128:131], a[72:75], v[128:131]
    s_add_u32 s51, s47, 196608
    s_add_u32 m0, s53, 40960
    v_mfma_f32_16x16x32_bf16 v[128:131], a[132:135], a[104:107], v[128:131]
    buffer_load_dwordx4 v7, s[16:19], s46 offen offset:3072 lds
    v_mfma_f32_16x16x32_bf16 v[156:159], a[128:131], a[76:79], v[156:159]
    s_add_u32 s48, s48, 128
    ds_read_b128 a[60:63], v17 offset:14336
    v_mfma_f32_16x16x32_bf16 v[156:159], a[132:135], a[108:111], v[156:159]
    v_mfma_f32_16x16x32_bf16 a[192:195], a[128:131], a[80:83], a[192:195]
    v_mfma_f32_16x16x32_bf16 a[192:195], a[132:135], a[112:115], a[192:195]
    v_mfma_f32_16x16x32_bf16 a[208:211], a[128:131], a[84:87], a[208:211]
    v_mfma_f32_16x16x32_bf16 a[208:211], a[132:135], a[116:119], a[208:211]
    v_mfma_f32_16x16x32_bf16 a[224:227], a[128:131], a[88:91], a[224:227]
    v_mfma_f32_16x16x32_bf16 a[224:227], a[132:135], a[120:123], a[224:227]
    v_mfma_f32_16x16x32_bf16 a[240:243], a[128:131], a[92:95], a[240:243]
    v_mfma_f32_16x16x32_bf16 a[240:243], a[132:135], a[124:127], a[240:243]
    s_waitcnt vmcnt(11) lgkmcnt(0)
    s_barrier
    v_mfma_f32_16x16x32_bf16 a[144:147], a[136:139], a[64:67], a[144:147]
    v_mfma_f32_16x16x32_bf16 a[144:147], a[140:143], a[96:99], a[144:147]
    ds_read_b64_tr_b16 a[128:129], v12 offset:4096
    ds_read_b64_tr_b16 a[130:131], v12 offset:4608
    v_mfma_f32_16x16x32_bf16 a[156:159], a[136:139], a[68:71], a[156:159]
    ds_read_b64_tr_b16 a[132:133], v12 offset:24576
    ds_read_b64_tr_b16 a[134:135], v12 offset:25088
    v_mfma_f32_16x16x32_bf16 a[156:159], a[140:143], a[100:103], a[156:159]
    s_add_u32 m0, s54, 40960
    s_add_u32 s47, s49, 229376
    v_mfma_f32_16x16x32_bf16 a[168:171], a[136:139], a[72:75], a[168:171]
    buffer_load_dwordx4 v8, s[20:23], s49 offen offset:0 nt lds
    v_mfma_f32_16x16x32_bf16 a[168:171], a[140:143], a[104:107], a[168:171]
    s_and_b32 s96, s96, 7
    v_mul_lo_u32 v39, v38, s96
    v_mfma_f32_16x16x32_bf16 a[180:183], a[136:139], a[76:79], a[180:183]
    v_add_co_u32 v40, vcc, v36, v39
    s_add_u32 s96, s96, 1
    v_mfma_f32_16x16x32_bf16 a[180:183], a[140:143], a[108:111], a[180:183]
    s_nop 1
    v_addc_co_u32 v41, vcc, 0, v37, vcc
    v_mfma_f32_16x16x32_bf16 a[196:199], a[136:139], a[80:83], a[196:199]
    s_mov_b64 exec, 0x3ff
    global_load_dword v1, v[40:41], off
    s_mov_b64 exec, -1
    v_mfma_f32_16x16x32_bf16 a[196:199], a[140:143], a[112:115], a[196:199]
    v_mfma_f32_16x16x32_bf16 a[212:215], a[136:139], a[84:87], a[212:215]
    v_mfma_f32_16x16x32_bf16 a[212:215], a[140:143], a[116:119], a[212:215]
    v_mfma_f32_16x16x32_bf16 a[228:231], a[136:139], a[88:91], a[228:231]
    v_mfma_f32_16x16x32_bf16 a[228:231], a[140:143], a[120:123], a[228:231]
    v_mfma_f32_16x16x32_bf16 a[244:247], a[136:139], a[92:95], a[244:247]
    v_mfma_f32_16x16x32_bf16 a[244:247], a[140:143], a[124:127], a[244:247]
    s_waitcnt lgkmcnt(0)
    v_mfma_f32_16x16x32_bf16 a[148:151], a[128:131], a[0:3], a[148:151]
    ds_read_b64_tr_b16 a[136:137], v13 offset:4096
    ds_read_b64_tr_b16 a[138:139], v13 offset:4608
    v_mfma_f32_16x16x32_bf16 a[148:151], a[132:135], a[32:35], a[148:151]
    ds_read_b64_tr_b16 a[140:141], v13 offset:24576
    ds_read_b64_tr_b16 a[142:143], v13 offset:25088
    v_mfma_f32_16x16x32_bf16 a[160:163], a[128:131], a[4:7], a[160:163]
    s_add_u32 m0, s54, 61440
    v_mfma_f32_16x16x32_bf16 a[160:163], a[132:135], a[36:39], a[160:163]
    buffer_load_dwordx4 v8, s[20:23], s47 offen offset:0 nt lds
    v_mfma_f32_16x16x32_bf16 a[172:175], a[128:131], a[8:11], a[172:175]
    s_add_u32 m0, s53, 0
    s_add_u32 s46, s48, 0
    v_mfma_f32_16x16x32_bf16 a[172:175], a[132:135], a[40:43], a[172:175]
    buffer_load_dwordx4 v4, s[16:19], s46 offen offset:0 lds
    v_mfma_f32_16x16x32_bf16 a[184:187], a[128:131], a[12:15], a[184:187]
    v_mfma_f32_16x16x32_bf16 a[184:187], a[132:135], a[44:47], a[184:187]
    v_mfma_f32_16x16x32_bf16 a[200:203], a[128:131], a[16:19], a[200:203]
    v_mfma_f32_16x16x32_bf16 a[200:203], a[132:135], a[48:51], a[200:203]
    v_mfma_f32_16x16x32_bf16 a[216:219], a[128:131], a[20:23], a[216:219]
    v_mfma_f32_16x16x32_bf16 a[216:219], a[132:135], a[52:55], a[216:219]
    v_mfma_f32_16x16x32_bf16 a[232:235], a[128:131], a[24:27], a[232:235]
    v_mfma_f32_16x16x32_bf16 a[232:235], a[132:135], a[56:59], a[232:235]
    v_mfma_f32_16x16x32_bf16 a[248:251], a[128:131], a[28:31], a[248:251]
    v_mfma_f32_16x16x32_bf16 a[248:251], a[132:135], a[60:63], a[248:251]
    s_waitcnt lgkmcnt(0)
    v_mfma_f32_16x16x32_bf16 a[152:155], a[136:139], a[0:3], a[152:155]
    ds_read_b64_tr_b16 a[128:129], v12 offset:0
    ds_read_b64_tr_b16 a[130:131], v12 offset:512
    v_mfma_f32_16x16x32_bf16 a[152:155], a[140:143], a[32:35], a[152:155]
    ds_read_b64_tr_b16 a[132:133], v12 offset:20480
    ds_read_b64_tr_b16 a[134:135], v12 offset:20992
    v_mfma_f32_16x16x32_bf16 a[164:167], a[136:139], a[4:7], a[164:167]
    s_add_u32 m0, s54, 40960
    s_add_u32 s47, s49, 229376
    v_mfma_f32_16x16x32_bf16 a[164:167], a[140:143], a[36:39], a[164:167]
    buffer_load_dwordx4 v8, s[24:27], s49 offen offset:1024 nt lds
    v_mfma_f32_16x16x32_bf16 a[176:179], a[136:139], a[8:11], a[176:179]
    s_add_u32 m0, s53, 0
    ds_read_b128 a[64:67], v11 offset:32768
    v_mfma_f32_16x16x32_bf16 a[176:179], a[140:143], a[40:43], a[176:179]
    buffer_load_dwordx4 v5, s[16:19], s46 offen offset:1024 lds
    v_mfma_f32_16x16x32_bf16 a[188:191], a[136:139], a[12:15], a[188:191]
    ds_read_b128 a[96:99], v17 offset:32768
    v_mfma_f32_16x16x32_bf16 a[188:191], a[140:143], a[44:47], a[188:191]
    v_mfma_f32_16x16x32_bf16 a[204:207], a[136:139], a[16:19], a[204:207]
    v_mfma_f32_16x16x32_bf16 a[204:207], a[140:143], a[48:51], a[204:207]
    v_mfma_f32_16x16x32_bf16 a[220:223], a[136:139], a[20:23], a[220:223]
    v_mfma_f32_16x16x32_bf16 a[220:223], a[140:143], a[52:55], a[220:223]
    v_mfma_f32_16x16x32_bf16 a[236:239], a[136:139], a[24:27], a[236:239]
    v_mfma_f32_16x16x32_bf16 a[236:239], a[140:143], a[56:59], a[236:239]
    v_mfma_f32_16x16x32_bf16 a[252:255], a[136:139], a[28:31], a[252:255]
    v_mfma_f32_16x16x32_bf16 a[252:255], a[140:143], a[60:63], a[252:255]
    s_waitcnt lgkmcnt(2)
    v_mfma_f32_16x16x32_bf16 v[48:51], a[128:131], a[0:3], v[48:51]
    ds_read_b64_tr_b16 a[136:137], v13 offset:0
    ds_read_b64_tr_b16 a[138:139], v13 offset:512
    v_mfma_f32_16x16x32_bf16 v[48:51], a[132:135], a[32:35], v[48:51]
    ds_read_b64_tr_b16 a[140:141], v13 offset:20480
    ds_read_b64_tr_b16 a[142:143], v13 offset:20992
    v_mfma_f32_16x16x32_bf16 v[76:79], a[128:131], a[4:7], v[76:79]
    s_add_u32 m0, s54, 61440
    ds_read_b128 a[68:71], v11 offset:34816
    v_mfma_f32_16x16x32_bf16 v[76:79], a[132:135], a[36:39], v[76:79]
    buffer_load_dwordx4 v8, s[24:27], s47 offen offset:1024 nt lds
    v_mfma_f32_16x16x32_bf16 v[104:107], a[128:131], a[8:11], v[104:107]
    s_add_u32 s49, s47, 229376
    s_add_u32 m0, s53, 0
    v_mfma_f32_16x16x32_bf16 v[104:107], a[132:135], a[40:43], v[104:107]
    buffer_load_dwordx4 v6, s[16:19], s46 offen offset:2048 lds
    v_mfma_f32_16x16x32_bf16 v[132:135], a[128:131], a[12:15], v[132:135]
    s_sub_u32 s69, s69, 1
    s_cbranch_scc1 Lf_zb7
Lf_nb7:
    ds_read_b128 a[100:103], v17 offset:34816
    v_mfma_f32_16x16x32_bf16 v[132:135], a[132:135], a[44:47], v[132:135]
    v_mfma_f32_16x16x32_bf16 v[160:163], a[128:131], a[16:19], v[160:163]
    v_mfma_f32_16x16x32_bf16 v[160:163], a[132:135], a[48:51], v[160:163]
    v_mfma_f32_16x16x32_bf16 v[184:187], a[128:131], a[20:23], v[184:187]
    v_mfma_f32_16x16x32_bf16 v[184:187], a[132:135], a[52:55], v[184:187]
    v_mfma_f32_16x16x32_bf16 v[208:211], a[128:131], a[24:27], v[208:211]
    v_mfma_f32_16x16x32_bf16 v[208:211], a[132:135], a[56:59], v[208:211]
    v_mfma_f32_16x16x32_bf16 v[232:235], a[128:131], a[28:31], v[232:235]
    v_mfma_f32_16x16x32_bf16 v[232:235], a[132:135], a[60:63], v[232:235]
    s_waitcnt lgkmcnt(2)
    v_mfma_f32_16x16x32_bf16 v[52:55], a[136:139], a[0:3], v[52:55]
    ds_read_b64_tr_b16 a[128:129], v12 offset:1024
    ds_read_b64_tr_b16 a[130:131], v12 offset:1536
    v_mfma_f32_16x16x32_bf16 v[52:55], a[140:143], a[32:35], v[52:55]
    ds_read_b64_tr_b16 a[132:133], v12 offset:21504
    ds_read_b64_tr_b16 a[134:135], v12 offset:22016
    v_mfma_f32_16x16x32_bf16 v[80:83], a[136:139], a[4:7], v[80:83]
    s_add_u32 m0, s54, 40960
    s_add_u32 s47, s50, s52
    v_mfma_f32_16x16x32_bf16 v[80:83], a[140:143], a[36:39], v[80:83]
    buffer_load_dwordx4 v9, s[28:31], s50 offen offset:2048 nt lds
    v_mfma_f32_16x16x32_bf16 v[108:111], a[136:139], a[8:11], v[108:111]
    s_add_u32 m0, s53, 0
    ds_read_b128 a[72:75], v11 offset:36864
    v_mfma_f32_16x16x32_bf16 v[108:111], a[140:143], a[40:43], v[108:111]
    buffer_load_dwordx4 v7, s[16:19], s46 offen offset:3072 lds
    v_mfma_f32_16x16x32_bf16 v[136:139], a[136:139], a[12:15], v[136:139]
    ds_read_b128 a[104:107], v17 offset:36864
    v_mfma_f32_16x16x32_bf16 v[136:139], a[140:143], a[44:47], v[136:139]
    v_mfma_f32_16x16x32_bf16 v[164:167], a[136:139], a[16:19], v[164:167]
    v_mfma_f32_16x16x32_bf16 v[164:167], a[140:143], a[48:51], v[164:167]
    v_mfma_f32_16x16x32_bf16 v[188:191], a[136:139], a[20:23], v[188:191]
    v_mfma_f32_16x16x32_bf16 v[188:191], a[140:143], a[52:55], v[188:191]
    v_mfma_f32_16x16x32_bf16 v[212:215], a[136:139], a[24:27], v[212:215]
    v_mfma_f32_16x16x32_bf16 v[212:215], a[140:143], a[56:59], v[212:215]
    v_mfma_f32_16x16x32_bf16 v[236:239], a[136:139], a[28:31], v[236:239]
    v_mfma_f32_16x16x32_bf16 v[236:239], a[140:143], a[60:63], v[236:239]
    s_waitcnt lgkmcnt(2)
    v_mfma_f32_16x16x32_bf16 v[56:59], a[128:131], a[0:3], v[56:59]
    ds_read_b64_tr_b16 a[136:137], v13 offset:1024
    ds_read_b64_tr_b16 a[138:139], v13 offset:1536
    v_mfma_f32_16x16x32_bf16 v[56:59], a[132:135], a[32:35], v[56:59]
    ds_read_b64_tr_b16 a[140:141], v13 offset:21504
    ds_read_b64_tr_b16 a[142:143], v13 offset:22016
    v_mfma_f32_16x16x32_bf16 v[84:87], a[128:131], a[4:7], v[84:87]
    s_add_u32 m0, s54, 61440
    ds_read_b128 a[76:79], v11 offset:38912
    v_mfma_f32_16x16x32_bf16 v[84:87], a[132:135], a[36:39], v[84:87]
    buffer_load_dwordx4 v9, s[28:31], s47 offen offset:2048 nt lds
    v_mfma_f32_16x16x32_bf16 v[112:115], a[128:131], a[8:11], v[112:115]
    ds_read_b128 a[108:111], v17 offset:38912
    v_mfma_f32_16x16x32_bf16 v[112:115], a[132:135], a[40:43], v[112:115]
    v_mfma_f32_16x16x32_bf16 v[140:143], a[128:131], a[12:15], v[140:143]
    v_mfma_f32_16x16x32_bf16 v[140:143], a[132:135], a[44:47], v[140:143]
    v_mfma_f32_16x16x32_bf16 v[168:171], a[128:131], a[16:19], v[168:171]
    v_mfma_f32_16x16x32_bf16 v[168:171], a[132:135], a[48:51], v[168:171]
    v_mfma_f32_16x16x32_bf16 v[192:195], a[128:131], a[20:23], v[192:195]
    v_mfma_f32_16x16x32_bf16 v[192:195], a[132:135], a[52:55], v[192:195]
    v_mfma_f32_16x16x32_bf16 v[216:219], a[128:131], a[24:27], v[216:219]
    v_mfma_f32_16x16x32_bf16 v[216:219], a[132:135], a[56:59], v[216:219]
    v_mfma_f32_16x16x32_bf16 v[240:243], a[128:131], a[28:31], v[240:243]
    v_mfma_f32_16x16x32_bf16 v[240:243], a[132:135], a[60:63], v[240:243]
    s_waitcnt vmcnt(11) lgkmcnt(0)
    s_barrier
    v_mfma_f32_16x16x32_bf16 v[60:63], a[136:139], a[0:3], v[60:63]
    v_mfma_f32_16x16x32_bf16 v[60:63], a[140:143], a[32:35], v[60:63]
    ds_read_b64_tr_b16 a[128:129], v12 offset:2048
    ds_read_b64_tr_b16 a[130:131], v12 offset:2560
    v_mfma_f32_16x16x32_bf16 v[88:91], a[136:139], a[4:7], v[88:91]
    ds_read_b64_tr_b16 a[132:133], v12 offset:22528
    ds_read_b64_tr_b16 a[134:135], v12 offset:23040
    v_mfma_f32_16x16x32_bf16 v[88:91], a[140:143], a[36:39], v[88:91]
    s_add_u32 m0, s54, 40960
    s_add_u32 s47, s50, s52
    v_mfma_f32_16x16x32_bf16 v[116:119], a[136:139], a[8:11], v[116:119]
    buffer_load_dwordx4 v9, s[32:35], s50 offen offset:3072 nt lds
    v_mfma_f32_16x16x32_bf16 v[116:119], a[140:143], a[40:43], v[116:119]
    s_add_u32 m0, s53, 8192
    s_add_u32 s46, s48, 131072
    v_mfma_f32_16x16x32_bf16 v[144:147], a[136:139], a[12:15], v[144:147]
    buffer_load_dwordx4 v4, s[16:19], s46 offen offset:0 lds
    v_mfma_f32_16x16x32_bf16 v[144:147], a[140:143], a[44:47], v[144:147]
    ds_read_b128 a[80:83], v11 offset:40960
    ds_read_b128 a[112:115], v17 offset:40960
    v_mfma_f32_16x16x32_bf16 v[172:175], a[136:139], a[16:19], v[172:175]
    ds_read_b64_tr_b16 v[24:25], v18 offset:0
    ds_read_b64_tr_b16 v[26:27], v18 offset:512
    v_mfma_f32_16x16x32_bf16 v[172:175], a[140:143], a[48:51], v[172:175]
    v_mfma_f32_16x16x32_bf16 v[196:199], a[136:139], a[20:23], v[196:199]
    v_mfma_f32_16x16x32_bf16 v[196:199], a[140:143], a[52:55], v[196:199]
    v_mfma_f32_16x16x32_bf16 v[220:223], a[136:139], a[24:27], v[220:223]
    v_mfma_f32_16x16x32_bf16 v[220:223], a[140:143], a[56:59], v[220:223]
    v_mfma_f32_16x16x32_bf16 v[244:247], a[136:139], a[28:31], v[244:247]
    v_mfma_f32_16x16x32_bf16 v[244:247], a[140:143], a[60:63], v[244:247]
    s_waitcnt lgkmcnt(0)
    v_mfma_f32_16x16x32_bf16 v[64:67], a[128:131], a[0:3], v[64:67]
    ds_read_b64_tr_b16 a[136:137], v13 offset:2048
    ds_read_b64_tr_b16 a[138:139], v13 offset:2560
    v_mfma_f32_16x16x32_bf16 v[64:67], a[132:135], a[32:35], v[64:67]
    ds_read_b64_tr_b16 a[140:141], v13 offset:22528
    ds_read_b64_tr_b16 a[142:143], v13 offset:23040
    v_mfma_f32_16x16x32_bf16 v[92:95], a[128:131], a[4:7], v[92:95]
    s_add_u32 m0, s54, 61440
    ds_read_b128 a[84:87], v11 offset:43008
    v_mfma_f32_16x16x32_bf16 v[92:95], a[132:135], a[36:39], v[92:95]
    buffer_load_dwordx4 v9, s[32:35], s47 offen offset:3072 nt lds
    v_mfma_f32_16x16x32_bf16 v[120:123], a[128:131], a[8:11], v[120:123]
    s_add_u32 s50, s47, s52
    s_add_u32 m0, s53, 8192
    v_mfma_f32_16x16x32_bf16 v[120:123], a[132:135], a[40:43], v[120:123]
    buffer_load_dwordx4 v5, s[16:19], s46 offen offset:1024 lds
    v_mfma_f32_16x16x32_bf16 v[148:151], a[128:131], a[12:15], v[148:151]
    buffer_store_dwordx4 v[24:27], v19, s[4:7], s76 offen sc1
    v_mfma_f32_16x16x32_bf16 v[148:151], a[132:135], a[44:47], v[148:151]
    ds_read_b128 a[116:119], v17 offset:43008
    v_mfma_f32_16x16x32_bf16 v[176:179], a[128:131], a[16:19], v[176:179]
    v_mfma_f32_16x16x32_bf16 v[176:179], a[132:135], a[48:51], v[176:179]
    v_mfma_f32_16x16x32_bf16 v[200:203], a[128:131], a[20:23], v[200:203]
    v_mfma_f32_16x16x32_bf16 v[200:203], a[132:135], a[52:55], v[200:203]
    v_mfma_f32_16x16x32_bf16 v[224:227], a[128:131], a[24:27], v[224:227]
    v_mfma_f32_16x16x32_bf16 v[224:227], a[132:135], a[56:59], v[224:227]
    v_mfma_f32_16x16x32_bf16 v[248:251], a[128:131], a[28:31], v[248:251]
    v_mfma_f32_16x16x32_bf16 v[248:251], a[132:135], a[60:63], v[248:251]
    s_waitcnt lgkmcnt(2)
    v_mfma_f32_16x16x32_bf16 v[68:71], a[136:139], a[0:3], v[68:71]
    ds_read_b64_tr_b16 a[128:129], v12 offset:3072
    ds_read_b64_tr_b16 a[130:131], v12 offset:3584
    v_mfma_f32_16x16x32_bf16 v[68:71], a[140:143], a[32:35], v[68:71]
    ds_read_b64_tr_b16 a[132:133], v12 offset:23552
    ds_read_b64_tr_b16 a[134:135], v12 offset:24064
    v_mfma_f32_16x16x32_bf16 v[96:99], a[136:139], a[4:7], v[96:99]
    s_add_u32 m0, s54, 4096
    s_add_u32 s47, s51, 196608
    v_mfma_f32_16x16x32_bf16 v[96:99], a[140:143], a[36:39], v[96:99]
    buffer_load_dwordx4 v10, s[36:39], s51 offen  nt lds
    v_mfma_f32_16x16x32_bf16 v[124:127], a[136:139], a[8:11], v[124:127]
    s_add_u32 m0, s53, 8192
    ds_read_b128 a[88:91], v11 offset:45056
    v_mfma_f32_16x16x32_bf16 v[124:127], a[140:143], a[40:43], v[124:127]
    buffer_load_dwordx4 v6, s[16:19], s46 offen offset:2048 lds
    v_mfma_f32_16x16x32_bf16 v[152:155], a[136:139], a[12:15], v[152:155]
    s_sub_u32 s69, s69, 1
    s_cbranch_scc1 Lf_zb8
Lf_nb8:
    ds_read_b128 a[120:123], v17 offset:45056
    v_mfma_f32_16x16x32_bf16 v[152:155], a[140:143], a[44:47], v[152:155]
    v_mfma_f32_16x16x32_bf16 v[180:183], a[136:139], a[16:19], v[180:183]
    v_mfma_f32_16x16x32_bf16 v[180:183], a[140:143], a[48:51], v[180:183]
    v_mfma_f32_16x16x32_bf16 v[204:207], a[136:139], a[20:23], v[204:207]
    v_mfma_f32_16x16x32_bf16 v[204:207], a[140:143], a[52:55], v[204:207]
    v_mfma_f32_16x16x32_bf16 v[228:231], a[136:139], a[24:27], v[228:231]
    v_mfma_f32_16x16x32_bf16 v[228:231], a[140:143], a[56:59], v[228:231]
    v_mfma_f32_16x16x32_bf16 v[252:255], a[136:139], a[28:31], v[252:255]
    v_mfma_f32_16x16x32_bf16 v[252:255], a[140:143], a[60:63], v[252:255]
    s_waitcnt lgkmcnt(2)
    v_mfma_f32_16x16x32_bf16 v[72:75], a[128:131], a[0:3], v[72:75]
    ds_read_b64_tr_b16 a[136:137], v13 offset:3072
    ds_read_b64_tr_b16 a[138:139], v13 offset:3584
    v_mfma_f32_16x16x32_bf16 v[72:75], a[132:135], a[32:35], v[72:75]
    ds_read_b64_tr_b16 a[140:141], v13 offset:23552
    ds_read_b64_tr_b16 a[142:143], v13 offset:24064
    v_mfma_f32_16x16x32_bf16 v[100:103], a[128:131], a[4:7], v[100:103]
    s_add_u32 m0, s54, 24576
    ds_read_b128 a[92:95], v11 offset:47104
    v_mfma_f32_16x16x32_bf16 v[100:103], a[132:135], a[36:39], v[100:103]
    buffer_load_dwordx4 v10, s[36:39], s47 offen  nt lds
    v_mfma_f32_16x16x32_bf16 v[128:131], a[128:131], a[8:11], v[128:131]
    s_add_u32 s51, s47, 196608
    s_add_u32 m0, s53, 8192
    v_mfma_f32_16x16x32_bf16 v[128:131], a[132:135], a[40:43], v[128:131]
    buffer_load_dwordx4 v7, s[16:19], s46 offen offset:3072 lds
    v_mfma_f32_16x16x32_bf16 v[156:159], a[128:131], a[12:15], v[156:159]
    s_add_u32 s48, s48, 128
    ds_read_b128 a[124:127], v17 offset:47104
    v_mfma_f32_16x16x32_bf16 v[156:159], a[132:135], a[44:47], v[156:159]
    v_mfma_f32_16x16x32_bf16 a[192:195], a[128:131], a[16:19], a[192:195]
    v_mfma_f32_16x16x32_bf16 a[192:195], a[132:135], a[48:51], a[192:195]
    v_mfma_f32_16x16x32_bf16 a[208:211], a[128:131], a[20:23], a[208:211]
    v_mfma_f32_16x16x32_bf16 a[208:211], a[132:135], a[52:55], a[208:211]
    v_mfma_f32_16x16x32_bf16 a[224:227], a[128:131], a[24:27], a[224:227]
    v_mfma_f32_16x16x32_bf16 a[224:227], a[132:135], a[56:59], a[224:227]
    v_mfma_f32_16x16x32_bf16 a[240:243], a[128:131], a[28:31], a[240:243]
    v_mfma_f32_16x16x32_bf16 a[240:243], a[132:135], a[60:63], a[240:243]
    s_waitcnt vmcnt(10) lgkmcnt(0)
    s_barrier
    v_mfma_f32_16x16x32_bf16 a[144:147], a[136:139], a[0:3], a[144:147]
    v_mfma_f32_16x16x32_bf16 a[144:147], a[140:143], a[32:35], a[144:147]
    ds_read_b64_tr_b16 a[128:129], v12 offset:45056
    ds_read_b64_tr_b16 a[130:131], v12 offset:45568
    v_mfma_f32_16x16x32_bf16 a[156:159], a[136:139], a[4:7], a[156:159]
    ds_read_b64_tr_b16 a[132:133], v14 offset:4096
    ds_read_b64_tr_b16 a[134:135], v14 offset:4608
    v_mfma_f32_16x16x32_bf16 a[156:159], a[140:143], a[36:39], a[156:159]
    s_add_u32 m0, s54, 0
    s_add_u32 s47, s49, 229376
    v_mfma_f32_16x16x32_bf16 a[168:171], a[136:139], a[8:11], a[168:171]
    buffer_load_dwordx4 v8, s[20:23], s49 offen offset:0 nt lds
    v_mfma_f32_16x16x32_bf16 a[168:171], a[140:143], a[40:43], a[168:171]
    v_mfma_f32_16x16x32_bf16 a[180:183], a[136:139], a[12:15], a[180:183]
    v_mfma_f32_16x16x32_bf16 a[180:183], a[140:143], a[44:47], a[180:183]
    v_mfma_f32_16x16x32_bf16 a[196:199], a[136:139], a[16:19], a[196:199]
    v_mfma_f32_16x16x32_bf16 a[196:199], a[140:143], a[48:51], a[196:199]
    v_mfma_f32_16x16x32_bf16 a[212:215], a[136:139], a[20:23], a[212:215]
    v_mfma_f32_16x16x32_bf16 a[212:215], a[140:143], a[52:55], a[212:215]
    v_mfma_f32_16x16x32_bf16 a[228:231], a[136:139], a[24:27], a[228:231]
    v_mfma_f32_16x16x32_bf16 a[228:231], a[140:143], a[56:59], a[228:231]
    v_mfma_f32_16x16x32_bf16 a[244:247], a[136:139], a[28:31], a[244:247]
    v_mfma_f32_16x16x32_bf16 a[244:247], a[140:143], a[60:63], a[244:247]
    s_waitcnt lgkmcnt(0)
    v_mfma_f32_16x16x32_bf16 a[148:151], a[128:131], a[64:67], a[148:151]
    ds_read_b64_tr_b16 a[136:137], v13 offset:45056
    ds_read_b64_tr_b16 a[138:139], v13 offset:45568
    v_mfma_f32_16x16x32_bf16 a[148:151], a[132:135], a[96:99], a[148:151]
    ds_read_b64_tr_b16 a[140:141], v15 offset:4096
    ds_read_b64_tr_b16 a[142:143], v15 offset:4608
    v_mfma_f32_16x16x32_bf16 a[160:163], a[128:131], a[68:71], a[160:163]
    s_add_u32 m0, s54, 20480
    v_mfma_f32_16x16x32_bf16 a[160:163], a[132:135], a[100:103], a[160:163]
    buffer_load_dwordx4 v8, s[20:23], s47 offen offset:0 nt lds
    v_mfma_f32_16x16x32_bf16 a[172:175], a[128:131], a[72:75], a[172:175]
    s_add_u32 m0, s53, 32768
    s_add_u32 s46, s48, 0
    v_mfma_f32_16x16x32_bf16 a[172:175], a[132:135], a[104:107], a[172:175]
    buffer_load_dwordx4 v4, s[16:19], s46 offen offset:0 lds
    v_mfma_f32_16x16x32_bf16 a[184:187], a[128:131], a[76:79], a[184:187]
    v_mfma_f32_16x16x32_bf16 a[184:187], a[132:135], a[108:111], a[184:187]
    v_mfma_f32_16x16x32_bf16 a[200:203], a[128:131], a[80:83], a[200:203]
    v_mfma_f32_16x16x32_bf16 a[200:203], a[132:135], a[112:115], a[200:203]
    v_mfma_f32_16x16x32_bf16 a[216:219], a[128:131], a[84:87], a[216:219]
    v_mfma_f32_16x16x32_bf16 a[216:219], a[132:135], a[116:119], a[216:219]
    v_mfma_f32_16x16x32_bf16 a[232:235], a[128:131], a[88:91], a[232:235]
    v_mfma_f32_16x16x32_bf16 a[232:235], a[132:135], a[120:123], a[232:235]
    v_mfma_f32_16x16x32_bf16 a[248:251], a[128:131], a[92:95], a[248:251]
    v_mfma_f32_16x16x32_bf16 a[248:251], a[132:135], a[124:127], a[248:251]
    s_waitcnt lgkmcnt(0)
    v_mfma_f32_16x16x32_bf16 a[152:155], a[136:139], a[64:67], a[152:155]
    ds_read_b64_tr_b16 a[128:129], v12 offset:40960
    ds_read_b64_tr_b16 a[130:131], v12 offset:41472
    v_mfma_f32_16x16x32_bf16 a[152:155], a[140:143], a[96:99], a[152:155]
    ds_read_b64_tr_b16 a[132:133], v14 offset:0
    ds_read_b64_tr_b16 a[134:135], v14 offset:512
    v_mfma_f32_16x16x32_bf16 a[164:167], a[136:139], a[68:71], a[164:167]
    s_add_u32 m0, s54, 0
    s_add_u32 s47, s49, 229376
    v_mfma_f32_16x16x32_bf16 a[164:167], a[140:143], a[100:103], a[164:167]
    buffer_load_dwordx4 v8, s[24:27], s49 offen offset:1024 nt lds
    v_mfma_f32_16x16x32_bf16 a[176:179], a[136:139], a[72:75], a[176:179]
    s_add_u32 m0, s53, 32768
    ds_read_b128 a[0:3], v11 offset:0
    v_mfma_f32_16x16x32_bf16 a[176:179], a[140:143], a[104:107], a[176:179]
    buffer_load_dwordx4 v5, s[16:19], s46 offen offset:1024 lds
    v_mfma_f32_16x16x32_bf16 a[188:191], a[136:139], a[76:79], a[188:191]
    ds_read_b128 a[32:35], v17 offset:0
    v_mfma_f32_16x16x32_bf16 a[188:191], a[140:143], a[108:111], a[188:191]
    v_mfma_f32_16x16x32_bf16 a[204:207], a[136:139], a[80:83], a[204:207]
    v_mfma_f32_16x16x32_bf16 a[204:207], a[140:143], a[112:115], a[204:207]
    v_mfma_f32_16x16x32_bf16 a[220:223], a[136:139], a[84:87], a[220:223]
    v_mfma_f32_16x16x32_bf16 a[220:223], a[140:143], a[116:119], a[220:223]
    v_mfma_f32_16x16x32_bf16 a[236:239], a[136:139], a[88:91], a[236:239]
    v_mfma_f32_16x16x32_bf16 a[236:239], a[140:143], a[120:123], a[236:239]
    v_mfma_f32_16x16x32_bf16 a[252:255], a[136:139], a[92:95], a[252:255]
    v_mfma_f32_16x16x32_bf16 a[252:255], a[140:143], a[124:127], a[252:255]
    s_add_u32 s55, s55, 1
    s_cmp_lt_u32 s55, 3
    s_cbranch_scc1 Lk1_loop
    s_waitcnt lgkmcnt(2)
    v_mfma_f32_16x16x32_bf16 v[48:51], a[128:131], a[64:67], v[48:51]
    ds_read_b64_tr_b16 a[136:137], v13 offset:40960
    ds_read_b64_tr_b16 a[138:139], v13 offset:41472
    v_mfma_f32_16x16x32_bf16 v[48:51], a[132:135], a[96:99], v[48:51]
    ds_read_b64_tr_b16 a[140:141], v15 offset:0
    ds_read_b64_tr_b16 a[142:143], v15 offset:512
    v_mfma_f32_16x16x32_bf16 v[76:79], a[128:131], a[68:71], v[76:79]
    s_add_u32 m0, s54, 20480
    ds_read_b128 a[4:7], v11 offset:2048
    v_mfma_f32_16x16x32_bf16 v[76:79], a[132:135], a[100:103], v[76:79]
    buffer_load_dwordx4 v8, s[24:27], s47 offen offset:1024 nt lds
    v_mfma_f32_16x16x32_bf16 v[104:107], a[128:131], a[72:75], v[104:107]
    s_add_u32 s49, s47, 229376
    s_add_u32 m0, s53, 32768
    v_mfma_f32_16x16x32_bf16 v[104:107], a[132:135], a[104:107], v[104:107]
    buffer_load_dwordx4 v6, s[16:19], s46 offen offset:2048 lds
    v_mfma_f32_16x16x32_bf16 v[132:135], a[128:131], a[76:79], v[132:135]
    buffer_load_dwordx4 v7, s[16:19], s46 offen offset:3072 lds
    v_mfma_f32_16x16x32_bf16 v[132:135], a[132:135], a[108:111], v[132:135]
    ds_read_b128 a[36:39], v17 offset:2048
    v_mfma_f32_16x16x32_bf16 v[160:163], a[128:131], a[80:83], v[160:163]
    v_mfma_f32_16x16x32_bf16 v[160:163], a[132:135], a[112:115], v[160:163]
    v_mfma_f32_16x16x32_bf16 v[184:187], a[128:131], a[84:87], v[184:187]
    v_mfma_f32_16x16x32_bf16 v[184:187], a[132:135], a[116:119], v[184:187]
    v_mfma_f32_16x16x32_bf16 v[208:211], a[128:131], a[88:91], v[208:211]
    v_mfma_f32_16x16x32_bf16 v[208:211], a[132:135], a[120:123], v[208:211]
    v_mfma_f32_16x16x32_bf16 v[232:235], a[128:131], a[92:95], v[232:235]
    v_mfma_f32_16x16x32_bf16 v[232:235], a[132:135], a[124:127], v[232:235]
    s_waitcnt lgkmcnt(2)
    v_mfma_f32_16x16x32_bf16 v[52:55], a[136:139], a[64:67], v[52:55]
    ds_read_b64_tr_b16 a[128:129], v12 offset:41984
    ds_read_b64_tr_b16 a[130:131], v12 offset:42496
    v_mfma_f32_16x16x32_bf16 v[52:55], a[140:143], a[96:99], v[52:55]
    ds_read_b64_tr_b16 a[132:133], v14 offset:1024
    ds_read_b64_tr_b16 a[134:135], v14 offset:1536
    v_mfma_f32_16x16x32_bf16 v[80:83], a[136:139], a[68:71], v[80:83]
    s_add_u32 m0, s53, 40960
    s_add_u32 s46, s48, 131072
    v_mfma_f32_16x16x32_bf16 v[80:83], a[140:143], a[100:103], v[80:83]
    buffer_load_dwordx4 v4, s[16:19], s46 offen offset:0 lds
    v_mfma_f32_16x16x32_bf16 v[108:111], a[136:139], a[72:75], v[108:111]
    buffer_load_dwordx4 v5, s[16:19], s46 offen offset:1024 lds
    v_mfma_f32_16x16x32_bf16 v[108:111], a[140:143], a[104:107], v[108:111]
    buffer_load_dwordx4 v6, s[16:19], s46 offen offset:2048 lds
    v_mfma_f32_16x16x32_bf16 v[136:139], a[136:139], a[76:79], v[136:139]
    ds_read_b128 a[8:11], v11 offset:4096
    ds_read_b128 a[40:43], v17 offset:4096
    v_mfma_f32_16x16x32_bf16 v[136:139], a[140:143], a[108:111], v[136:139]
    v_mfma_f32_16x16x32_bf16 v[164:167], a[136:139], a[80:83], v[164:167]
    v_mfma_f32_16x16x32_bf16 v[164:167], a[140:143], a[112:115], v[164:167]
    v_mfma_f32_16x16x32_bf16 v[188:191], a[136:139], a[84:87], v[188:191]
    v_mfma_f32_16x16x32_bf16 v[188:191], a[140:143], a[116:119], v[188:191]
    v_mfma_f32_16x16x32_bf16 v[212:215], a[136:139], a[88:91], v[212:215]
    v_mfma_f32_16x16x32_bf16 v[212:215], a[140:143], a[120:123], v[212:215]
    v_mfma_f32_16x16x32_bf16 v[236:239], a[136:139], a[92:95], v[236:239]
    v_mfma_f32_16x16x32_bf16 v[236:239], a[140:143], a[124:127], v[236:239]
    s_waitcnt lgkmcnt(2)
    v_mfma_f32_16x16x32_bf16 v[56:59], a[128:131], a[64:67], v[56:59]
    ds_read_b64_tr_b16 a[136:137], v13 offset:41984
    ds_read_b64_tr_b16 a[138:139], v13 offset:42496
    v_mfma_f32_16x16x32_bf16 v[56:59], a[132:135], a[96:99], v[56:59]
    ds_read_b64_tr_b16 a[140:141], v15 offset:1024
    ds_read_b64_tr_b16 a[142:143], v15 offset:1536
    v_mfma_f32_16x16x32_bf16 v[84:87], a[128:131], a[68:71], v[84:87]
    s_add_u32 m0, s53, 40960
    ds_read_b128 a[12:15], v11 offset:6144
    v_mfma_f32_16x16x32_bf16 v[84:87], a[132:135], a[100:103], v[84:87]
    buffer_load_dwordx4 v7, s[16:19], s46 offen offset:3072 lds
    v_mfma_f32_16x16x32_bf16 v[112:115], a[128:131], a[72:75], v[112:115]
    s_add_u32 s48, s48, 128
    s_add_u32 m0, s54, 0
    v_mfma_f32_16x16x32_bf16 v[112:115], a[132:135], a[104:107], v[112:115]
    s_add_u32 s47, s50, s52
    ds_read_b128 a[44:47], v17 offset:6144
    v_mfma_f32_16x16x32_bf16 v[140:143], a[128:131], a[76:79], v[140:143]
    buffer_load_dwordx4 v9, s[28:31], s50 offen offset:2048 nt lds
    v_mfma_f32_16x16x32_bf16 v[140:143], a[132:135], a[108:111], v[140:143]
    s_add_u32 m0, s54, 20480
    v_mfma_f32_16x16x32_bf16 v[168:171], a[128:131], a[80:83], v[168:171]
    buffer_load_dwordx4 v9, s[28:31], s47 offen offset:2048 nt lds
    v_mfma_f32_16x16x32_bf16 v[168:171], a[132:135], a[112:115], v[168:171]
    v_mfma_f32_16x16x32_bf16 v[192:195], a[128:131], a[84:87], v[192:195]
    v_mfma_f32_16x16x32_bf16 v[192:195], a[132:135], a[116:119], v[192:195]
    v_mfma_f32_16x16x32_bf16 v[216:219], a[128:131], a[88:91], v[216:219]
    v_mfma_f32_16x16x32_bf16 v[216:219], a[132:135], a[120:123], v[216:219]
    v_mfma_f32_16x16x32_bf16 v[240:243], a[128:131], a[92:95], v[240:243]
    v_mfma_f32_16x16x32_bf16 v[240:243], a[132:135], a[124:127], v[240:243]
    s_waitcnt vmcnt(14) lgkmcnt(0)
    s_barrier
    v_mfma_f32_16x16x32_bf16 v[60:63], a[136:139], a[64:67], v[60:63]
    v_mfma_f32_16x16x32_bf16 v[60:63], a[140:143], a[96:99], v[60:63]
    ds_read_b64_tr_b16 a[128:129], v12 offset:43008
    ds_read_b64_tr_b16 a[130:131], v12 offset:43520
    v_mfma_f32_16x16x32_bf16 v[88:91], a[136:139], a[68:71], v[88:91]
    ds_read_b64_tr_b16 a[132:133], v14 offset:2048
    ds_read_b64_tr_b16 a[134:135], v14 offset:2560
    v_mfma_f32_16x16x32_bf16 v[88:91], a[140:143], a[100:103], v[88:91]
    s_add_u32 m0, s54, 45056
    s_add_u32 s47, s51, 196608
    v_mfma_f32_16x16x32_bf16 v[116:119], a[136:139], a[72:75], v[116:119]
    buffer_load_dwordx4 v10, s[36:39], s51 offen  nt lds
    v_mfma_f32_16x16x32_bf16 v[116:119], a[140:143], a[104:107], v[116:119]
    s_add_u32 m0, s54, 65536
    ds_read_b128 a[16:19], v11 offset:8192
    v_mfma_f32_16x16x32_bf16 v[144:147], a[136:139], a[76:79], v[144:147]
    buffer_load_dwordx4 v10, s[36:39], s47 offen  nt lds
    v_mfma_f32_16x16x32_bf16 v[144:147], a[140:143], a[108:111], v[144:147]
    s_add_u32 s51, s47, 196608
    v_mov_b32 v40, 1
    v_mfma_f32_16x16x32_bf16 v[172:175], a[136:139], a[80:83], v[172:175]
    v_mov_b32_e64 v41, 0
    ds_read_b128 a[48:51], v17 offset:8192
    v_mfma_f32_16x16x32_bf16 v[172:175], a[140:143], a[112:115], v[172:175]
    s_mov_b64 exec, 1
    buffer_store_dword v40, v41, s[4:7], s68 offen sc1
    s_mov_b64 exec, -1
    v_mfma_f32_16x16x32_bf16 v[196:199], a[136:139], a[84:87], v[196:199]
    v_mfma_f32_16x16x32_bf16 v[196:199], a[140:143], a[116:119], v[196:199]
    v_mfma_f32_16x16x32_bf16 v[220:223], a[136:139], a[88:91], v[220:223]
    v_mfma_f32_16x16x32_bf16 v[220:223], a[140:143], a[120:123], v[220:223]
    v_mfma_f32_16x16x32_bf16 v[244:247], a[136:139], a[92:95], v[244:247]
    v_mfma_f32_16x16x32_bf16 v[244:247], a[140:143], a[124:127], v[244:247]
    s_waitcnt lgkmcnt(2)
    v_mfma_f32_16x16x32_bf16 v[64:67], a[128:131], a[64:67], v[64:67]
    ds_read_b64_tr_b16 a[136:137], v13 offset:43008
    ds_read_b64_tr_b16 a[138:139], v13 offset:43520
    v_mfma_f32_16x16x32_bf16 v[64:67], a[132:135], a[96:99], v[64:67]
    ds_read_b64_tr_b16 a[140:141], v15 offset:2048
    ds_read_b64_tr_b16 a[142:143], v15 offset:2560
    v_mfma_f32_16x16x32_bf16 v[92:95], a[128:131], a[68:71], v[92:95]
    s_add_u32 m0, s54, 40960
    s_add_u32 s47, s49, 229376
    v_mfma_f32_16x16x32_bf16 v[92:95], a[132:135], a[100:103], v[92:95]
    buffer_load_dwordx4 v8, s[20:23], s49 offen offset:0 nt lds
    v_mfma_f32_16x16x32_bf16 v[120:123], a[128:131], a[72:75], v[120:123]
    s_add_u32 m0, s54, 61440
    ds_read_b128 a[20:23], v11 offset:10240
    v_mfma_f32_16x16x32_bf16 v[120:123], a[132:135], a[104:107], v[120:123]
    buffer_load_dwordx4 v8, s[20:23], s47 offen offset:0 nt lds
    v_mfma_f32_16x16x32_bf16 v[148:151], a[128:131], a[76:79], v[148:151]
    global_load_dword v1, v[32:33], off
    v_mfma_f32_16x16x32_bf16 v[148:151], a[132:135], a[108:111], v[148:151]
    s_and_b32 s8, s2, 1
    s_bfe_u32 s9, s2, 0x10001
    v_mfma_f32_16x16x32_bf16 v[176:179], a[128:131], a[80:83], v[176:179]
    s_lshl_b32 s72, s58, 1
    s_add_u32 s9, s9, s72
    v_mfma_f32_16x16x32_bf16 v[176:179], a[132:135], a[112:115], v[176:179]
    s_bfe_u32 s10, s2, 0x10002
    s_lshl_b32 s10, s10, 2
    v_mfma_f32_16x16x32_bf16 v[200:203], a[128:131], a[84:87], v[200:203]
    s_add_u32 s10, s10, s59
    s_lshl_b32 s11, s71, 12
    v_mfma_f32_16x16x32_bf16 v[200:203], a[132:135], a[116:119], v[200:203]
    s_lshl_b32 s74, s9, 13
    s_add_u32 s74, s74, s11
    v_mfma_f32_16x16x32_bf16 v[224:227], a[128:131], a[88:91], v[224:227]
    s_add_u32 s74, s74, 16775168
    s_lshl_b32 s75, s10, 13
    v_mfma_f32_16x16x32_bf16 v[224:227], a[132:135], a[120:123], v[224:227]
    s_add_u32 s75, s75, s11
    s_add_u32 s75, s75, 37748736
    v_mfma_f32_16x16x32_bf16 v[248:251], a[128:131], a[92:95], v[248:251]
    ds_read_b128 a[52:55], v17 offset:10240
    v_mfma_f32_16x16x32_bf16 v[248:251], a[132:135], a[124:127], v[248:251]
    s_waitcnt lgkmcnt(2)
    v_mfma_f32_16x16x32_bf16 v[68:71], a[136:139], a[64:67], v[68:71]
    ds_read_b64_tr_b16 a[128:129], v12 offset:44032
    ds_read_b64_tr_b16 a[130:131], v12 offset:44544
    v_mfma_f32_16x16x32_bf16 v[68:71], a[140:143], a[96:99], v[68:71]
    ds_read_b64_tr_b16 a[132:133], v14 offset:3072
    ds_read_b64_tr_b16 a[134:135], v14 offset:3584
    v_mfma_f32_16x16x32_bf16 v[96:99], a[136:139], a[68:71], v[96:99]
    s_add_u32 m0, s54, 40960
    s_add_u32 s47, s49, 229376
    v_mfma_f32_16x16x32_bf16 v[96:99], a[140:143], a[100:103], v[96:99]
    buffer_load_dwordx4 v8, s[24:27], s49 offen offset:1024 nt lds
    v_mfma_f32_16x16x32_bf16 v[124:127], a[136:139], a[72:75], v[124:127]
    s_add_u32 m0, s54, 61440
    ds_read_b128 a[24:27], v11 offset:12288
    v_mfma_f32_16x16x32_bf16 v[124:127], a[140:143], a[104:107], v[124:127]
    buffer_load_dwordx4 v8, s[24:27], s47 offen offset:1024 nt lds
    v_mfma_f32_16x16x32_bf16 v[152:155], a[136:139], a[76:79], v[152:155]
    s_add_u32 s49, s47, 229376
    s_mul_i32 s72, s8, 56
    v_mfma_f32_16x16x32_bf16 v[152:155], a[140:143], a[108:111], v[152:155]
    s_add_u32 s72, s72, s70
    s_add_u32 s72, s72, 32
    v_mfma_f32_16x16x32_bf16 v[180:183], a[136:139], a[80:83], v[180:183]
    s_mul_i32 s73, s8, 20
    s_add_u32 s73, s73, s70
    v_mfma_f32_16x16x32_bf16 v[180:183], a[140:143], a[112:115], v[180:183]
    s_lshl_b32 s40, s72, 17
    s_add_u32 s40, s40, s74
    v_mfma_f32_16x16x32_bf16 v[204:207], a[136:139], a[84:87], v[204:207]
    s_lshl_b32 s41, s72, 16
    s_add_u32 s41, s41, s75
    v_mfma_f32_16x16x32_bf16 v[204:207], a[140:143], a[116:119], v[204:207]
    s_lshl_b32 s42, s73, 17
    s_add_u32 s42, s42, s74
    v_mfma_f32_16x16x32_bf16 v[228:231], a[136:139], a[88:91], v[228:231]
    s_lshl_b32 s43, s73, 16
    s_add_u32 s43, s43, s75
    v_mfma_f32_16x16x32_bf16 v[228:231], a[140:143], a[120:123], v[228:231]
    s_lshl_b32 s44, s70, 14
    s_add_u32 s44, s44, s11
    v_mfma_f32_16x16x32_bf16 v[252:255], a[136:139], a[92:95], v[252:255]
    s_sub_u32 s44, s44, 1024
    s_mov_b32 s3, 0
    v_mfma_f32_16x16x32_bf16 v[252:255], a[140:143], a[124:127], v[252:255]
    ds_read_b128 a[56:59], v17 offset:12288
    s_waitcnt lgkmcnt(2)
    v_mfma_f32_16x16x32_bf16 v[72:75], a[128:131], a[64:67], v[72:75]
    ds_read_b64_tr_b16 a[136:137], v13 offset:44032
    ds_read_b64_tr_b16 a[138:139], v13 offset:44544
    v_mfma_f32_16x16x32_bf16 v[72:75], a[132:135], a[96:99], v[72:75]
    ds_read_b64_tr_b16 a[140:141], v15 offset:3072
    ds_read_b64_tr_b16 a[142:143], v15 offset:3584
    v_mfma_f32_16x16x32_bf16 v[100:103], a[128:131], a[68:71], v[100:103]
    s_add_u32 m0, s54, 0
    s_add_u32 s47, s50, s52
    v_mfma_f32_16x16x32_bf16 v[100:103], a[132:135], a[100:103], v[100:103]
    buffer_load_dwordx4 v9, s[32:35], s50 offen offset:3072 nt lds
    v_mfma_f32_16x16x32_bf16 v[128:131], a[128:131], a[72:75], v[128:131]
    s_add_u32 m0, s54, 20480
    ds_read_b128 a[28:31], v11 offset:14336
    v_mfma_f32_16x16x32_bf16 v[128:131], a[132:135], a[104:107], v[128:131]
    buffer_load_dwordx4 v9, s[32:35], s47 offen offset:3072 nt lds
    v_mfma_f32_16x16x32_bf16 v[156:159], a[128:131], a[76:79], v[156:159]
    s_add_u32 s50, s47, s52
    s_lshl_b32 s45, s58, 12
    v_mfma_f32_16x16x32_bf16 v[156:159], a[132:135], a[108:111], v[156:159]
    s_add_u32 s45, s45, 50462720
    s_mov_b32 s14, 50528256
    v_mfma_f32_16x16x32_bf16 a[192:195], a[128:131], a[80:83], a[192:195]
    s_lshl_b32 s76, s2, 14
    s_lshl_b32 s72, s56, 12
    v_mfma_f32_16x16x32_bf16 a[192:195], a[132:135], a[112:115], a[192:195]
    s_add_u32 s76, s76, s72
    s_add_u32 s76, s76, 51380224
    v_mfma_f32_16x16x32_bf16 a[208:211], a[128:131], a[84:87], a[208:211]
    s_lshl_b32 s96, s57, 2
    s_add_u32 s96, s96, s59
    v_mfma_f32_16x16x32_bf16 a[208:211], a[132:135], a[116:119], a[208:211]
    s_lshl_b32 s77, s96, 17
    s_lshl_b32 s73, s58, 14
    v_mfma_f32_16x16x32_bf16 a[224:227], a[128:131], a[88:91], a[224:227]
    s_add_u32 s77, s77, s73
    s_add_u32 s65, s77, s72
    v_mfma_f32_16x16x32_bf16 a[224:227], a[132:135], a[120:123], a[224:227]
    ds_read_b128 a[60:63], v17 offset:14336
    v_mfma_f32_16x16x32_bf16 a[240:243], a[128:131], a[92:95], a[240:243]
    v_mfma_f32_16x16x32_bf16 a[240:243], a[132:135], a[124:127], a[240:243]
    s_waitcnt vmcnt(12) lgkmcnt(0)
    s_barrier
    v_mfma_f32_16x16x32_bf16 a[144:147], a[136:139], a[64:67], a[144:147]
    v_mfma_f32_16x16x32_bf16 a[144:147], a[140:143], a[96:99], a[144:147]
    ds_read_b64_tr_b16 a[128:129], v12 offset:4096
    ds_read_b64_tr_b16 a[130:131], v12 offset:4608
    v_mfma_f32_16x16x32_bf16 a[156:159], a[136:139], a[68:71], a[156:159]
    ds_read_b64_tr_b16 a[132:133], v12 offset:24576
    ds_read_b64_tr_b16 a[134:135], v12 offset:25088
    v_mfma_f32_16x16x32_bf16 a[156:159], a[140:143], a[100:103], a[156:159]
    s_add_u32 m0, s54, 40960
    s_add_u32 s47, s50, s52
    v_mfma_f32_16x16x32_bf16 a[168:171], a[136:139], a[72:75], a[168:171]
    buffer_load_dwordx4 v9, s[28:31], s50 offen offset:2048 nt lds
    v_mfma_f32_16x16x32_bf16 a[168:171], a[140:143], a[104:107], a[168:171]
    s_add_u32 m0, s54, 61440
    v_mfma_f32_16x16x32_bf16 a[180:183], a[136:139], a[76:79], a[180:183]
    buffer_load_dwordx4 v9, s[28:31], s47 offen offset:2048 nt lds
    v_mfma_f32_16x16x32_bf16 a[180:183], a[140:143], a[108:111], a[180:183]
    v_and_b32 v3, 15, v2
    s_lshl_b32 s72, s70, 7
    v_mfma_f32_16x16x32_bf16 a[196:199], a[136:139], a[80:83], a[196:199]
    s_add_u32 s72, s72, s64
    s_lshl_b32 s72, s72, 6
    v_mfma_f32_16x16x32_bf16 a[196:199], a[140:143], a[112:115], a[196:199]
    v_lshlrev_b32 v3, 4, v3
    v_add_u32_e64 v3, s72, v3
    v_mfma_f32_16x16x32_bf16 a[212:215], a[136:139], a[84:87], a[212:215]
    v_bfe_u32 v4, v2, 4, 1
    v_lshlrev_b32_e64 v4, 9, v4
    v_mfma_f32_16x16x32_bf16 a[212:215], a[140:143], a[116:119], a[212:215]
    v_bfe_u32 v5, v2, 5, 1
    v_lshl_add_u32 v4, v5, 8, v4
    v_mfma_f32_16x16x32_bf16 a[228:231], a[136:139], a[88:91], a[228:231]
    v_add_u32 v4, v3, v4
    s_lshl_b32 s72, s71, 17
    v_mfma_f32_16x16x32_bf16 a[228:231], a[140:143], a[120:123], a[228:231]
    v_add_u32_e64 v5, s72, v4
    v_add_u32 v6, 4096, v5
    v_mfma_f32_16x16x32_bf16 a[244:247], a[136:139], a[92:95], a[244:247]
    v_mfma_f32_16x16x32_bf16 a[244:247], a[140:143], a[124:127], a[244:247]
    s_waitcnt lgkmcnt(0)
    v_mfma_f32_16x16x32_bf16 a[148:151], a[128:131], a[0:3], a[148:151]
    ds_read_b64_tr_b16 a[136:137], v13 offset:4096
    ds_read_b64_tr_b16 a[138:139], v13 offset:4608
    v_mfma_f32_16x16x32_bf16 a[148:151], a[132:135], a[32:35], a[148:151]
    ds_read_b64_tr_b16 a[140:141], v13 offset:24576
    ds_read_b64_tr_b16 a[142:143], v13 offset:25088
    v_mfma_f32_16x16x32_bf16 a[160:163], a[128:131], a[4:7], a[160:163]
    ds_read_b128 a[64:67], v11 offset:32768
    v_mfma_f32_16x16x32_bf16 a[160:163], a[132:135], a[36:39], a[160:163]
    ds_read_b128 a[96:99], v17 offset:32768
    v_mfma_f32_16x16x32_bf16 a[172:175], a[128:131], a[8:11], a[172:175]
    ds_read_b128 a[68:71], v11 offset:34816
    v_mfma_f32_16x16x32_bf16 a[172:175], a[132:135], a[40:43], a[172:175]
    ds_read_b128 a[100:103], v17 offset:34816
    v_mfma_f32_16x16x32_bf16 a[184:187], a[128:131], a[12:15], a[184:187]
    ds_read_b128 a[72:75], v11 offset:36864
    v_mfma_f32_16x16x32_bf16 a[184:187], a[132:135], a[44:47], a[184:187]
    ds_read_b128 a[104:107], v17 offset:36864
    v_mfma_f32_16x16x32_bf16 a[200:203], a[128:131], a[16:19], a[200:203]
    ds_read_b128 a[76:79], v11 offset:38912
    v_mfma_f32_16x16x32_bf16 a[200:203], a[132:135], a[48:51], a[200:203]
    ds_read_b128 a[108:111], v17 offset:38912
    s_add_u32 m0, s54, 40960
    v_mfma_f32_16x16x32_bf16 a[216:219], a[128:131], a[20:23], a[216:219]
    s_add_u32 s47, s50, s52
    v_mfma_f32_16x16x32_bf16 a[216:219], a[132:135], a[52:55], a[216:219]
    buffer_load_dwordx4 v9, s[32:35], s50 offen offset:3072 nt lds
    v_mfma_f32_16x16x32_bf16 a[232:235], a[128:131], a[24:27], a[232:235]
    s_add_u32 m0, s54, 61440
    v_mfma_f32_16x16x32_bf16 a[232:235], a[132:135], a[56:59], a[232:235]
    buffer_load_dwordx4 v9, s[32:35], s47 offen offset:3072 nt lds
    v_mfma_f32_16x16x32_bf16 a[248:251], a[128:131], a[28:31], a[248:251]
    s_add_u32 s50, s47, s52
    v_mfma_f32_16x16x32_bf16 a[248:251], a[132:135], a[60:63], a[248:251]
    s_waitcnt vmcnt(12) lgkmcnt(8)
    s_barrier
    v_mfma_f32_16x16x32_bf16 a[152:155], a[136:139], a[0:3], a[152:155]
    ds_read_b64_tr_b16 a[128:129], v12 offset:45056
    ds_read_b64_tr_b16 a[130:131], v12 offset:45568
    v_mfma_f32_16x16x32_bf16 a[152:155], a[140:143], a[32:35], a[152:155]
    ds_read_b64_tr_b16 a[132:133], v14 offset:4096
    ds_read_b64_tr_b16 a[134:135], v14 offset:4608
    v_mfma_f32_16x16x32_bf16 a[164:167], a[136:139], a[4:7], a[164:167]
    ds_read_b128 a[80:83], v11 offset:40960
    v_mfma_f32_16x16x32_bf16 a[164:167], a[140:143], a[36:39], a[164:167]
    ds_read_b128 a[112:115], v17 offset:40960
    v_mfma_f32_16x16x32_bf16 a[176:179], a[136:139], a[8:11], a[176:179]
    ds_read_b128 a[84:87], v11 offset:43008
    v_mfma_f32_16x16x32_bf16 a[176:179], a[140:143], a[40:43], a[176:179]
    ds_read_b128 a[116:119], v17 offset:43008
    v_mfma_f32_16x16x32_bf16 a[188:191], a[136:139], a[12:15], a[188:191]
    ds_read_b128 a[88:91], v11 offset:45056
    v_mfma_f32_16x16x32_bf16 a[188:191], a[140:143], a[44:47], a[188:191]
    ds_read_b128 a[120:123], v17 offset:45056
    v_mfma_f32_16x16x32_bf16 a[204:207], a[136:139], a[16:19], a[204:207]
    ds_read_b128 a[92:95], v11 offset:47104
    v_mfma_f32_16x16x32_bf16 a[204:207], a[140:143], a[48:51], a[204:207]
    ds_read_b128 a[124:127], v17 offset:47104
    v_mfma_f32_16x16x32_bf16 a[220:223], a[136:139], a[20:23], a[220:223]
    s_lshl_b32 s48, s60, 18
    s_add_u32 s48, s48, 20971520
    v_mfma_f32_16x16x32_bf16 a[220:223], a[140:143], a[52:55], a[220:223]
    s_add_u32 s49, s48, 262144
    s_lshl_b32 s50, s61, 18
    v_mfma_f32_16x16x32_bf16 a[236:239], a[136:139], a[24:27], a[236:239]
    s_lshl_b32 s51, s98, 18
    s_lshl_b32 s52, s99, 18
    v_mfma_f32_16x16x32_bf16 a[236:239], a[140:143], a[56:59], a[236:239]
    s_mov_b32 s46, 0xbfb8aa3b
    s_mov_b32 s47, 0xbfb8aa3b
    v_mfma_f32_16x16x32_bf16 a[252:255], a[136:139], a[28:31], a[252:255]
    v_mfma_f32_16x16x32_bf16 a[252:255], a[140:143], a[60:63], a[252:255]
    global_load_dword v1, v[32:33], off
    s_waitcnt lgkmcnt(0)
    v_mfma_f32_16x16x32_bf16 a[148:151], a[128:131], a[64:67], a[148:151]
    ds_read_b64_tr_b16 a[136:137], v13 offset:45056
    ds_read_b64_tr_b16 a[138:139], v13 offset:45568
    v_mfma_f32_16x16x32_bf16 a[148:151], a[132:135], a[96:99], a[148:151]
    ds_read_b64_tr_b16 a[140:141], v15 offset:4096
    ds_read_b64_tr_b16 a[142:143], v15 offset:4608
    v_mfma_f32_16x16x32_bf16 a[160:163], a[128:131], a[68:71], a[160:163]
    s_lshl_b32 s53, s56, 13
    s_add_u32 s54, s77, s53
    v_mfma_f32_16x16x32_bf16 a[160:163], a[132:135], a[100:103], a[160:163]
    s_add_u32 s54, s54, 4177920
    s_or_b32 s72, s70, s58
    v_mfma_f32_16x16x32_bf16 a[172:175], a[128:131], a[72:75], a[172:175]
    s_cmp_eq_u32 s72, 0
    s_cselect_b32 s72, 16384, 0
    s_add_u32 s54, s54, s72
    v_mfma_f32_16x16x32_bf16 a[172:175], a[132:135], a[104:107], a[172:175]
    s_add_u32 s55, s54, 4194304
    s_lshl_b32 s69, s58, 10
    v_mfma_f32_16x16x32_bf16 a[184:187], a[128:131], a[76:79], a[184:187]
    s_lshl_b32 s72, s56, 8
    s_add_u32 s69, s69, s72
    v_mfma_f32_16x16x32_bf16 a[184:187], a[132:135], a[108:111], a[184:187]
    s_add_u32 s69, s69, 50331648
    v_lshrrev_b32 v10, 5, v2
    v_mfma_f32_16x16x32_bf16 a[200:203], a[128:131], a[80:83], a[200:203]
    v_lshrrev_b32 v17, 4, v2
    v_lshlrev_b32 v18, 2, v17
    v_mfma_f32_16x16x32_bf16 a[200:203], a[132:135], a[112:115], a[200:203]
    v_sub_u32 v18, v2, v18
    v_and_b32 v18, 15, v18
    v_mfma_f32_16x16x32_bf16 a[216:219], a[128:131], a[84:87], a[216:219]
    v_lshlrev_b32 v18, 4, v18
    v_lshl_add_u32 v17, v17, 8, v18
    v_mfma_f32_16x16x32_bf16 a[216:219], a[132:135], a[116:119], a[216:219]
    v_and_b32 v18, 15, v2
    v_lshlrev_b32 v18, 4, v18
    v_mfma_f32_16x16x32_bf16 a[232:235], a[128:131], a[88:91], a[232:235]
    v_lshl_add_u32 v18, v10, 8, v18
    v_bfe_u32 v11, v2, 4, 1
    v_mfma_f32_16x16x32_bf16 a[232:235], a[132:135], a[120:123], a[232:235]
    v_lshl_add_u32 v18, v11, 10, v18
    v_and_b32 v16, 31, v2
    v_mfma_f32_16x16x32_bf16 a[248:251], a[128:131], a[92:95], a[248:251]
    v_lshlrev_b32 v16, 2, v16
    v_lshlrev_b32 v9, 2, v2
    v_mfma_f32_16x16x32_bf16 a[248:251], a[132:135], a[124:127], a[248:251]
    s_lshr_b32 s72, s96, 1
    s_lshl_b32 s72, s72, 10
    s_waitcnt lgkmcnt(0)
    v_mfma_f32_16x16x32_bf16 a[152:155], a[136:139], a[64:67], a[152:155]
    ds_read_b64_tr_b16 a[128:129], v12 offset:0
    ds_read_b64_tr_b16 a[130:131], v12 offset:512
    v_mfma_f32_16x16x32_bf16 a[152:155], a[140:143], a[96:99], a[152:155]
    ds_read_b64_tr_b16 a[132:133], v12 offset:20480
    ds_read_b64_tr_b16 a[134:135], v12 offset:20992
    v_mfma_f32_16x16x32_bf16 a[164:167], a[136:139], a[68:71], a[164:167]
    s_add_u32 s72, s72, 50397184
    s_lshl_b32 s73, s58, 7
    v_mfma_f32_16x16x32_bf16 a[164:167], a[140:143], a[100:103], a[164:167]
    s_add_u32 s73, s73, s72
    s_max_u32 s74, s58, 1
    v_mfma_f32_16x16x32_bf16 a[176:179], a[136:139], a[72:75], a[176:179]
    s_lshl_b32 s74, s74, 7
    s_add_u32 s74, s74, s72
    v_mfma_f32_16x16x32_bf16 a[176:179], a[140:143], a[104:107], a[176:179]
    s_add_u32 s74, s74, 16256
    v_and_b32 v11, 3, v2
    v_mfma_f32_16x16x32_bf16 a[188:191], a[136:139], a[76:79], a[188:191]
    v_lshlrev_b32 v11, 2, v11
    v_add_u32 v7, s74, v11
    v_mfma_f32_16x16x32_bf16 a[188:191], a[140:143], a[108:111], a[188:191]
    v_add_u32 v8, 16384, v7
    v_add_u32 v11, s73, v11
    v_mfma_f32_16x16x32_bf16 a[204:207], a[136:139], a[80:83], a[204:207]
    s_mov_b64 exec, 15
    v_mov_b32_e64 v7, v11
    v_add_u32 v8, 32768, v11
    s_mov_b64 exec, 0xf0
    v_add_u32 v7, 16384, v11
    s_mov_b64 exec, -1
    v_mfma_f32_16x16x32_bf16 a[204:207], a[140:143], a[112:115], a[204:207]
    v_mfma_f32_16x16x32_bf16 a[220:223], a[136:139], a[84:87], a[220:223]
    v_accvgpr_read_b32 v24, a148
    v_accvgpr_read_b32 v25, a149
    v_accvgpr_read_b32 v26, a150
    v_mfma_f32_16x16x32_bf16 a[220:223], a[140:143], a[116:119], a[220:223]
    v_accvgpr_read_b32 v27, a151
    v_cvt_pk_bf16_f32 v36, v24, v25
    v_mfma_f32_16x16x32_bf16 a[236:239], a[136:139], a[88:91], a[236:239]
    v_cvt_pk_bf16_f32 v37, v26, v27
    v_accvgpr_read_b32 v28, a152
    v_mfma_f32_16x16x32_bf16 a[236:239], a[140:143], a[120:123], a[236:239]
    v_accvgpr_read_b32 v29, a153
    v_accvgpr_read_b32 v30, a154
    v_mfma_f32_16x16x32_bf16 a[252:255], a[136:139], a[92:95], a[252:255]
    v_accvgpr_read_b32 v31, a155
    v_cvt_pk_bf16_f32 v38, v28, v29
    v_mfma_f32_16x16x32_bf16 a[252:255], a[140:143], a[124:127], a[252:255]
    v_cvt_pk_bf16_f32 v39, v30, v31
    v_accvgpr_read_b32 v24, a160
    s_waitcnt vmcnt(7) lgkmcnt(0)
    s_barrier
    v_mfma_f32_16x16x32_bf16 v[48:51], a[128:131], a[0:3], v[48:51]
    ds_read_b64_tr_b16 a[136:137], v12 offset:40960
    ds_read_b64_tr_b16 a[138:139], v12 offset:41472
    v_mfma_f32_16x16x32_bf16 v[48:51], a[132:135], a[32:35], v[48:51]
    ds_read_b64_tr_b16 a[140:141], v14 offset:0
    ds_read_b64_tr_b16 a[142:143], v14 offset:512
    v_mfma_f32_16x16x32_bf16 v[76:79], a[128:131], a[4:7], v[76:79]
    v_accvgpr_read_b32 v25, a161
    v_permlane16_swap_b32 v36, v38
    v_mfma_f32_16x16x32_bf16 v[76:79], a[132:135], a[36:39], v[76:79]
    v_permlane16_swap_b32_e64 v37, v39
    v_mfma_f32_16x16x32_bf16 v[104:107], a[128:131], a[8:11], v[104:107]
    buffer_store_dwordx4 v[36:39], v5, s[4:7], s50 offen offset:0 sc1
    v_accvgpr_read_b32 v26, a162
    v_mfma_f32_16x16x32_bf16 v[104:107], a[132:135], a[40:43], v[104:107]
    v_accvgpr_read_b32 v27, a163
    v_cvt_pk_bf16_f32 v32, v24, v25
    v_mfma_f32_16x16x32_bf16 v[132:135], a[128:131], a[12:15], v[132:135]
    v_cvt_pk_bf16_f32 v33, v26, v27
    v_accvgpr_read_b32 v28, a164
    v_mfma_f32_16x16x32_bf16 v[132:135], a[132:135], a[44:47], v[132:135]
    v_accvgpr_read_b32 v29, a165
    v_accvgpr_read_b32 v30, a166
    v_mfma_f32_16x16x32_bf16 v[160:163], a[128:131], a[16:19], v[160:163]
    v_accvgpr_read_b32 v31, a167
    v_cvt_pk_bf16_f32 v34, v28, v29
    v_mfma_f32_16x16x32_bf16 v[160:163], a[132:135], a[48:51], v[160:163]
    v_cvt_pk_bf16_f32 v35, v30, v31
    v_accvgpr_read_b32 v24, a172
    v_mfma_f32_16x16x32_bf16 v[184:187], a[128:131], a[20:23], v[184:187]
    v_accvgpr_read_b32 v25, a173
    v_permlane16_swap_b32 v32, v34
    v_mfma_f32_16x16x32_bf16 v[184:187], a[132:135], a[52:55], v[184:187]
    v_permlane16_swap_b32 v33, v35
    v_mfma_f32_16x16x32_bf16 v[208:211], a[128:131], a[24:27], v[208:211]
    buffer_store_dwordx4 v[32:35], v5, s[4:7], s50 offen offset:1024 sc1
    v_accvgpr_read_b32 v26, a174
    v_mfma_f32_16x16x32_bf16 v[208:211], a[132:135], a[56:59], v[208:211]
    v_accvgpr_read_b32 v27, a175
    v_cvt_pk_bf16_f32 v36, v24, v25
    v_mfma_f32_16x16x32_bf16 v[232:235], a[128:131], a[28:31], v[232:235]
    v_cvt_pk_bf16_f32 v37, v26, v27
    v_accvgpr_read_b32 v28, a176
    v_mfma_f32_16x16x32_bf16 v[232:235], a[132:135], a[60:63], v[232:235]
    v_accvgpr_read_b32 v29, a177
    v_accvgpr_read_b32 v30, a178
    s_waitcnt lgkmcnt(0)
    v_mfma_f32_16x16x32_bf16 v[48:51], a[136:139], a[64:67], v[48:51]
    ds_read_b64_tr_b16 a[128:129], v12 offset:1024
    ds_read_b64_tr_b16 a[130:131], v12 offset:1536
    v_mfma_f32_16x16x32_bf16 v[48:51], a[140:143], a[96:99], v[48:51]
    ds_read_b64_tr_b16 a[132:133], v12 offset:21504
    ds_read_b64_tr_b16 a[134:135], v12 offset:22016
    v_mfma_f32_16x16x32_bf16 v[76:79], a[136:139], a[68:71], v[76:79]
    v_accvgpr_read_b32 v31, a179
    v_cvt_pk_bf16_f32 v38, v28, v29
    v_mfma_f32_16x16x32_bf16 v[76:79], a[140:143], a[100:103], v[76:79]
    v_cvt_pk_bf16_f32 v39, v30, v31
    v_accvgpr_read_b32 v24, a184
    v_mfma_f32_16x16x32_bf16 v[104:107], a[136:139], a[72:75], v[104:107]
    v_accvgpr_read_b32 v25, a185
    v_permlane16_swap_b32 v36, v38
    v_mfma_f32_16x16x32_bf16 v[104:107], a[140:143], a[104:107], v[104:107]
    v_permlane16_swap_b32_e64 v37, v39
    v_mfma_f32_16x16x32_bf16 v[132:135], a[136:139], a[76:79], v[132:135]
    buffer_store_dwordx4 v[36:39], v5, s[4:7], s50 offen offset:2048 sc1
    v_accvgpr_read_b32 v26, a186
    v_mfma_f32_16x16x32_bf16 v[132:135], a[140:143], a[108:111], v[132:135]
    v_accvgpr_read_b32 v27, a187
    v_cvt_pk_bf16_f32 v32, v24, v25
    v_mfma_f32_16x16x32_bf16 v[160:163], a[136:139], a[80:83], v[160:163]
    v_cvt_pk_bf16_f32 v33, v26, v27
    v_accvgpr_read_b32 v28, a188
    v_mfma_f32_16x16x32_bf16 v[160:163], a[140:143], a[112:115], v[160:163]
    v_accvgpr_read_b32 v29, a189
    v_accvgpr_read_b32 v30, a190
    v_mfma_f32_16x16x32_bf16 v[184:187], a[136:139], a[84:87], v[184:187]
    v_accvgpr_read_b32 v31, a191
    v_cvt_pk_bf16_f32 v34, v28, v29
    v_mfma_f32_16x16x32_bf16 v[184:187], a[140:143], a[116:119], v[184:187]
    v_cvt_pk_bf16_f32 v35, v30, v31
    v_accvgpr_read_b32 v24, a200
    v_mfma_f32_16x16x32_bf16 v[208:211], a[136:139], a[88:91], v[208:211]
    v_accvgpr_read_b32 v25, a201
    v_permlane16_swap_b32 v32, v34
    v_mfma_f32_16x16x32_bf16 v[208:211], a[140:143], a[120:123], v[208:211]
    v_permlane16_swap_b32 v33, v35
    v_mfma_f32_16x16x32_bf16 v[232:235], a[136:139], a[92:95], v[232:235]
    buffer_store_dwordx4 v[32:35], v5, s[4:7], s50 offen offset:3072 sc1
    v_accvgpr_read_b32 v26, a202
    v_mfma_f32_16x16x32_bf16 v[232:235], a[140:143], a[124:127], v[232:235]
    v_accvgpr_read_b32 v27, a203
    v_cvt_pk_bf16_f32 v36, v24, v25
    s_waitcnt lgkmcnt(0)
    v_mfma_f32_16x16x32_bf16 v[56:59], a[128:131], a[0:3], v[56:59]
    ds_read_b64_tr_b16 a[136:137], v12 offset:41984
    ds_read_b64_tr_b16 a[138:139], v12 offset:42496
    v_mfma_f32_16x16x32_bf16 v[56:59], a[132:135], a[32:35], v[56:59]
    ds_read_b64_tr_b16 a[140:141], v14 offset:1024
    ds_read_b64_tr_b16 a[142:143], v14 offset:1536
    v_mfma_f32_16x16x32_bf16 v[84:87], a[128:131], a[4:7], v[84:87]
    v_cvt_pk_bf16_f32 v37, v26, v27
    v_accvgpr_read_b32 v28, a204
    v_mfma_f32_16x16x32_bf16 v[84:87], a[132:135], a[36:39], v[84:87]
    v_accvgpr_read_b32 v29, a205
    v_accvgpr_read_b32 v30, a206
    v_mfma_f32_16x16x32_bf16 v[112:115], a[128:131], a[8:11], v[112:115]
    v_accvgpr_read_b32 v31, a207
    v_cvt_pk_bf16_f32 v38, v28, v29
    v_mfma_f32_16x16x32_bf16 v[112:115], a[132:135], a[40:43], v[112:115]
    v_cvt_pk_bf16_f32 v39, v30, v31
    v_accvgpr_read_b32 v24, a216
    v_mfma_f32_16x16x32_bf16 v[140:143], a[128:131], a[12:15], v[140:143]
    v_accvgpr_read_b32 v25, a217
    v_permlane16_swap_b32 v36, v38
    v_mfma_f32_16x16x32_bf16 v[140:143], a[132:135], a[44:47], v[140:143]
    v_permlane16_swap_b32_e64 v37, v39
    v_mfma_f32_16x16x32_bf16 v[168:171], a[128:131], a[16:19], v[168:171]
    buffer_store_dwordx4 v[36:39], v6, s[4:7], s50 offen offset:0 sc1
    v_accvgpr_read_b32 v26, a218
    v_mfma_f32_16x16x32_bf16 v[168:171], a[132:135], a[48:51], v[168:171]
    v_accvgpr_read_b32 v27, a219
    v_cvt_pk_bf16_f32 v32, v24, v25
    v_mfma_f32_16x16x32_bf16 v[192:195], a[128:131], a[20:23], v[192:195]
    v_cvt_pk_bf16_f32 v33, v26, v27
    v_accvgpr_read_b32 v28, a220
    v_mfma_f32_16x16x32_bf16 v[192:195], a[132:135], a[52:55], v[192:195]
    v_accvgpr_read_b32 v29, a221
    v_accvgpr_read_b32 v30, a222
    v_mfma_f32_16x16x32_bf16 v[216:219], a[128:131], a[24:27], v[216:219]
    v_accvgpr_read_b32 v31, a223
    v_cvt_pk_bf16_f32 v34, v28, v29
    v_mfma_f32_16x16x32_bf16 v[216:219], a[132:135], a[56:59], v[216:219]
    v_cvt_pk_bf16_f32 v35, v30, v31
    v_accvgpr_read_b32 v24, a232
    v_mfma_f32_16x16x32_bf16 v[240:243], a[128:131], a[28:31], v[240:243]
    v_accvgpr_read_b32 v25, a233
    v_permlane16_swap_b32 v32, v34
    v_mfma_f32_16x16x32_bf16 v[240:243], a[132:135], a[60:63], v[240:243]
    v_permlane16_swap_b32 v33, v35
    s_waitcnt lgkmcnt(0)
    v_mfma_f32_16x16x32_bf16 v[56:59], a[136:139], a[64:67], v[56:59]
    ds_read_b64_tr_b16 a[128:129], v13 offset:0
    ds_read_b64_tr_b16 a[130:131], v13 offset:512
    v_mfma_f32_16x16x32_bf16 v[56:59], a[140:143], a[96:99], v[56:59]
    ds_read_b64_tr_b16 a[132:133], v13 offset:20480
    ds_read_b64_tr_b16 a[134:135], v13 offset:20992
    v_mfma_f32_16x16x32_bf16 v[84:87], a[136:139], a[68:71], v[84:87]
    buffer_store_dwordx4 v[32:35], v6, s[4:7], s50 offen offset:1024 sc1
    v_accvgpr_read_b32 v26, a234
    v_mfma_f32_16x16x32_bf16 v[84:87], a[140:143], a[100:103], v[84:87]
    v_accvgpr_read_b32 v27, a235
    v_cvt_pk_bf16_f32 v36, v24, v25
    v_mfma_f32_16x16x32_bf16 v[112:115], a[136:139], a[72:75], v[112:115]
    v_cvt_pk_bf16_f32 v37, v26, v27
    v_accvgpr_read_b32 v28, a236
    v_mfma_f32_16x16x32_bf16 v[112:115], a[140:143], a[104:107], v[112:115]
    v_accvgpr_read_b32 v29, a237
    v_accvgpr_read_b32 v30, a238
    v_mfma_f32_16x16x32_bf16 v[140:143], a[136:139], a[76:79], v[140:143]
    v_accvgpr_read_b32 v31, a239
    v_cvt_pk_bf16_f32 v38, v28, v29
    v_mfma_f32_16x16x32_bf16 v[140:143], a[140:143], a[108:111], v[140:143]
    v_cvt_pk_bf16_f32 v39, v30, v31
    v_accvgpr_read_b32 v24, a248
    v_mfma_f32_16x16x32_bf16 v[168:171], a[136:139], a[80:83], v[168:171]
    v_accvgpr_read_b32 v25, a249
    v_permlane16_swap_b32 v36, v38
    v_mfma_f32_16x16x32_bf16 v[168:171], a[140:143], a[112:115], v[168:171]
    v_permlane16_swap_b32_e64 v37, v39
    v_mfma_f32_16x16x32_bf16 v[192:195], a[136:139], a[84:87], v[192:195]
    buffer_store_dwordx4 v[36:39], v6, s[4:7], s50 offen offset:2048 sc1
    v_accvgpr_read_b32 v26, a250
    v_mfma_f32_16x16x32_bf16 v[192:195], a[140:143], a[116:119], v[192:195]
    v_accvgpr_read_b32 v27, a251
    v_cvt_pk_bf16_f32 v32, v24, v25
    v_mfma_f32_16x16x32_bf16 v[216:219], a[136:139], a[88:91], v[216:219]
    v_cvt_pk_bf16_f32 v33, v26, v27
    v_accvgpr_read_b32 v28, a252
    v_mfma_f32_16x16x32_bf16 v[216:219], a[140:143], a[120:123], v[216:219]
    v_accvgpr_read_b32 v29, a253
    v_accvgpr_read_b32 v30, a254
    v_mfma_f32_16x16x32_bf16 v[240:243], a[136:139], a[92:95], v[240:243]
    v_accvgpr_read_b32 v31, a255
    v_cvt_pk_bf16_f32 v34, v28, v29
    v_mfma_f32_16x16x32_bf16 v[240:243], a[140:143], a[124:127], v[240:243]
    v_cvt_pk_bf16_f32 v35, v30, v31
    v_mul_f32 v20, s46, v48
    s_waitcnt lgkmcnt(0)
    v_mfma_f32_16x16x32_bf16 v[52:55], a[128:131], a[0:3], v[52:55]
    ds_read_b64_tr_b16 a[136:137], v13 offset:40960
    ds_read_b64_tr_b16 a[138:139], v13 offset:41472
    v_mfma_f32_16x16x32_bf16 v[52:55], a[132:135], a[32:35], v[52:55]
    ds_read_b64_tr_b16 a[140:141], v15 offset:0
    ds_read_b64_tr_b16 a[142:143], v15 offset:512
    v_mfma_f32_16x16x32_bf16 v[80:83], a[128:131], a[4:7], v[80:83]
    v_mul_f32 v21, s46, v49
    v_permlane16_swap_b32 v32, v34
    v_mfma_f32_16x16x32_bf16 v[80:83], a[132:135], a[36:39], v[80:83]
    v_permlane16_swap_b32_e64 v33, v35
    v_mfma_f32_16x16x32_bf16 v[108:111], a[128:131], a[8:11], v[108:111]
    buffer_store_dwordx4 v[32:35], v6, s[4:7], s50 offen offset:3072 sc1
    v_mul_f32 v22, s46, v50
    v_mfma_f32_16x16x32_bf16 v[108:111], a[132:135], a[40:43], v[108:111]
    v_mul_f32 v23, s46, v51
    v_mfma_f32_16x16x32_bf16 v[136:139], a[128:131], a[12:15], v[136:139]
    v_exp_f32 v20, v20
    v_mfma_f32_16x16x32_bf16 v[136:139], a[132:135], a[44:47], v[136:139]
    v_exp_f32 v21, v21
    v_mfma_f32_16x16x32_bf16 v[164:167], a[128:131], a[16:19], v[164:167]
    v_exp_f32 v22, v22
    v_mfma_f32_16x16x32_bf16 v[164:167], a[132:135], a[48:51], v[164:167]
    v_exp_f32 v23, v23
    v_mul_f32 v48, v48, v56
    v_mfma_f32_16x16x32_bf16 v[188:191], a[128:131], a[20:23], v[188:191]
    v_mul_f32 v49, v49, v57
    v_add_f32 v20, 1.0, v20
    v_mfma_f32_16x16x32_bf16 v[188:191], a[132:135], a[52:55], v[188:191]
    v_add_f32 v21, 1.0, v21
    v_add_f32 v22, 1.0, v22
    v_mfma_f32_16x16x32_bf16 v[212:215], a[128:131], a[24:27], v[212:215]
    v_add_f32 v23, 1.0, v23
    v_mfma_f32_16x16x32_bf16 v[212:215], a[132:135], a[56:59], v[212:215]
    v_rcp_f32 v20, v20
    v_mfma_f32_16x16x32_bf16 v[236:239], a[128:131], a[28:31], v[236:239]
    v_rcp_f32 v21, v21
    v_mfma_f32_16x16x32_bf16 v[236:239], a[132:135], a[60:63], v[236:239]
    v_rcp_f32 v22, v22
    s_waitcnt lgkmcnt(0)
    v_mfma_f32_16x16x32_bf16 v[52:55], a[136:139], a[64:67], v[52:55]
    ds_read_b64_tr_b16 a[128:129], v13 offset:1024
    ds_read_b64_tr_b16 a[130:131], v13 offset:1536
    v_mfma_f32_16x16x32_bf16 v[52:55], a[140:143], a[96:99], v[52:55]
    ds_read_b64_tr_b16 a[132:133], v13 offset:21504
    ds_read_b64_tr_b16 a[134:135], v13 offset:22016
    v_mfma_f32_16x16x32_bf16 v[80:83], a[136:139], a[68:71], v[80:83]
    v_rcp_f32 v23, v23
    v_mul_f32 v50, v50, v58
    v_mfma_f32_16x16x32_bf16 v[80:83], a[140:143], a[100:103], v[80:83]
    v_mul_f32 v51, v51, v59
    v_mul_f32 v20, v20, v48
    v_mfma_f32_16x16x32_bf16 v[108:111], a[136:139], a[72:75], v[108:111]
    v_mul_f32 v21, v21, v49
    v_mul_f32 v22, v22, v50
    v_mfma_f32_16x16x32_bf16 v[108:111], a[140:143], a[104:107], v[108:111]
    v_mul_f32_e64 v23, v23, v51
    v_cvt_pk_bf16_f32 v48, v20, v21
    v_mfma_f32_16x16x32_bf16 v[136:139], a[136:139], a[76:79], v[136:139]
    v_cvt_pk_bf16_f32 v49, v22, v23
    v_mfma_f32_16x16x32_bf16 v[136:139], a[140:143], a[108:111], v[136:139]
    global_load_dword v45, v9, s[100:101] sc1
    v_mul_f32 v20, s46, v76
    v_mfma_f32_16x16x32_bf16 v[164:167], a[136:139], a[80:83], v[164:167]
    v_mul_f32 v21, s46, v77
    v_mul_f32 v22, s46, v78
    v_mfma_f32_16x16x32_bf16 v[164:167], a[140:143], a[112:115], v[164:167]
    v_mul_f32 v23, s46, v79
    v_mfma_f32_16x16x32_bf16 v[188:191], a[136:139], a[84:87], v[188:191]
    v_exp_f32 v20, v20
    v_mfma_f32_16x16x32_bf16 v[188:191], a[140:143], a[116:119], v[188:191]
    v_exp_f32 v21, v21
    v_mfma_f32_16x16x32_bf16 v[212:215], a[136:139], a[88:91], v[212:215]
    v_exp_f32 v22, v22
    v_mfma_f32_16x16x32_bf16 v[212:215], a[140:143], a[120:123], v[212:215]
    v_exp_f32 v23, v23
    v_mul_f32 v76, v76, v84
    v_mfma_f32_16x16x32_bf16 v[236:239], a[136:139], a[92:95], v[236:239]
    v_mul_f32 v77, v77, v85
    v_add_f32 v20, 1.0, v20
    v_mfma_f32_16x16x32_bf16 v[236:239], a[140:143], a[124:127], v[236:239]
    v_add_f32 v21, 1.0, v21
    v_add_f32 v22, 1.0, v22
    s_waitcnt lgkmcnt(0)
    v_mfma_f32_16x16x32_bf16 v[60:63], a[128:131], a[0:3], v[60:63]
    ds_read_b64_tr_b16 a[136:137], v13 offset:41984
    ds_read_b64_tr_b16 a[138:139], v13 offset:42496
    v_mfma_f32_16x16x32_bf16 v[60:63], a[132:135], a[32:35], v[60:63]
    ds_read_b64_tr_b16 a[140:141], v15 offset:1024
    ds_read_b64_tr_b16 a[142:143], v15 offset:1536
    v_mfma_f32_16x16x32_bf16 v[88:91], a[128:131], a[4:7], v[88:91]
    v_add_f32 v23, 1.0, v23
    v_mfma_f32_16x16x32_bf16 v[88:91], a[132:135], a[36:39], v[88:91]
    v_rcp_f32 v20, v20
    v_mfma_f32_16x16x32_bf16 v[116:119], a[128:131], a[8:11], v[116:119]
    v_rcp_f32 v21, v21
    v_mfma_f32_16x16x32_bf16 v[116:119], a[132:135], a[40:43], v[116:119]
    v_rcp_f32 v22, v22
    v_mfma_f32_16x16x32_bf16 v[144:147], a[128:131], a[12:15], v[144:147]
    v_rcp_f32 v23, v23
    v_mul_f32 v78, v78, v86
    v_mfma_f32_16x16x32_bf16 v[144:147], a[132:135], a[44:47], v[144:147]
    v_mul_f32 v79, v79, v87
    v_mul_f32 v20, v20, v76
    v_mfma_f32_16x16x32_bf16 v[172:175], a[128:131], a[16:19], v[172:175]
    v_mul_f32 v21, v21, v77
    v_mul_f32 v22, v22, v78
    v_mfma_f32_16x16x32_bf16 v[172:175], a[132:135], a[48:51], v[172:175]
    v_mul_f32_e64 v23, v23, v79
    v_cvt_pk_bf16_f32 v76, v20, v21
    v_mfma_f32_16x16x32_bf16 v[196:199], a[128:131], a[20:23], v[196:199]
    v_cvt_pk_bf16_f32 v77, v22, v23
    v_mul_f32 v20, s46, v104
    v_mfma_f32_16x16x32_bf16 v[196:199], a[132:135], a[52:55], v[196:199]
    v_mul_f32 v21, s46, v105
    v_mul_f32 v22, s46, v106
    v_mfma_f32_16x16x32_bf16 v[220:223], a[128:131], a[24:27], v[220:223]
    v_mul_f32 v23, s46, v107
    v_mfma_f32_16x16x32_bf16 v[220:223], a[132:135], a[56:59], v[220:223]
    v_exp_f32 v20, v20
    v_mfma_f32_16x16x32_bf16 v[244:247], a[128:131], a[28:31], v[244:247]
    v_exp_f32 v21, v21
    v_mfma_f32_16x16x32_bf16 v[244:247], a[132:135], a[60:63], v[244:247]
    v_exp_f32 v22, v22
    s_waitcnt vmcnt(10) lgkmcnt(0)
    s_barrier
    v_mfma_f32_16x16x32_bf16 v[60:63], a[136:139], a[64:67], v[60:63]
    ds_read_b64_tr_b16 a[128:129], v12 offset:2048
    ds_read_b64_tr_b16 a[130:131], v12 offset:2560
    v_mfma_f32_16x16x32_bf16 v[60:63], a[140:143], a[96:99], v[60:63]
    ds_read_b64_tr_b16 a[132:133], v12 offset:22528
    ds_read_b64_tr_b16 a[134:135], v12 offset:23040
    v_mfma_f32_16x16x32_bf16 v[88:91], a[136:139], a[68:71], v[88:91]
    v_exp_f32 v23, v23
    v_mul_f32 v104, v104, v112
    v_mfma_f32_16x16x32_bf16 v[88:91], a[140:143], a[100:103], v[88:91]
    v_mul_f32 v105, v105, v113
    v_add_f32 v20, 1.0, v20
    v_mfma_f32_16x16x32_bf16 v[116:119], a[136:139], a[72:75], v[116:119]
    v_add_f32 v21, 1.0, v21
    v_add_f32 v22, 1.0, v22
    v_mfma_f32_16x16x32_bf16 v[116:119], a[140:143], a[104:107], v[116:119]
    v_add_f32 v23, 1.0, v23
    v_mfma_f32_16x16x32_bf16 v[144:147], a[136:139], a[76:79], v[144:147]
    v_rcp_f32 v20, v20
    v_mfma_f32_16x16x32_bf16 v[144:147], a[140:143], a[108:111], v[144:147]
    v_rcp_f32 v21, v21
    v_mfma_f32_16x16x32_bf16 v[172:175], a[136:139], a[80:83], v[172:175]
    v_rcp_f32 v22, v22
    v_mfma_f32_16x16x32_bf16 v[172:175], a[140:143], a[112:115], v[172:175]
    v_rcp_f32 v23, v23
    v_mul_f32 v106, v106, v114
    v_mfma_f32_16x16x32_bf16 v[196:199], a[136:139], a[84:87], v[196:199]
    v_mul_f32 v107, v107, v115
    v_mul_f32 v20, v20, v104
    v_mfma_f32_16x16x32_bf16 v[196:199], a[140:143], a[116:119], v[196:199]
    v_mul_f32 v21, v21, v105
    v_mul_f32 v22, v22, v106
    v_mfma_f32_16x16x32_bf16 v[220:223], a[136:139], a[88:91], v[220:223]
    v_mul_f32 v23, v23, v107
    v_cvt_pk_bf16_f32 v104, v20, v21
    v_mfma_f32_16x16x32_bf16 v[220:223], a[140:143], a[120:123], v[220:223]
    v_cvt_pk_bf16_f32 v105, v22, v23
    s_waitcnt vmcnt(0)
    v_mfma_f32_16x16x32_bf16 v[244:247], a[136:139], a[92:95], v[244:247]
    s_mov_b64 exec, 1
    buffer_store_dword v40, v41, s[4:7], s62 offen sc1
    s_mov_b64 exec, -1
    v_mfma_f32_16x16x32_bf16 v[244:247], a[140:143], a[124:127], v[244:247]
    s_waitcnt lgkmcnt(0)
    v_mfma_f32_16x16x32_bf16 v[64:67], a[128:131], a[0:3], v[64:67]
    ds_read_b64_tr_b16 a[136:137], v12 offset:43008
    ds_read_b64_tr_b16 a[138:139], v12 offset:43520
    v_mfma_f32_16x16x32_bf16 v[64:67], a[132:135], a[32:35], v[64:67]
    ds_read_b64_tr_b16 a[140:141], v14 offset:2048
    ds_read_b64_tr_b16 a[142:143], v14 offset:2560
    v_mfma_f32_16x16x32_bf16 v[92:95], a[128:131], a[4:7], v[92:95]
    v_cmp_eq_u32 vcc, 0x01010101, v45
    s_nop 1
    v_mfma_f32_16x16x32_bf16 v[92:95], a[132:135], a[36:39], v[92:95]
    s_cmp_eq_u64 vcc, exec
    s_cbranch_scc0 Lf_sl1
Lf_ok1:
    v_mfma_f32_16x16x32_bf16 v[120:123], a[128:131], a[8:11], v[120:123]
    v_mul_f32 v20, s46, v132
    v_mul_f32 v21, s46, v133
    v_mfma_f32_16x16x32_bf16 v[120:123], a[132:135], a[40:43], v[120:123]
    v_mul_f32 v22, s46, v134
    v_mul_f32 v23, s46, v135
    v_mfma_f32_16x16x32_bf16 v[148:151], a[128:131], a[12:15], v[148:151]
    v_exp_f32 v20, v20
    v_mfma_f32_16x16x32_bf16 v[148:151], a[132:135], a[44:47], v[148:151]
    v_exp_f32 v21, v21
    v_mfma_f32_16x16x32_bf16 v[176:179], a[128:131], a[16:19], v[176:179]
    v_exp_f32 v22, v22
    v_mfma_f32_16x16x32_bf16 v[176:179], a[132:135], a[48:51], v[176:179]
    v_exp_f32 v23, v23
    v_mfma_f32_16x16x32_bf16 v[200:203], a[128:131], a[20:23], v[200:203]
    v_mul_f32 v132, v132, v140
    v_mul_f32 v133, v133, v141
    v_mfma_f32_16x16x32_bf16 v[200:203], a[132:135], a[52:55], v[200:203]
    v_add_f32 v20, 1.0, v20
    v_add_f32 v21, 1.0, v21
    v_mfma_f32_16x16x32_bf16 v[224:227], a[128:131], a[24:27], v[224:227]
    v_add_f32 v22, 1.0, v22
    v_add_f32 v23, 1.0, v23
    v_mfma_f32_16x16x32_bf16 v[224:227], a[132:135], a[56:59], v[224:227]
    v_rcp_f32 v20, v20
    v_mfma_f32_16x16x32_bf16 v[248:251], a[128:131], a[28:31], v[248:251]
    v_rcp_f32 v21, v21
    v_mfma_f32_16x16x32_bf16 v[248:251], a[132:135], a[60:63], v[248:251]
    v_rcp_f32 v22, v22
    s_waitcnt lgkmcnt(0)
    v_mfma_f32_16x16x32_bf16 v[64:67], a[136:139], a[64:67], v[64:67]
    ds_read_b64_tr_b16 a[128:129], v12 offset:3072
    ds_read_b64_tr_b16 a[130:131], v12 offset:3584
    v_mfma_f32_16x16x32_bf16 v[64:67], a[140:143], a[96:99], v[64:67]
    ds_read_b64_tr_b16 a[132:133], v12 offset:23552
    ds_read_b64_tr_b16 a[134:135], v12 offset:24064
    v_mfma_f32_16x16x32_bf16 v[92:95], a[136:139], a[68:71], v[92:95]
    v_rcp_f32 v23, v23
    v_mfma_f32_16x16x32_bf16 v[92:95], a[140:143], a[100:103], v[92:95]
    v_mul_f32 v134, v134, v142
    v_mul_f32 v135, v135, v143
    v_mfma_f32_16x16x32_bf16 v[120:123], a[136:139], a[72:75], v[120:123]
    v_mul_f32 v20, v20, v132
    v_mul_f32 v21, v21, v133
    v_mfma_f32_16x16x32_bf16 v[120:123], a[140:143], a[104:107], v[120:123]
    v_mul_f32 v22, v22, v134
    v_mul_f32 v23, v23, v135
    v_mfma_f32_16x16x32_bf16 v[148:151], a[136:139], a[76:79], v[148:151]
    v_cvt_pk_bf16_f32 v132, v20, v21
    v_cvt_pk_bf16_f32 v133, v22, v23
    v_mfma_f32_16x16x32_bf16 v[148:151], a[140:143], a[108:111], v[148:151]
    v_mul_f32 v20, s46, v160
    v_mul_f32 v21, s46, v161
    v_mfma_f32_16x16x32_bf16 v[176:179], a[136:139], a[80:83], v[176:179]
    v_mul_f32 v22, s46, v162
    v_mul_f32 v23, s46, v163
    v_mfma_f32_16x16x32_bf16 v[176:179], a[140:143], a[112:115], v[176:179]
    v_exp_f32 v20, v20
    v_mfma_f32_16x16x32_bf16 v[200:203], a[136:139], a[84:87], v[200:203]
    v_exp_f32 v21, v21
    v_mfma_f32_16x16x32_bf16 v[200:203], a[140:143], a[116:119], v[200:203]
    v_exp_f32 v22, v22
    v_mfma_f32_16x16x32_bf16 v[224:227], a[136:139], a[88:91], v[224:227]
    v_exp_f32 v23, v23
    v_mfma_f32_16x16x32_bf16 v[224:227], a[140:143], a[120:123], v[224:227]
    v_mul_f32 v160, v160, v168
    v_mul_f32 v161, v161, v169
    v_mfma_f32_16x16x32_bf16 v[248:251], a[136:139], a[92:95], v[248:251]
    v_add_f32 v20, 1.0, v20
    v_add_f32 v21, 1.0, v21
    v_mfma_f32_16x16x32_bf16 v[248:251], a[140:143], a[124:127], v[248:251]
    v_add_f32 v22, 1.0, v22
    v_add_f32 v23, 1.0, v23
    s_waitcnt lgkmcnt(0)
    v_mfma_f32_16x16x32_bf16 v[72:75], a[128:131], a[0:3], v[72:75]
    ds_read_b64_tr_b16 a[136:137], v12 offset:44032
    ds_read_b64_tr_b16 a[138:139], v12 offset:44544
    v_mfma_f32_16x16x32_bf16 v[72:75], a[132:135], a[32:35], v[72:75]
    ds_read_b64_tr_b16 a[140:141], v14 offset:3072
    ds_read_b64_tr_b16 a[142:143], v14 offset:3584
    v_mfma_f32_16x16x32_bf16 v[100:103], a[128:131], a[4:7], v[100:103]
    v_rcp_f32 v20, v20
    v_mfma_f32_16x16x32_bf16 v[100:103], a[132:135], a[36:39], v[100:103]
    v_rcp_f32 v21, v21
    v_mfma_f32_16x16x32_bf16 v[128:131], a[128:131], a[8:11], v[128:131]
    v_rcp_f32 v22, v22
    v_mfma_f32_16x16x32_bf16 v[128:131], a[132:135], a[40:43], v[128:131]
    v_rcp_f32 v23, v23
    v_mfma_f32_16x16x32_bf16 v[156:159], a[128:131], a[12:15], v[156:159]
    v_mul_f32 v162, v162, v170
    v_mul_f32 v163, v163, v171
    v_mfma_f32_16x16x32_bf16 v[156:159], a[132:135], a[44:47], v[156:159]
    v_mul_f32 v20, v20, v160
    v_mul_f32 v21, v21, v161
    v_mfma_f32_16x16x32_bf16 a[192:195], a[128:131], a[16:19], a[192:195]
    v_mul_f32 v22, v22, v162
    v_mul_f32_e64 v23, v23, v163
    v_mfma_f32_16x16x32_bf16 a[192:195], a[132:135], a[48:51], a[192:195]
    v_cvt_pk_bf16_f32 v160, v20, v21
    v_cvt_pk_bf16_f32 v161, v22, v23
    v_mfma_f32_16x16x32_bf16 a[208:211], a[128:131], a[20:23], a[208:211]
    buffer_load_dword v45, v7, s[4:7], 0 offen sc1
    v_mfma_f32_16x16x32_bf16 a[208:211], a[132:135], a[52:55], a[208:211]
    v_mul_f32 v20, s46, v184
    v_mul_f32 v21, s46, v185
    v_mfma_f32_16x16x32_bf16 a[224:227], a[128:131], a[24:27], a[224:227]
    v_mul_f32 v22, s46, v186
    v_mul_f32 v23, s46, v187
    v_mfma_f32_16x16x32_bf16 a[224:227], a[132:135], a[56:59], a[224:227]
    v_exp_f32 v20, v20
    v_mfma_f32_16x16x32_bf16 a[240:243], a[128:131], a[28:31], a[240:243]
    v_exp_f32 v21, v21
    v_mfma_f32_16x16x32_bf16 a[240:243], a[132:135], a[60:63], a[240:243]
    v_exp_f32 v22, v22
    s_waitcnt lgkmcnt(0)
    v_mfma_f32_16x16x32_bf16 v[72:75], a[136:139], a[64:67], v[72:75]
    ds_read_b64_tr_b16 a[128:129], v13 offset:2048
    ds_read_b64_tr_b16 a[130:131], v13 offset:2560
    v_mfma_f32_16x16x32_bf16 v[72:75], a[140:143], a[96:99], v[72:75]
    ds_read_b64_tr_b16 a[132:133], v13 offset:22528
    ds_read_b64_tr_b16 a[134:135], v13 offset:23040
    v_mfma_f32_16x16x32_bf16 v[100:103], a[136:139], a[68:71], v[100:103]
    v_exp_f32 v23, v23
    v_mfma_f32_16x16x32_bf16 v[100:103], a[140:143], a[100:103], v[100:103]
    v_mul_f32 v184, v184, v192
    v_mul_f32 v185, v185, v193
    v_mfma_f32_16x16x32_bf16 v[128:131], a[136:139], a[72:75], v[128:131]
    v_add_f32 v20, 1.0, v20
    v_add_f32 v21, 1.0, v21
    v_mfma_f32_16x16x32_bf16 v[128:131], a[140:143], a[104:107], v[128:131]
    v_add_f32 v22, 1.0, v22
    v_add_f32 v23, 1.0, v23
    v_mfma_f32_16x16x32_bf16 v[156:159], a[136:139], a[76:79], v[156:159]
    v_rcp_f32 v20, v20
    v_mfma_f32_16x16x32_bf16 v[156:159], a[140:143], a[108:111], v[156:159]
    v_rcp_f32 v21, v21
    v_mfma_f32_16x16x32_bf16 a[192:195], a[136:139], a[80:83], a[192:195]
    v_rcp_f32 v22, v22
    v_mfma_f32_16x16x32_bf16 a[192:195], a[140:143], a[112:115], a[192:195]
    v_rcp_f32 v23, v23
    v_mfma_f32_16x16x32_bf16 a[208:211], a[136:139], a[84:87], a[208:211]
    v_mul_f32 v186, v186, v194
    v_mul_f32 v187, v187, v195
    v_mfma_f32_16x16x32_bf16 a[208:211], a[140:143], a[116:119], a[208:211]
    v_mul_f32 v20, v20, v184
    v_mul_f32 v21, v21, v185
    v_mfma_f32_16x16x32_bf16 a[224:227], a[136:139], a[88:91], a[224:227]
    v_mul_f32 v22, v22, v186
    v_mul_f32_e64 v23, v23, v187
    v_mfma_f32_16x16x32_bf16 a[224:227], a[140:143], a[120:123], a[224:227]
    v_cvt_pk_bf16_f32 v184, v20, v21
    v_cvt_pk_bf16_f32 v185, v22, v23
    v_mfma_f32_16x16x32_bf16 a[240:243], a[136:139], a[92:95], a[240:243]
    v_mul_f32 v20, s46, v208
    v_mul_f32 v21, s46, v209
    v_mfma_f32_16x16x32_bf16 a[240:243], a[140:143], a[124:127], a[240:243]
    v_mul_f32 v22, s46, v210
    v_mul_f32 v23, s46, v211
    s_waitcnt lgkmcnt(0)
    v_mfma_f32_16x16x32_bf16 v[68:71], a[128:131], a[0:3], v[68:71]
    ds_read_b64_tr_b16 a[136:137], v13 offset:43008
    ds_read_b64_tr_b16 a[138:139], v13 offset:43520
    v_mfma_f32_16x16x32_bf16 v[68:71], a[132:135], a[32:35], v[68:71]
    ds_read_b64_tr_b16 a[140:141], v15 offset:2048
    ds_read_b64_tr_b16 a[142:143], v15 offset:2560
    v_mfma_f32_16x16x32_bf16 v[96:99], a[128:131], a[4:7], v[96:99]
    v_exp_f32 v20, v20
    v_mfma_f32_16x16x32_bf16 v[96:99], a[132:135], a[36:39], v[96:99]
    v_exp_f32 v21, v21
    v_mfma_f32_16x16x32_bf16 v[124:127], a[128:131], a[8:11], v[124:127]
    v_exp_f32 v22, v22
    v_mfma_f32_16x16x32_bf16 v[124:127], a[132:135], a[40:43], v[124:127]
    v_exp_f32 v23, v23
    v_mfma_f32_16x16x32_bf16 v[152:155], a[128:131], a[12:15], v[152:155]
    v_mul_f32 v208, v208, v216
    v_mul_f32 v209, v209, v217
    v_mfma_f32_16x16x32_bf16 v[152:155], a[132:135], a[44:47], v[152:155]
    v_add_f32 v20, 1.0, v20
    v_add_f32 v21, 1.0, v21
    v_mfma_f32_16x16x32_bf16 v[180:183], a[128:131], a[16:19], v[180:183]
    v_add_f32 v22, 1.0, v22
    v_add_f32 v23, 1.0, v23
    v_mfma_f32_16x16x32_bf16 v[180:183], a[132:135], a[48:51], v[180:183]
    v_rcp_f32 v20, v20
    v_mfma_f32_16x16x32_bf16 v[204:207], a[128:131], a[20:23], v[204:207]
    v_rcp_f32 v21, v21
    v_mfma_f32_16x16x32_bf16 v[204:207], a[132:135], a[52:55], v[204:207]
    v_rcp_f32 v22, v22
    v_mfma_f32_16x16x32_bf16 v[228:231], a[128:131], a[24:27], v[228:231]
    v_rcp_f32 v23, v23
    v_mfma_f32_16x16x32_bf16 v[228:231], a[132:135], a[56:59], v[228:231]
    v_mul_f32 v210, v210, v218
    v_mul_f32 v211, v211, v219
    v_mfma_f32_16x16x32_bf16 v[252:255], a[128:131], a[28:31], v[252:255]
    v_mul_f32 v20, v20, v208
    v_mul_f32 v21, v21, v209
    v_mfma_f32_16x16x32_bf16 v[252:255], a[132:135], a[60:63], v[252:255]
    v_mul_f32 v22, v22, v210
    v_mul_f32 v23, v23, v211
    s_waitcnt lgkmcnt(0)
    v_mfma_f32_16x16x32_bf16 v[68:71], a[136:139], a[64:67], v[68:71]
    ds_read_b64_tr_b16 a[128:129], v13 offset:3072
    ds_read_b64_tr_b16 a[130:131], v13 offset:3584
    v_mfma_f32_16x16x32_bf16 v[68:71], a[140:143], a[96:99], v[68:71]
    ds_read_b64_tr_b16 a[132:133], v13 offset:23552
    ds_read_b64_tr_b16 a[134:135], v13 offset:24064
    v_mfma_f32_16x16x32_bf16 v[96:99], a[136:139], a[68:71], v[96:99]
    v_cvt_pk_bf16_f32 v208, v20, v21
    v_cvt_pk_bf16_f32 v209, v22, v23
    v_mfma_f32_16x16x32_bf16 v[96:99], a[140:143], a[100:103], v[96:99]
    s_waitcnt vmcnt(0)
    v_cmp_eq_u32 vcc, 1, v45
    v_mfma_f32_16x16x32_bf16 v[124:127], a[136:139], a[72:75], v[124:127]
    s_nop 1
    v_mfma_f32_16x16x32_bf16 v[124:127], a[140:143], a[104:107], v[124:127]
    s_cmp_eq_u64 vcc, exec
    s_cbranch_scc0 Lf_sl2
Lf_ok2:
    s_add_u32 m0, s53, 0
    v_mfma_f32_16x16x32_bf16 v[152:155], a[136:139], a[76:79], v[152:155]
    s_add_u32 s73, s54, 0
    v_mfma_f32_16x16x32_bf16 v[152:155], a[140:143], a[108:111], v[152:155]
    buffer_load_dwordx4 v19, s[4:7], s73 offen offset:0 sc1 lds
    v_mfma_f32_16x16x32_bf16 v[180:183], a[136:139], a[80:83], v[180:183]
    buffer_load_dwordx4 v19, s[4:7], s73 offen offset:1024 sc1 lds
    v_mfma_f32_16x16x32_bf16 v[180:183], a[140:143], a[112:115], v[180:183]
    buffer_load_dwordx4 v19, s[4:7], s73 offen offset:2048 sc1 lds
    v_mfma_f32_16x16x32_bf16 v[204:207], a[136:139], a[84:87], v[204:207]
    buffer_load_dwordx4 v19, s[4:7], s73 offen offset:3072 sc1 lds
    s_add_u32 m0, s53, 4096
    v_mfma_f32_16x16x32_bf16 v[204:207], a[140:143], a[116:119], v[204:207]
    s_add_u32 s73, s54, 4096
    v_mfma_f32_16x16x32_bf16 v[228:231], a[136:139], a[88:91], v[228:231]
    buffer_load_dwordx4 v19, s[4:7], s73 offen offset:0 sc1 lds
    v_mfma_f32_16x16x32_bf16 v[228:231], a[140:143], a[120:123], v[228:231]
    buffer_load_dwordx4 v19, s[4:7], s73 offen offset:1024 sc1 lds
    v_mfma_f32_16x16x32_bf16 v[252:255], a[136:139], a[92:95], v[252:255]
    buffer_load_dwordx4 v19, s[4:7], s73 offen offset:2048 sc1 lds
    v_mfma_f32_16x16x32_bf16 v[252:255], a[140:143], a[124:127], v[252:255]
    buffer_load_dwordx4 v19, s[4:7], s73 offen offset:3072 sc1 lds
    s_waitcnt lgkmcnt(0)
    v_mfma_f32_16x16x32_bf16 a[144:147], a[128:131], a[0:3], a[144:147]
    ds_read_b64_tr_b16 a[136:137], v13 offset:44032
    ds_read_b64_tr_b16 a[138:139], v13 offset:44544
    v_mfma_f32_16x16x32_bf16 a[144:147], a[132:135], a[32:35], a[144:147]
    ds_read_b64_tr_b16 a[140:141], v15 offset:3072
    ds_read_b64_tr_b16 a[142:143], v15 offset:3584
    v_mfma_f32_16x16x32_bf16 a[156:159], a[128:131], a[4:7], a[156:159]
    buffer_load_dwordx4 a[232:235], v18, s[4:7], s65 offen offset:0 sc1
    v_mfma_f32_16x16x32_bf16 a[156:159], a[132:135], a[36:39], a[156:159]
    buffer_load_dwordx4 a[236:239], v18, s[4:7], s65 offen offset:512 sc1
    v_mfma_f32_16x16x32_bf16 a[168:171], a[128:131], a[8:11], a[168:171]
    buffer_load_dwordx4 a[248:251], v18, s[4:7], s65 offen offset:2048 sc1
    v_mfma_f32_16x16x32_bf16 a[168:171], a[132:135], a[40:43], a[168:171]
    buffer_load_dwordx4 a[252:255], v18, s[4:7], s65 offen offset:2560 sc1
    v_mul_f32 v20, s46, v232
    v_mfma_f32_16x16x32_bf16 a[180:183], a[128:131], a[12:15], a[180:183]
    v_mul_f32 v21, s46, v233
    v_mul_f32 v22, s46, v234
    v_mfma_f32_16x16x32_bf16 a[180:183], a[132:135], a[44:47], a[180:183]
    v_mul_f32 v23, s46, v235
    v_mfma_f32_16x16x32_bf16 a[196:199], a[128:131], a[16:19], a[196:199]
    v_exp_f32 v20, v20
    v_mfma_f32_16x16x32_bf16 a[196:199], a[132:135], a[48:51], a[196:199]
    v_exp_f32 v21, v21
    v_mfma_f32_16x16x32_bf16 a[212:215], a[128:131], a[20:23], a[212:215]
    v_exp_f32 v22, v22
    v_mfma_f32_16x16x32_bf16 a[212:215], a[132:135], a[52:55], a[212:215]
    v_exp_f32 v23, v23
    v_mul_f32 v232, v232, v240
    v_mfma_f32_16x16x32_bf16 a[228:231], a[128:131], a[24:27], a[228:231]
    v_mul_f32 v233, v233, v241
    v_add_f32 v20, 1.0, v20
    v_mfma_f32_16x16x32_bf16 a[228:231], a[132:135], a[56:59], a[228:231]
    v_add_f32 v21, 1.0, v21
    v_add_f32 v22, 1.0, v22
    v_mfma_f32_16x16x32_bf16 a[244:247], a[128:131], a[28:31], a[244:247]
    v_add_f32 v23, 1.0, v23
    v_mfma_f32_16x16x32_bf16 a[244:247], a[132:135], a[60:63], a[244:247]
    v_rcp_f32 v20, v20
    s_waitcnt lgkmcnt(0)
    v_mfma_f32_16x16x32_bf16 a[144:147], a[136:139], a[64:67], a[144:147]
    v_rcp_f32 v21, v21
    v_mfma_f32_16x16x32_bf16 a[144:147], a[140:143], a[96:99], a[144:147]
    v_rcp_f32 v22, v22
    v_mfma_f32_16x16x32_bf16 a[156:159], a[136:139], a[68:71], a[156:159]
    v_rcp_f32 v23, v23
    v_mul_f32 v234, v234, v242
    v_mfma_f32_16x16x32_bf16 a[156:159], a[140:143], a[100:103], a[156:159]
    v_mul_f32 v235, v235, v243
    v_mul_f32 v20, v20, v232
    v_mfma_f32_16x16x32_bf16 a[168:171], a[136:139], a[72:75], a[168:171]
    v_mul_f32 v21, v21, v233
    v_mul_f32 v22, v22, v234
    v_mfma_f32_16x16x32_bf16 a[168:171], a[140:143], a[104:107], a[168:171]
    v_mul_f32_e64 v23, v23, v235
    v_cvt_pk_bf16_f32 v232, v20, v21
    v_mfma_f32_16x16x32_bf16 a[180:183], a[136:139], a[76:79], a[180:183]
    v_cvt_pk_bf16_f32 v233, v22, v23
    s_lshl_b32 s74, s2, 14
    v_mfma_f32_16x16x32_bf16 a[180:183], a[140:143], a[108:111], a[180:183]
    s_lshl_b32 s75, s56, 12
    s_add_u32 s74, s74, s75
    v_mfma_f32_16x16x32_bf16 a[196:199], a[136:139], a[80:83], a[196:199]
    buffer_load_dwordx4 v[56:59], v19, s[16:19], s74 offen offset:0
    v_mfma_f32_16x16x32_bf16 a[196:199], a[140:143], a[112:115], a[196:199]
    buffer_load_dwordx4 v[84:87], v19, s[16:19], s74 offen offset:1024
    v_mfma_f32_16x16x32_bf16 a[212:215], a[136:139], a[84:87], a[212:215]
    buffer_load_dwordx4 v[112:115], v19, s[16:19], s74 offen offset:2048
    v_mfma_f32_16x16x32_bf16 a[212:215], a[140:143], a[116:119], a[212:215]
    buffer_load_dwordx4 v[140:143], v19, s[16:19], s74 offen offset:3072
    v_mfma_f32_16x16x32_bf16 a[228:231], a[136:139], a[88:91], a[228:231]
    global_load_dwordx4 v[168:171], v19, s[78:79] offset:0
    v_mfma_f32_16x16x32_bf16 a[228:231], a[140:143], a[120:123], a[228:231]
    global_load_dwordx4 v[192:195], v19, s[78:79] offset:1024
    v_mfma_f32_16x16x32_bf16 a[244:247], a[136:139], a[92:95], a[244:247]
    v_mul_f32 v20, s46, v52
    v_mul_f32 v21, s46, v53
    v_mfma_f32_16x16x32_bf16 a[244:247], a[140:143], a[124:127], a[244:247]
    v_mul_f32 v22, s46, v54
    v_mul_f32 v23, s46, v55
    v_exp_f32 v20, v20
    v_exp_f32 v21, v21
    v_exp_f32 v22, v22
    v_exp_f32 v23, v23
    v_mul_f32 v52, v52, v60
    v_mul_f32 v53, v53, v61
    v_add_f32 v20, 1.0, v20
    v_add_f32 v21, 1.0, v21
    v_add_f32 v22, 1.0, v22
    v_add_f32 v23, 1.0, v23
    v_rcp_f32 v20, v20
    v_rcp_f32 v21, v21
    v_rcp_f32 v22, v22
    v_rcp_f32 v23, v23
    v_mul_f32 v54, v54, v62
    v_mul_f32 v55, v55, v63
    v_mul_f32 v20, v20, v52
    v_mul_f32 v21, v21, v53
    v_mul_f32 v22, v22, v54
    v_mul_f32_e64 v23, v23, v55
    v_cvt_pk_bf16_f32 v50, v20, v21
    v_cvt_pk_bf16_f32 v51, v22, v23
    s_barrier
    s_cmp_eq_u32 s59, 3
    s_cbranch_scc1 Lf_epiY
    v_pk_mul_f32 v[20:21], v[80:81], s[46:47]
    v_pk_mul_f32 v[22:23], v[82:83], s[46:47]
    v_permlane16_swap_b32 v48, v50
    v_permlane16_swap_b32 v49, v51
    buffer_store_dwordx4 v[48:51], v5, s[4:7], s48 offen offset:0 sc1
    v_exp_f32 v20, v20
    v_exp_f32 v21, v21
    v_exp_f32 v22, v22
    v_exp_f32_e64 v23, v23
    v_pk_mul_f32 v[80:81], v[80:81], v[88:89]
    v_pk_add_f32 v[20:21], v[20:21], 1.0 op_sel_hi:[1,0]
    v_pk_add_f32 v[22:23], v[22:23], 1.0 op_sel_hi:[1,0]
    v_rcp_f32 v20, v20
    v_rcp_f32 v21, v21
    v_rcp_f32 v22, v22
    v_rcp_f32 v23, v23
    v_pk_mul_f32 v[82:83], v[82:83], v[90:91]
    v_pk_mul_f32 v[20:21], v[20:21], v[80:81]
    v_pk_mul_f32 v[22:23], v[22:23], v[82:83]
    v_cvt_pk_bf16_f32 v78, v20, v21
    v_cvt_pk_bf16_f32 v79, v22, v23
    v_pk_mul_f32 v[20:21], v[108:109], s[46:47]
    v_pk_mul_f32 v[22:23], v[110:111], s[46:47]
    v_permlane16_swap_b32 v76, v78
    v_permlane16_swap_b32 v77, v79
    buffer_store_dwordx4 v[76:79], v5, s[4:7], s48 offen offset:1024 sc1
    v_exp_f32 v20, v20
    v_exp_f32 v21, v21
    v_exp_f32 v22, v22
    v_exp_f32 v23, v23
    v_pk_mul_f32 v[108:109], v[108:109], v[116:117]
    v_pk_add_f32 v[20:21], v[20:21], 1.0 op_sel_hi:[1,0]
    v_pk_add_f32 v[22:23], v[22:23], 1.0 op_sel_hi:[1,0]
    v_rcp_f32 v20, v20
    v_rcp_f32 v21, v21
    v_rcp_f32 v22, v22
    v_rcp_f32 v23, v23
    v_pk_mul_f32 v[110:111], v[110:111], v[118:119]
    v_pk_mul_f32 v[20:21], v[20:21], v[108:109]
    v_pk_mul_f32 v[22:23], v[22:23], v[110:111]
    v_cvt_pk_bf16_f32 v106, v20, v21
    v_cvt_pk_bf16_f32 v107, v22, v23
    v_pk_mul_f32 v[20:21], v[136:137], s[46:47]
    v_pk_mul_f32 v[22:23], v[138:139], s[46:47]
    v_permlane16_swap_b32 v104, v106
    v_permlane16_swap_b32 v105, v107
    buffer_store_dwordx4 v[104:107], v5, s[4:7], s48 offen offset:2048 sc1
    v_exp_f32 v20, v20
    v_exp_f32 v21, v21
    v_exp_f32 v22, v22
    v_exp_f32 v23, v23
    v_pk_mul_f32 v[136:137], v[136:137], v[144:145]
    v_pk_add_f32 v[20:21], v[20:21], 1.0 op_sel_hi:[1,0]
    v_pk_add_f32 v[22:23], v[22:23], 1.0 op_sel_hi:[1,0]
    v_rcp_f32 v20, v20
    v_rcp_f32 v21, v21
    v_rcp_f32 v22, v22
    v_rcp_f32 v23, v23
    v_pk_mul_f32 v[138:139], v[138:139], v[146:147]
    v_pk_mul_f32 v[20:21], v[20:21], v[136:137]
    v_pk_mul_f32 v[22:23], v[22:23], v[138:139]
    v_cvt_pk_bf16_f32 v134, v20, v21
    v_cvt_pk_bf16_f32 v135, v22, v23
    v_pk_mul_f32 v[20:21], v[164:165], s[46:47]
    v_pk_mul_f32 v[22:23], v[166:167], s[46:47]
    v_permlane16_swap_b32 v132, v134
    v_permlane16_swap_b32 v133, v135
    buffer_store_dwordx4 v[132:135], v5, s[4:7], s48 offen offset:3072 sc1
    v_exp_f32 v20, v20
    v_exp_f32 v21, v21
    v_exp_f32 v22, v22
    v_exp_f32 v23, v23
    v_pk_mul_f32 v[164:165], v[164:165], v[172:173]
    v_pk_add_f32 v[20:21], v[20:21], 1.0 op_sel_hi:[1,0]
    v_pk_add_f32 v[22:23], v[22:23], 1.0 op_sel_hi:[1,0]
    v_rcp_f32 v20, v20
    v_rcp_f32 v21, v21
    v_rcp_f32 v22, v22
    v_rcp_f32 v23, v23
    v_pk_mul_f32 v[166:167], v[166:167], v[174:175]
    v_pk_mul_f32 v[20:21], v[20:21], v[164:165]
    v_pk_mul_f32 v[22:23], v[22:23], v[166:167]
    v_cvt_pk_bf16_f32 v162, v20, v21
    v_cvt_pk_bf16_f32 v163, v22, v23
    v_pk_mul_f32 v[20:21], v[188:189], s[46:47]
    v_pk_mul_f32 v[22:23], v[190:191], s[46:47]
    v_permlane16_swap_b32 v160, v162
    v_permlane16_swap_b32 v161, v163
    buffer_store_dwordx4 v[160:163], v6, s[4:7], s48 offen offset:0 sc1
    v_exp_f32 v20, v20
    v_exp_f32 v21, v21
    v_exp_f32 v22, v22
    v_exp_f32 v23, v23
    v_pk_mul_f32 v[188:189], v[188:189], v[196:197]
    v_pk_add_f32 v[20:21], v[20:21], 1.0 op_sel_hi:[1,0]
    v_pk_add_f32 v[22:23], v[22:23], 1.0 op_sel_hi:[1,0]
    v_rcp_f32 v20, v20
    v_rcp_f32 v21, v21
    v_rcp_f32 v22, v22
    v_rcp_f32 v23, v23
    v_pk_mul_f32 v[190:191], v[190:191], v[198:199]
    v_pk_mul_f32 v[20:21], v[20:21], v[188:189]
    v_pk_mul_f32 v[22:23], v[22:23], v[190:191]
    v_cvt_pk_bf16_f32 v186, v20, v21
    v_cvt_pk_bf16_f32 v187, v22, v23
    v_pk_mul_f32 v[20:21], v[212:213], s[46:47]
    v_pk_mul_f32 v[22:23], v[214:215], s[46:47]
    v_permlane16_swap_b32 v184, v186
    v_permlane16_swap_b32 v185, v187
    buffer_store_dwordx4 v[184:187], v6, s[4:7], s48 offen offset:1024 sc1
    v_exp_f32 v20, v20
    v_exp_f32 v21, v21
    v_exp_f32 v22, v22
    v_exp_f32 v23, v23
    v_pk_mul_f32 v[212:213], v[212:213], v[220:221]
    v_pk_add_f32 v[20:21], v[20:21], 1.0 op_sel_hi:[1,0]
    v_pk_add_f32 v[22:23], v[22:23], 1.0 op_sel_hi:[1,0]
    v_rcp_f32 v20, v20
    v_rcp_f32 v21, v21
    v_rcp_f32 v22, v22
    v_rcp_f32 v23, v23
    v_pk_mul_f32 v[214:215], v[214:215], v[222:223]
    v_pk_mul_f32 v[20:21], v[20:21], v[212:213]
    v_pk_mul_f32 v[22:23], v[22:23], v[214:215]
    v_cvt_pk_bf16_f32 v210, v20, v21
    v_cvt_pk_bf16_f32 v211, v22, v23
    v_pk_mul_f32 v[20:21], v[236:237], s[46:47]
    v_pk_mul_f32 v[22:23], v[238:239], s[46:47]
    v_permlane16_swap_b32 v208, v210
    v_permlane16_swap_b32 v209, v211
    buffer_store_dwordx4 v[208:211], v6, s[4:7], s48 offen offset:2048 sc1
    v_exp_f32 v20, v20
    v_exp_f32 v21, v21
    v_exp_f32 v22, v22
    v_exp_f32 v23, v23
    v_pk_mul_f32 v[236:237], v[236:237], v[244:245]
    v_pk_add_f32 v[20:21], v[20:21], 1.0 op_sel_hi:[1,0]
    v_pk_add_f32 v[22:23], v[22:23], 1.0 op_sel_hi:[1,0]
    v_rcp_f32 v20, v20
    v_rcp_f32 v21, v21
    v_rcp_f32 v22, v22
    v_rcp_f32 v23, v23
    v_pk_mul_f32 v[238:239], v[238:239], v[246:247]
    v_pk_mul_f32 v[20:21], v[20:21], v[236:237]
    v_pk_mul_f32 v[22:23], v[22:23], v[238:239]
    v_cvt_pk_bf16_f32 v234, v20, v21
    v_cvt_pk_bf16_f32 v235, v22, v23
    s_waitcnt vmcnt(7)
    v_mov_b32 v28, 0
    v_mov_b32 v29, 0
    v_permlane16_swap_b32 v232, v234
    v_permlane16_swap_b32_e64 v233, v235
    buffer_store_dwordx4 v[232:235], v6, s[4:7], s48 offen offset:3072 sc1
    v_dot2_f32_bf16 v28, v56, v168, v28
    v_dot2_f32_bf16 v29, v112, v168, v29
    v_dot2_f32_bf16 v28, v57, v169, v28
    v_dot2_f32_bf16 v29, v113, v169, v29
    v_dot2_f32_bf16 v28, v58, v170, v28
    v_dot2_f32_bf16 v29, v114, v170, v29
    v_dot2_f32_bf16 v28, v59, v171, v28
    v_dot2_f32_bf16 v29, v115, v171, v29
    v_dot2_f32_bf16 v28, v84, v192, v28
    v_dot2_f32_bf16 v29, v140, v192, v29
    v_dot2_f32_bf16 v28, v85, v193, v28
    v_dot2_f32_bf16 v29, v141, v193, v29
    v_dot2_f32_bf16 v28, v86, v194, v28
    v_dot2_f32_bf16 v29, v142, v194, v29
    v_dot2_f32_bf16 v28, v87, v195, v28
    v_dot2_f32_bf16 v29, v143, v195, v29
    s_lshl_b32 s72, s2, 5
    s_lshl_b32 s73, s56, 3
    s_add_u32 s72, s72, s73
    s_add_u32 s72, s72, 50331648
    v_permlane32_swap_b32 v28, v29
    v_add_f32 v28, v28, v29
    v_mov_b32 v29, v28
    s_nop 1
    v_permlane16_swap_b32 v28, v29
    v_add_f32 v28, v28, v29
    s_nop 1
    v_add_f32_dpp v28, v28, v28 row_ror:8 row_mask:0xf bank_mask:0xf
    s_nop 1
    v_add_f32_dpp v28, v28, v28 row_ror:4 row_mask:0xf bank_mask:0xf
    s_nop 1
    v_add_f32_dpp v28, v28, v28 row_ror:2 row_mask:0xf bank_mask:0xf
    s_nop 1
    v_add_f32_dpp v28, v28, v28 row_ror:1 row_mask:0xf bank_mask:0xf
    v_mul_f32 v28, 0xbfb8aa3b, v28
    v_exp_f32 v28, v28
    v_lshrrev_b32 v3, 5, v2
    v_add_f32 v28, 1.0, v28
    v_rcp_f32 v4, v28
    v_lshlrev_b32 v3, 2, v3
    buffer_store_dword v4, v3, s[4:7], s72 offen sc1
    v_pk_mul_f32 v[20:21], v[64:65], s[46:47]
    v_pk_mul_f32 v[22:23], v[66:67], s[46:47]
    v_exp_f32 v20, v20
    v_exp_f32 v21, v21
    v_exp_f32 v22, v22
    v_exp_f32 v23, v23
    v_pk_mul_f32 v[64:65], v[64:65], v[72:73]
    v_pk_add_f32 v[20:21], v[20:21], 1.0 op_sel_hi:[1,0]
    v_pk_add_f32 v[22:23], v[22:23], 1.0 op_sel_hi:[1,0]
    v_rcp_f32 v20, v20
    v_rcp_f32 v21, v21
    v_rcp_f32 v22, v22
    v_rcp_f32 v23, v23
    v_pk_mul_f32 v[66:67], v[66:67], v[74:75]
    v_pk_mul_f32 v[20:21], v[20:21], v[64:65]
    v_pk_mul_f32 v[22:23], v[22:23], v[66:67]
    v_cvt_pk_bf16_f32 v36, v20, v21
    v_cvt_pk_bf16_f32 v37, v22, v23
    v_accvgpr_read_b32 v28, a144
    v_accvgpr_read_b32 v29, a145
    v_accvgpr_read_b32 v30, a146
    v_accvgpr_read_b32 v31, a147
    v_pk_mul_f32 v[20:21], v[68:69], s[46:47]
    v_pk_mul_f32 v[22:23], v[70:71], s[46:47]
    v_exp_f32 v20, v20
    v_exp_f32 v21, v21
    v_exp_f32 v22, v22
    v_exp_f32 v23, v23
    v_pk_mul_f32 v[68:69], v[68:69], v[28:29]
    v_pk_add_f32 v[20:21], v[20:21], 1.0 op_sel_hi:[1,0]
    v_pk_add_f32 v[22:23], v[22:23], 1.0 op_sel_hi:[1,0]
    v_rcp_f32 v20, v20
    v_rcp_f32 v21, v21
    v_rcp_f32 v22, v22
    v_rcp_f32 v23, v23
    v_pk_mul_f32 v[70:71], v[70:71], v[30:31]
    v_pk_mul_f32 v[20:21], v[20:21], v[68:69]
    v_pk_mul_f32 v[22:23], v[22:23], v[70:71]
    v_cvt_pk_bf16_f32 v38, v20, v21
    v_cvt_pk_bf16_f32 v39, v22, v23
    v_pk_mul_f32 v[20:21], v[92:93], s[46:47]
    v_pk_mul_f32 v[22:23], v[94:95], s[46:47]
    v_permlane16_swap_b32 v36, v38
    v_permlane16_swap_b32 v37, v39
    buffer_store_dwordx4 v[36:39], v5, s[4:7], s49 offen offset:0 sc1
    v_exp_f32 v20, v20
    v_exp_f32 v21, v21
    v_exp_f32 v22, v22
    v_exp_f32 v23, v23
    v_pk_mul_f32 v[92:93], v[92:93], v[100:101]
    v_pk_add_f32 v[20:21], v[20:21], 1.0 op_sel_hi:[1,0]
    v_pk_add_f32 v[22:23], v[22:23], 1.0 op_sel_hi:[1,0]
    v_rcp_f32 v20, v20
    v_rcp_f32 v21, v21
    v_rcp_f32 v22, v22
    v_rcp_f32 v23, v23
    v_pk_mul_f32 v[94:95], v[94:95], v[102:103]
    v_pk_mul_f32 v[20:21], v[20:21], v[92:93]
    v_pk_mul_f32 v[22:23], v[22:23], v[94:95]
    v_cvt_pk_bf16_f32 v32, v20, v21
    v_cvt_pk_bf16_f32 v33, v22, v23
    v_accvgpr_read_b32 v28, a156
    v_accvgpr_read_b32 v29, a157
    v_accvgpr_read_b32 v30, a158
    v_accvgpr_read_b32 v31, a159
    v_pk_mul_f32 v[20:21], v[96:97], s[46:47]
    v_pk_mul_f32 v[22:23], v[98:99], s[46:47]
    v_exp_f32 v20, v20
    v_exp_f32 v21, v21
    v_exp_f32 v22, v22
    v_exp_f32 v23, v23
    v_pk_mul_f32 v[96:97], v[96:97], v[28:29]
    v_pk_add_f32 v[20:21], v[20:21], 1.0 op_sel_hi:[1,0]
    v_pk_add_f32 v[22:23], v[22:23], 1.0 op_sel_hi:[1,0]
    v_rcp_f32 v20, v20
    v_rcp_f32 v21, v21
    v_rcp_f32 v22, v22
    v_rcp_f32 v23, v23
    v_pk_mul_f32 v[98:99], v[98:99], v[30:31]
    v_pk_mul_f32 v[20:21], v[20:21], v[96:97]
    v_pk_mul_f32 v[22:23], v[22:23], v[98:99]
    v_cvt_pk_bf16_f32 v34, v20, v21
    v_cvt_pk_bf16_f32 v35, v22, v23
    v_pk_mul_f32 v[20:21], v[120:121], s[46:47]
    v_pk_mul_f32 v[22:23], v[122:123], s[46:47]
    v_permlane16_swap_b32 v32, v34
    v_permlane16_swap_b32 v33, v35
    buffer_store_dwordx4 v[32:35], v5, s[4:7], s49 offen offset:1024 sc1
    v_exp_f32 v20, v20
    v_exp_f32 v21, v21
    v_exp_f32 v22, v22
    v_exp_f32 v23, v23
    v_pk_mul_f32 v[120:121], v[120:121], v[128:129]
    v_pk_add_f32 v[20:21], v[20:21], 1.0 op_sel_hi:[1,0]
    v_pk_add_f32 v[22:23], v[22:23], 1.0 op_sel_hi:[1,0]
    v_rcp_f32 v20, v20
    v_rcp_f32 v21, v21
    v_rcp_f32 v22, v22
    v_rcp_f32 v23, v23
    v_pk_mul_f32 v[122:123], v[122:123], v[130:131]
    v_pk_mul_f32 v[20:21], v[20:21], v[120:121]
    v_pk_mul_f32 v[22:23], v[22:23], v[122:123]
    v_cvt_pk_bf16_f32 v36, v20, v21
    v_cvt_pk_bf16_f32 v37, v22, v23
    v_accvgpr_read_b32 v28, a168
    v_accvgpr_read_b32 v29, a169
    v_accvgpr_read_b32 v30, a170
    v_accvgpr_read_b32 v31, a171
    v_pk_mul_f32 v[20:21], v[124:125], s[46:47]
    v_pk_mul_f32 v[22:23], v[126:127], s[46:47]
    v_exp_f32 v20, v20
    v_exp_f32 v21, v21
    v_exp_f32 v22, v22
    v_exp_f32 v23, v23
    v_pk_mul_f32 v[124:125], v[124:125], v[28:29]
    v_pk_add_f32 v[20:21], v[20:21], 1.0 op_sel_hi:[1,0]
    v_pk_add_f32 v[22:23], v[22:23], 1.0 op_sel_hi:[1,0]
    v_rcp_f32 v20, v20
    v_rcp_f32 v21, v21
    v_rcp_f32 v22, v22
    v_rcp_f32 v23, v23
    v_pk_mul_f32 v[126:127], v[126:127], v[30:31]
    v_pk_mul_f32 v[20:21], v[20:21], v[124:125]
    v_pk_mul_f32 v[22:23], v[22:23], v[126:127]
    v_cvt_pk_bf16_f32 v38, v20, v21
    v_cvt_pk_bf16_f32 v39, v22, v23
    v_pk_mul_f32 v[20:21], v[148:149], s[46:47]
    v_pk_mul_f32 v[22:23], v[150:151], s[46:47]
    v_permlane16_swap_b32 v36, v38
    v_permlane16_swap_b32 v37, v39
    buffer_store_dwordx4 v[36:39], v5, s[4:7], s49 offen offset:2048 sc1
    v_exp_f32 v20, v20
    v_exp_f32 v21, v21
    v_exp_f32 v22, v22
    v_exp_f32 v23, v23
    v_pk_mul_f32 v[148:149], v[148:149], v[156:157]
    v_pk_add_f32 v[20:21], v[20:21], 1.0 op_sel_hi:[1,0]
    v_pk_add_f32 v[22:23], v[22:23], 1.0 op_sel_hi:[1,0]
    v_rcp_f32 v20, v20
    v_rcp_f32 v21, v21
    v_rcp_f32 v22, v22
    v_rcp_f32 v23, v23
    v_pk_mul_f32 v[150:151], v[150:151], v[158:159]
    v_pk_mul_f32 v[20:21], v[20:21], v[148:149]
    v_pk_mul_f32 v[22:23], v[22:23], v[150:151]
    v_cvt_pk_bf16_f32 v32, v20, v21
    v_cvt_pk_bf16_f32 v33, v22, v23
    v_accvgpr_read_b32 v28, a180
    v_accvgpr_read_b32 v29, a181
    v_accvgpr_read_b32 v30, a182
    v_accvgpr_read_b32 v31, a183
    v_pk_mul_f32 v[20:21], v[152:153], s[46:47]
    v_pk_mul_f32 v[22:23], v[154:155], s[46:47]
    v_exp_f32 v20, v20
    v_exp_f32 v21, v21
    v_exp_f32 v22, v22
    v_exp_f32 v23, v23
    v_pk_mul_f32 v[152:153], v[152:153], v[28:29]
    v_pk_add_f32 v[20:21], v[20:21], 1.0 op_sel_hi:[1,0]
    v_pk_add_f32 v[22:23], v[22:23], 1.0 op_sel_hi:[1,0]
    v_rcp_f32 v20, v20
    v_rcp_f32 v21, v21
    v_rcp_f32 v22, v22
    v_rcp_f32 v23, v23
    v_pk_mul_f32 v[154:155], v[154:155], v[30:31]
    v_pk_mul_f32 v[20:21], v[20:21], v[152:153]
    v_pk_mul_f32 v[22:23], v[22:23], v[154:155]
    v_cvt_pk_bf16_f32 v34, v20, v21
    v_cvt_pk_bf16_f32 v35, v22, v23
    v_accvgpr_read_b32 v28, a192
    v_accvgpr_read_b32 v29, a193
    v_permlane16_swap_b32 v32, v34
    v_permlane16_swap_b32 v33, v35
    buffer_store_dwordx4 v[32:35], v5, s[4:7], s49 offen offset:3072 sc1
    v_accvgpr_read_b32 v30, a194
    v_accvgpr_read_b32 v31, a195
    v_pk_mul_f32 v[20:21], v[176:177], s[46:47]
    v_pk_mul_f32 v[22:23], v[178:179], s[46:47]
    v_exp_f32 v20, v20
    v_exp_f32 v21, v21
    v_exp_f32 v22, v22
    v_exp_f32 v23, v23
    v_pk_mul_f32 v[176:177], v[176:177], v[28:29]
    v_pk_add_f32 v[20:21], v[20:21], 1.0 op_sel_hi:[1,0]
    v_pk_add_f32 v[22:23], v[22:23], 1.0 op_sel_hi:[1,0]
    v_rcp_f32 v20, v20
    v_rcp_f32 v21, v21
    v_rcp_f32 v22, v22
    v_rcp_f32 v23, v23
    v_pk_mul_f32 v[178:179], v[178:179], v[30:31]
    v_pk_mul_f32 v[20:21], v[20:21], v[176:177]
    v_pk_mul_f32 v[22:23], v[22:23], v[178:179]
    v_cvt_pk_bf16_f32 v36, v20, v21
    v_cvt_pk_bf16_f32 v37, v22, v23
    v_accvgpr_read_b32 v28, a196
    v_accvgpr_read_b32 v29, a197
    v_accvgpr_read_b32 v30, a198
    v_accvgpr_read_b32 v31, a199
    v_pk_mul_f32 v[20:21], v[180:181], s[46:47]
    v_pk_mul_f32 v[22:23], v[182:183], s[46:47]
    v_exp_f32 v20, v20
    v_exp_f32 v21, v21
    v_exp_f32 v22, v22
    v_exp_f32 v23, v23
    v_pk_mul_f32 v[180:181], v[180:181], v[28:29]
    v_pk_add_f32 v[20:21], v[20:21], 1.0 op_sel_hi:[1,0]
    v_pk_add_f32 v[22:23], v[22:23], 1.0 op_sel_hi:[1,0]
    v_rcp_f32 v20, v20
    v_rcp_f32 v21, v21
    v_rcp_f32 v22, v22
    v_rcp_f32 v23, v23
    v_pk_mul_f32 v[182:183], v[182:183], v[30:31]
    v_pk_mul_f32 v[20:21], v[20:21], v[180:181]
    v_pk_mul_f32 v[22:23], v[22:23], v[182:183]
    v_cvt_pk_bf16_f32 v38, v20, v21
    v_cvt_pk_bf16_f32 v39, v22, v23
    v_accvgpr_read_b32 v28, a208
    v_accvgpr_read_b32 v29, a209
    v_permlane16_swap_b32 v36, v38
    v_permlane16_swap_b32 v37, v39
    buffer_store_dwordx4 v[36:39], v6, s[4:7], s49 offen offset:0 sc1
    v_accvgpr_read_b32 v30, a210
    v_accvgpr_read_b32 v31, a211
    v_pk_mul_f32 v[20:21], v[200:201], s[46:47]
    v_pk_mul_f32 v[22:23], v[202:203], s[46:47]
    v_exp_f32 v20, v20
    v_exp_f32 v21, v21
    v_exp_f32 v22, v22
    v_exp_f32 v23, v23
    v_pk_mul_f32 v[200:201], v[200:201], v[28:29]
    v_pk_add_f32 v[20:21], v[20:21], 1.0 op_sel_hi:[1,0]
    v_pk_add_f32 v[22:23], v[22:23], 1.0 op_sel_hi:[1,0]
    v_rcp_f32 v20, v20
    v_rcp_f32 v21, v21
    v_rcp_f32 v22, v22
    v_rcp_f32 v23, v23
    v_pk_mul_f32 v[202:203], v[202:203], v[30:31]
    v_pk_mul_f32 v[20:21], v[20:21], v[200:201]
    v_pk_mul_f32 v[22:23], v[22:23], v[202:203]
    v_cvt_pk_bf16_f32 v32, v20, v21
    v_cvt_pk_bf16_f32 v33, v22, v23
    v_accvgpr_read_b32 v28, a212
    v_accvgpr_read_b32 v29, a213
    v_accvgpr_read_b32 v30, a214
    v_accvgpr_read_b32 v31, a215
    v_pk_mul_f32 v[20:21], v[204:205], s[46:47]
    v_pk_mul_f32 v[22:23], v[206:207], s[46:47]
    v_exp_f32 v20, v20
    v_exp_f32 v21, v21
    v_exp_f32 v22, v22
    v_exp_f32 v23, v23
    v_pk_mul_f32 v[204:205], v[204:205], v[28:29]
    v_pk_add_f32 v[20:21], v[20:21], 1.0 op_sel_hi:[1,0]
    v_pk_add_f32 v[22:23], v[22:23], 1.0 op_sel_hi:[1,0]
    v_rcp_f32 v20, v20
    v_rcp_f32 v21, v21
    v_rcp_f32 v22, v22
    v_rcp_f32 v23, v23
    v_pk_mul_f32 v[206:207], v[206:207], v[30:31]
    v_pk_mul_f32 v[20:21], v[20:21], v[204:205]
    v_pk_mul_f32 v[22:23], v[22:23], v[206:207]
    v_cvt_pk_bf16_f32 v34, v20, v21
    v_cvt_pk_bf16_f32 v35, v22, v23
    v_accvgpr_read_b32 v28, a224
    v_accvgpr_read_b32 v29, a225
    v_permlane16_swap_b32 v32, v34
    v_permlane16_swap_b32 v33, v35
    buffer_store_dwordx4 v[32:35], v6, s[4:7], s49 offen offset:1024 sc1
    v_accvgpr_read_b32 v30, a226
    v_accvgpr_read_b32 v31, a227
    v_pk_mul_f32 v[20:21], v[224:225], s[46:47]
    v_pk_mul_f32 v[22:23], v[226:227], s[46:47]
    v_exp_f32 v20, v20
    v_exp_f32 v21, v21
    v_exp_f32 v22, v22
    v_exp_f32 v23, v23
    v_pk_mul_f32 v[224:225], v[224:225], v[28:29]
    v_pk_add_f32 v[20:21], v[20:21], 1.0 op_sel_hi:[1,0]
    v_pk_add_f32 v[22:23], v[22:23], 1.0 op_sel_hi:[1,0]
    v_rcp_f32 v20, v20
    v_rcp_f32 v21, v21
    v_rcp_f32 v22, v22
    v_rcp_f32 v23, v23
    v_pk_mul_f32 v[226:227], v[226:227], v[30:31]
    v_pk_mul_f32 v[20:21], v[20:21], v[224:225]
    v_pk_mul_f32 v[22:23], v[22:23], v[226:227]
    v_cvt_pk_bf16_f32 v36, v20, v21
    v_cvt_pk_bf16_f32 v37, v22, v23
    v_accvgpr_read_b32 v28, a228
    v_accvgpr_read_b32 v29, a229
    v_accvgpr_read_b32 v30, a230
    v_accvgpr_read_b32 v31, a231
    v_pk_mul_f32 v[20:21], v[228:229], s[46:47]
    v_pk_mul_f32 v[22:23], v[230:231], s[46:47]
    v_exp_f32 v20, v20
    v_exp_f32 v21, v21
    v_exp_f32 v22, v22
    v_exp_f32 v23, v23
    v_pk_mul_f32 v[228:229], v[228:229], v[28:29]
    v_pk_add_f32 v[20:21], v[20:21], 1.0 op_sel_hi:[1,0]
    v_pk_add_f32 v[22:23], v[22:23], 1.0 op_sel_hi:[1,0]
    v_rcp_f32 v20, v20
    v_rcp_f32 v21, v21
    v_rcp_f32 v22, v22
    v_rcp_f32 v23, v23
    v_pk_mul_f32 v[230:231], v[230:231], v[30:31]
    v_pk_mul_f32 v[20:21], v[20:21], v[228:229]
    v_pk_mul_f32 v[22:23], v[22:23], v[230:231]
    v_cvt_pk_bf16_f32 v38, v20, v21
    v_cvt_pk_bf16_f32 v39, v22, v23
    v_accvgpr_read_b32 v28, a240
    v_accvgpr_read_b32 v29, a241
    v_permlane16_swap_b32 v36, v38
    v_permlane16_swap_b32 v37, v39
    buffer_store_dwordx4 v[36:39], v6, s[4:7], s49 offen offset:2048 sc1
    v_accvgpr_read_b32 v30, a242
    v_accvgpr_read_b32 v31, a243
    v_pk_mul_f32 v[20:21], v[248:249], s[46:47]
    v_pk_mul_f32 v[22:23], v[250:251], s[46:47]
    v_exp_f32 v20, v20
    v_exp_f32 v21, v21
    v_exp_f32 v22, v22
    v_exp_f32 v23, v23
    v_pk_mul_f32 v[248:249], v[248:249], v[28:29]
    v_pk_add_f32 v[20:21], v[20:21], 1.0 op_sel_hi:[1,0]
    v_pk_add_f32 v[22:23], v[22:23], 1.0 op_sel_hi:[1,0]
    v_rcp_f32 v20, v20
    v_rcp_f32 v21, v21
    v_rcp_f32 v22, v22
    v_rcp_f32 v23, v23
    v_pk_mul_f32 v[250:251], v[250:251], v[30:31]
    v_pk_mul_f32 v[20:21], v[20:21], v[248:249]
    v_pk_mul_f32 v[22:23], v[22:23], v[250:251]
    v_cvt_pk_bf16_f32 v32, v20, v21
    v_cvt_pk_bf16_f32 v33, v22, v23
    v_accvgpr_read_b32 v28, a244
    v_accvgpr_read_b32 v29, a245
    v_accvgpr_read_b32 v30, a246
    v_accvgpr_read_b32 v31, a247
    v_pk_mul_f32 v[20:21], v[252:253], s[46:47]
    v_pk_mul_f32 v[22:23], v[254:255], s[46:47]
    v_exp_f32 v20, v20
    v_exp_f32 v21, v21
    v_exp_f32 v22, v22
    v_exp_f32 v23, v23
    v_pk_mul_f32 v[252:253], v[252:253], v[28:29]
    v_pk_add_f32 v[20:21], v[20:21], 1.0 op_sel_hi:[1,0]
    v_pk_add_f32 v[22:23], v[22:23], 1.0 op_sel_hi:[1,0]
    v_rcp_f32 v20, v20
    v_rcp_f32 v21, v21
    v_rcp_f32 v22, v22
    v_rcp_f32 v23, v23
    v_pk_mul_f32 v[254:255], v[254:255], v[30:31]
    v_pk_mul_f32 v[20:21], v[20:21], v[252:253]
    v_pk_mul_f32 v[22:23], v[22:23], v[254:255]
    v_cvt_pk_bf16_f32 v34, v20, v21
    v_cvt_pk_bf16_f32 v35, v22, v23
    s_nop 1
    v_permlane16_swap_b32 v32, v34
    v_permlane16_swap_b32 v33, v35
    buffer_store_dwordx4 v[32:35], v6, s[4:7], s49 offen offset:3072 sc1
    s_mov_b32 s50, s49
    s_branch Lf_epi_done
Lf_epiY:
    s_nop 7
    v_cvt_pk_bf16_f32 v36, v64, v65
    v_cvt_pk_bf16_f32 v37, v66, v67
    v_cvt_pk_bf16_f32 v38, v68, v69
    v_cvt_pk_bf16_f32 v39, v70, v71
    v_cvt_pk_bf16_f32 v32, v72, v73
    v_cvt_pk_bf16_f32 v33, v74, v75
    v_permlane16_swap_b32 v36, v38
    v_permlane16_swap_b32 v37, v39
    buffer_store_dwordx4 v[36:39], v5, s[4:7], s51 offen offset:0 sc1
    v_accvgpr_read_b32 v28, a144
    v_accvgpr_read_b32 v29, a145
    v_accvgpr_read_b32 v30, a146
    v_accvgpr_read_b32 v31, a147
    v_cvt_pk_bf16_f32 v34, v28, v29
    v_cvt_pk_bf16_f32 v35, v30, v31
    v_cvt_pk_bf16_f32 v36, v92, v93
    v_cvt_pk_bf16_f32 v37, v94, v95
    v_permlane16_swap_b32 v32, v34
    v_permlane16_swap_b32 v33, v35
    buffer_store_dwordx4 v[32:35], v5, s[4:7], s52 offen offset:0 sc1
    v_cvt_pk_bf16_f32 v38, v96, v97
    v_cvt_pk_bf16_f32 v39, v98, v99
    v_cvt_pk_bf16_f32 v32, v100, v101
    v_cvt_pk_bf16_f32 v33, v102, v103
    v_permlane16_swap_b32 v36, v38
    v_permlane16_swap_b32 v37, v39
    buffer_store_dwordx4 v[36:39], v5, s[4:7], s51 offen offset:1024 sc1
    v_accvgpr_read_b32 v28, a156
    v_accvgpr_read_b32 v29, a157
    v_accvgpr_read_b32 v30, a158
    v_accvgpr_read_b32 v31, a159
    v_cvt_pk_bf16_f32 v34, v28, v29
    v_cvt_pk_bf16_f32 v35, v30, v31
    v_cvt_pk_bf16_f32 v36, v120, v121
    v_cvt_pk_bf16_f32 v37, v122, v123
    v_permlane16_swap_b32 v32, v34
    v_permlane16_swap_b32 v33, v35
    buffer_store_dwordx4 v[32:35], v5, s[4:7], s52 offen offset:1024 sc1
    v_cvt_pk_bf16_f32 v38, v124, v125
    v_cvt_pk_bf16_f32 v39, v126, v127
    v_cvt_pk_bf16_f32 v32, v128, v129
    v_cvt_pk_bf16_f32 v33, v130, v131
    v_permlane16_swap_b32 v36, v38
    v_permlane16_swap_b32 v37, v39
    buffer_store_dwordx4 v[36:39], v5, s[4:7], s51 offen offset:2048 sc1
    v_accvgpr_read_b32 v28, a168
    v_accvgpr_read_b32 v29, a169
    v_accvgpr_read_b32 v30, a170
    v_accvgpr_read_b32 v31, a171
    v_cvt_pk_bf16_f32 v34, v28, v29
    v_cvt_pk_bf16_f32 v35, v30, v31
    v_cvt_pk_bf16_f32 v36, v148, v149
    v_cvt_pk_bf16_f32 v37, v150, v151
    v_permlane16_swap_b32 v32, v34
    v_permlane16_swap_b32 v33, v35
    buffer_store_dwordx4 v[32:35], v5, s[4:7], s52 offen offset:2048 sc1
    v_cvt_pk_bf16_f32 v38, v152, v153
    v_cvt_pk_bf16_f32 v39, v154, v155
    v_cvt_pk_bf16_f32 v32, v156, v157
    v_cvt_pk_bf16_f32 v33, v158, v159
    v_permlane16_swap_b32 v36, v38
    v_permlane16_swap_b32 v37, v39
    buffer_store_dwordx4 v[36:39], v5, s[4:7], s51 offen offset:3072 sc1
    v_accvgpr_read_b32 v28, a180
    v_accvgpr_read_b32 v29, a181
    v_accvgpr_read_b32 v30, a182
    v_accvgpr_read_b32 v31, a183
    v_cvt_pk_bf16_f32 v34, v28, v29
    v_cvt_pk_bf16_f32 v35, v30, v31
    v_cvt_pk_bf16_f32 v36, v176, v177
    v_cvt_pk_bf16_f32 v37, v178, v179
    v_permlane16_swap_b32 v32, v34
    v_permlane16_swap_b32 v33, v35
    buffer_store_dwordx4 v[32:35], v5, s[4:7], s52 offen offset:3072 sc1
    v_cvt_pk_bf16_f32 v38, v180, v181
    v_cvt_pk_bf16_f32 v39, v182, v183
    v_accvgpr_read_b32 v24, a192
    v_accvgpr_read_b32 v25, a193
    v_permlane16_swap_b32 v36, v38
    v_permlane16_swap_b32 v37, v39
    buffer_store_dwordx4 v[36:39], v6, s[4:7], s51 offen offset:0 sc1
    v_accvgpr_read_b32 v26, a194
    v_accvgpr_read_b32 v27, a195
    v_cvt_pk_bf16_f32 v32, v24, v25
    v_cvt_pk_bf16_f32 v33, v26, v27
    v_accvgpr_read_b32 v28, a196
    v_accvgpr_read_b32 v29, a197
    v_accvgpr_read_b32 v30, a198
    v_accvgpr_read_b32 v31, a199
    v_cvt_pk_bf16_f32 v34, v28, v29
    v_cvt_pk_bf16_f32 v35, v30, v31
    v_cvt_pk_bf16_f32 v36, v200, v201
    v_cvt_pk_bf16_f32 v37, v202, v203
    v_permlane16_swap_b32 v32, v34
    v_permlane16_swap_b32 v33, v35
    buffer_store_dwordx4 v[32:35], v6, s[4:7], s52 offen offset:0 sc1
    v_cvt_pk_bf16_f32 v38, v204, v205
    v_cvt_pk_bf16_f32 v39, v206, v207
    v_accvgpr_read_b32 v24, a208
    v_accvgpr_read_b32 v25, a209
    v_permlane16_swap_b32 v36, v38
    v_permlane16_swap_b32 v37, v39
    buffer_store_dwordx4 v[36:39], v6, s[4:7], s51 offen offset:1024 sc1
    v_accvgpr_read_b32 v26, a210
    v_accvgpr_read_b32 v27, a211
    v_cvt_pk_bf16_f32 v32, v24, v25
    v_cvt_pk_bf16_f32 v33, v26, v27
    v_accvgpr_read_b32 v28, a212
    v_accvgpr_read_b32 v29, a213
    v_accvgpr_read_b32 v30, a214
    v_accvgpr_read_b32 v31, a215
    v_cvt_pk_bf16_f32 v34, v28, v29
    v_cvt_pk_bf16_f32 v35, v30, v31
    v_cvt_pk_bf16_f32 v36, v224, v225
    v_cvt_pk_bf16_f32 v37, v226, v227
    v_permlane16_swap_b32 v32, v34
    v_permlane16_swap_b32 v33, v35
    buffer_store_dwordx4 v[32:35], v6, s[4:7], s52 offen offset:1024 sc1
    v_cvt_pk_bf16_f32 v38, v228, v229
    v_cvt_pk_bf16_f32 v39, v230, v231
    v_accvgpr_read_b32 v24, a224
    v_accvgpr_read_b32 v25, a225
    v_permlane16_swap_b32 v36, v38
    v_permlane16_swap_b32 v37, v39
    buffer_store_dwordx4 v[36:39], v6, s[4:7], s51 offen offset:2048 sc1
    v_accvgpr_read_b32 v26, a226
    v_accvgpr_read_b32 v27, a227
    v_cvt_pk_bf16_f32 v32, v24, v25
    v_cvt_pk_bf16_f32 v33, v26, v27
    v_accvgpr_read_b32 v28, a228
    v_accvgpr_read_b32 v29, a229
    v_accvgpr_read_b32 v30, a230
    v_accvgpr_read_b32 v31, a231
    v_cvt_pk_bf16_f32 v34, v28, v29
    v_cvt_pk_bf16_f32 v35, v30, v31
    v_cvt_pk_bf16_f32 v36, v248, v249
    v_cvt_pk_bf16_f32 v37, v250, v251
    v_permlane16_swap_b32 v32, v34
    v_permlane16_swap_b32 v33, v35
    buffer_store_dwordx4 v[32:35], v6, s[4:7], s52 offen offset:2048 sc1
    v_cvt_pk_bf16_f32 v38, v252, v253
    v_cvt_pk_bf16_f32 v39, v254, v255
    v_accvgpr_read_b32 v24, a240
    v_accvgpr_read_b32 v25, a241
    v_permlane16_swap_b32 v36, v38
    v_permlane16_swap_b32 v37, v39
    buffer_store_dwordx4 v[36:39], v6, s[4:7], s51 offen offset:3072 sc1
    v_accvgpr_read_b32 v26, a242
    v_accvgpr_read_b32 v27, a243
    v_cvt_pk_bf16_f32 v32, v24, v25
    v_cvt_pk_bf16_f32 v33, v26, v27
    v_accvgpr_read_b32 v28, a244
    v_accvgpr_read_b32 v29, a245
    v_accvgpr_read_b32 v30, a246
    v_accvgpr_read_b32 v31, a247
    v_cvt_pk_bf16_f32 v34, v28, v29
    v_cvt_pk_bf16_f32 v35, v30, v31
    s_nop 1
    v_permlane16_swap_b32 v32, v34
    v_permlane16_swap_b32_e64 v33, v35
    buffer_store_dwordx4 v[32:35], v6, s[4:7], s52 offen offset:3072 sc1
    v_pk_mul_f32 v[20:21], v[80:81], s[46:47]
    v_pk_mul_f32 v[22:23], v[82:83], s[46:47]
    v_permlane16_swap_b32 v48, v50
    v_permlane16_swap_b32 v49, v51
    buffer_store_dwordx4 v[48:51], v5, s[4:7], s48 offen offset:0 sc1
    v_exp_f32 v20, v20
    v_exp_f32 v21, v21
    v_exp_f32 v22, v22
    v_exp_f32 v23, v23
    v_pk_mul_f32 v[80:81], v[80:81], v[88:89]
    v_pk_add_f32 v[20:21], v[20:21], 1.0 op_sel_hi:[1,0]
    v_pk_add_f32 v[22:23], v[22:23], 1.0 op_sel_hi:[1,0]
    v_rcp_f32 v20, v20
    v_rcp_f32 v21, v21
    v_rcp_f32 v22, v22
    v_rcp_f32 v23, v23
    v_pk_mul_f32 v[82:83], v[82:83], v[90:91]
    v_pk_mul_f32 v[20:21], v[20:21], v[80:81]
    v_pk_mul_f32 v[22:23], v[22:23], v[82:83]
    v_cvt_pk_bf16_f32 v78, v20, v21
    v_cvt_pk_bf16_f32 v79, v22, v23
    v_pk_mul_f32 v[20:21], v[108:109], s[46:47]
    v_pk_mul_f32 v[22:23], v[110:111], s[46:47]
    v_permlane16_swap_b32 v76, v78
    v_permlane16_swap_b32 v77, v79
    buffer_store_dwordx4 v[76:79], v5, s[4:7], s48 offen offset:1024 sc1
    v_exp_f32 v20, v20
    v_exp_f32 v21, v21
    v_exp_f32 v22, v22
    v_exp_f32 v23, v23
    v_pk_mul_f32 v[108:109], v[108:109], v[116:117]
    v_pk_add_f32 v[20:21], v[20:21], 1.0 op_sel_hi:[1,0]
    v_pk_add_f32 v[22:23], v[22:23], 1.0 op_sel_hi:[1,0]
    v_rcp_f32 v20, v20
    v_rcp_f32 v21, v21
    v_rcp_f32 v22, v22
    v_rcp_f32 v23, v23
    v_pk_mul_f32 v[110:111], v[110:111], v[118:119]
    v_pk_mul_f32 v[20:21], v[20:21], v[108:109]
    v_pk_mul_f32 v[22:23], v[22:23], v[110:111]
    v_cvt_pk_bf16_f32 v106, v20, v21
    v_cvt_pk_bf16_f32 v107, v22, v23
    v_pk_mul_f32 v[20:21], v[136:137], s[46:47]
    v_pk_mul_f32 v[22:23], v[138:139], s[46:47]
    v_permlane16_swap_b32 v104, v106
    v_permlane16_swap_b32 v105, v107
    buffer_store_dwordx4 v[104:107], v5, s[4:7], s48 offen offset:2048 sc1
    v_exp_f32 v20, v20
    v_exp_f32 v21, v21
    v_exp_f32 v22, v22
    v_exp_f32 v23, v23
    v_pk_mul_f32 v[136:137], v[136:137], v[144:145]
    v_pk_add_f32 v[20:21], v[20:21], 1.0 op_sel_hi:[1,0]
    v_pk_add_f32 v[22:23], v[22:23], 1.0 op_sel_hi:[1,0]
    v_rcp_f32 v20, v20
    v_rcp_f32 v21, v21
    v_rcp_f32 v22, v22
    v_rcp_f32 v23, v23
    v_pk_mul_f32 v[138:139], v[138:139], v[146:147]
    v_pk_mul_f32 v[20:21], v[20:21], v[136:137]
    v_pk_mul_f32 v[22:23], v[22:23], v[138:139]
    v_cvt_pk_bf16_f32 v134, v20, v21
    v_cvt_pk_bf16_f32 v135, v22, v23
    v_pk_mul_f32 v[20:21], v[164:165], s[46:47]
    v_pk_mul_f32 v[22:23], v[166:167], s[46:47]
    v_permlane16_swap_b32 v132, v134
    v_permlane16_swap_b32 v133, v135
    buffer_store_dwordx4 v[132:135], v5, s[4:7], s48 offen offset:3072 sc1
    v_exp_f32 v20, v20
    v_exp_f32 v21, v21
    v_exp_f32 v22, v22
    v_exp_f32 v23, v23
    v_pk_mul_f32 v[164:165], v[164:165], v[172:173]
    v_pk_add_f32 v[20:21], v[20:21], 1.0 op_sel_hi:[1,0]
    v_pk_add_f32 v[22:23], v[22:23], 1.0 op_sel_hi:[1,0]
    v_rcp_f32 v20, v20
    v_rcp_f32 v21, v21
    v_rcp_f32 v22, v22
    v_rcp_f32 v23, v23
    v_pk_mul_f32 v[166:167], v[166:167], v[174:175]
    v_pk_mul_f32 v[20:21], v[20:21], v[164:165]
    v_pk_mul_f32 v[22:23], v[22:23], v[166:167]
    v_cvt_pk_bf16_f32 v162, v20, v21
    v_cvt_pk_bf16_f32 v163, v22, v23
    v_pk_mul_f32 v[20:21], v[188:189], s[46:47]
    v_pk_mul_f32 v[22:23], v[190:191], s[46:47]
    v_permlane16_swap_b32 v160, v162
    v_permlane16_swap_b32 v161, v163
    buffer_store_dwordx4 v[160:163], v6, s[4:7], s48 offen offset:0 sc1
    v_exp_f32 v20, v20
    v_exp_f32 v21, v21
    v_exp_f32 v22, v22
    v_exp_f32 v23, v23
    v_pk_mul_f32 v[188:189], v[188:189], v[196:197]
    v_pk_add_f32 v[20:21], v[20:21], 1.0 op_sel_hi:[1,0]
    v_pk_add_f32 v[22:23], v[22:23], 1.0 op_sel_hi:[1,0]
    v_rcp_f32 v20, v20
    v_rcp_f32 v21, v21
    v_rcp_f32 v22, v22
    v_rcp_f32 v23, v23
    v_pk_mul_f32 v[190:191], v[190:191], v[198:199]
    v_pk_mul_f32 v[20:21], v[20:21], v[188:189]
    v_pk_mul_f32 v[22:23], v[22:23], v[190:191]
    v_cvt_pk_bf16_f32 v186, v20, v21
    v_cvt_pk_bf16_f32 v187, v22, v23
    v_pk_mul_f32 v[20:21], v[212:213], s[46:47]
    v_pk_mul_f32 v[22:23], v[214:215], s[46:47]
    v_permlane16_swap_b32 v184, v186
    v_permlane16_swap_b32 v185, v187
    buffer_store_dwordx4 v[184:187], v6, s[4:7], s48 offen offset:1024 sc1
    v_exp_f32 v20, v20
    v_exp_f32 v21, v21
    v_exp_f32 v22, v22
    v_exp_f32 v23, v23
    v_pk_mul_f32 v[212:213], v[212:213], v[220:221]
    v_pk_add_f32 v[20:21], v[20:21], 1.0 op_sel_hi:[1,0]
    v_pk_add_f32 v[22:23], v[22:23], 1.0 op_sel_hi:[1,0]
    v_rcp_f32 v20, v20
    v_rcp_f32 v21, v21
    v_rcp_f32 v22, v22
    v_rcp_f32 v23, v23
    v_pk_mul_f32 v[214:215], v[214:215], v[222:223]
    v_pk_mul_f32 v[20:21], v[20:21], v[212:213]
    v_pk_mul_f32 v[22:23], v[22:23], v[214:215]
    v_cvt_pk_bf16_f32 v210, v20, v21
    v_cvt_pk_bf16_f32 v211, v22, v23
    v_pk_mul_f32 v[20:21], v[236:237], s[46:47]
    v_pk_mul_f32 v[22:23], v[238:239], s[46:47]
    v_permlane16_swap_b32 v208, v210
    v_permlane16_swap_b32 v209, v211
    buffer_store_dwordx4 v[208:211], v6, s[4:7], s48 offen offset:2048 sc1
    v_exp_f32 v20, v20
    v_exp_f32 v21, v21
    v_exp_f32 v22, v22
    v_exp_f32 v23, v23
    v_pk_mul_f32 v[236:237], v[236:237], v[244:245]
    v_pk_add_f32 v[20:21], v[20:21], 1.0 op_sel_hi:[1,0]
    v_pk_add_f32 v[22:23], v[22:23], 1.0 op_sel_hi:[1,0]
    v_rcp_f32 v20, v20
    v_rcp_f32 v21, v21
    v_rcp_f32 v22, v22
    v_rcp_f32 v23, v23
    v_pk_mul_f32 v[238:239], v[238:239], v[246:247]
    v_pk_mul_f32 v[20:21], v[20:21], v[236:237]
    v_pk_mul_f32 v[22:23], v[22:23], v[238:239]
    v_cvt_pk_bf16_f32 v234, v20, v21
    v_cvt_pk_bf16_f32 v235, v22, v23
    s_waitcnt vmcnt(23)
    v_mov_b32 v28, 0
    v_mov_b32 v29, 0
    v_permlane16_swap_b32 v232, v234
    v_permlane16_swap_b32_e64 v233, v235
    buffer_store_dwordx4 v[232:235], v6, s[4:7], s48 offen offset:3072 sc1
    v_dot2_f32_bf16 v28, v56, v168, v28
    v_dot2_f32_bf16 v29, v112, v168, v29
    v_dot2_f32_bf16 v28, v57, v169, v28
    v_dot2_f32_bf16 v29, v113, v169, v29
    v_dot2_f32_bf16 v28, v58, v170, v28
    v_dot2_f32_bf16 v29, v114, v170, v29
    v_dot2_f32_bf16 v28, v59, v171, v28
    v_dot2_f32_bf16 v29, v115, v171, v29
    v_dot2_f32_bf16 v28, v84, v192, v28
    v_dot2_f32_bf16 v29, v140, v192, v29
    v_dot2_f32_bf16 v28, v85, v193, v28
    v_dot2_f32_bf16 v29, v141, v193, v29
    v_dot2_f32_bf16 v28, v86, v194, v28
    v_dot2_f32_bf16 v29, v142, v194, v29
    v_dot2_f32_bf16 v28, v87, v195, v28
    v_dot2_f32_bf16 v29, v143, v195, v29
    s_lshl_b32 s72, s2, 5
    s_lshl_b32 s73, s56, 3
    s_add_u32 s72, s72, s73
    s_add_u32 s72, s72, 50331648
    v_permlane32_swap_b32 v28, v29
    v_add_f32 v28, v28, v29
    v_mov_b32 v29, v28
    s_nop 1
    v_permlane16_swap_b32 v28, v29
    v_add_f32 v28, v28, v29
    s_nop 1
    v_add_f32_dpp v28, v28, v28 row_ror:8 row_mask:0xf bank_mask:0xf
    s_nop 1
    v_add_f32_dpp v28, v28, v28 row_ror:4 row_mask:0xf bank_mask:0xf
    s_nop 1
    v_add_f32_dpp v28, v28, v28 row_ror:2 row_mask:0xf bank_mask:0xf
    s_nop 1
    v_add_f32_dpp v28, v28, v28 row_ror:1 row_mask:0xf bank_mask:0xf
    v_mul_f32 v28, 0xbfb8aa3b, v28
    v_exp_f32 v28, v28
    v_lshrrev_b32 v3, 5, v2
    v_add_f32 v28, 1.0, v28
    v_rcp_f32 v4, v28
    v_lshlrev_b32 v3, 2, v3
    buffer_store_dword v4, v3, s[4:7], s72 offen sc1
    s_waitcnt vmcnt(9)
    s_mov_b64 exec, 1
    buffer_store_dword v40, v41, s[4:7], s63 offen sc1
    s_mov_b64 exec, -1
    s_mov_b64 exec, 1
    buffer_store_dword v40, v41, s[4:7], s67 offen sc1
    s_mov_b64 exec, -1
    s_mov_b32 s50, 67108864
Lf_epi_done:
    v_mov_b32 v0, v8
    s_lshl_b32 s72, s56, 12
    s_add_u32 s73, s72, 0
    v_add_u32 v29, s73, v18
    s_barrier
    ds_read_b128 a[0:3], v29 offset:0
    ds_read_b128 a[4:7], v29 offset:512
    ds_read_b128 a[64:67], v29 offset:16384
    ds_read_b128 a[68:71], v29 offset:16896
    ds_read_b128 a[8:11], v29 offset:2048
    ds_read_b128 a[12:15], v29 offset:2560
    ds_read_b128 a[16:19], v29 offset:4096
    ds_read_b128 a[20:23], v29 offset:4608
    ds_read_b128 a[24:27], v29 offset:6144
    ds_read_b128 a[28:31], v29 offset:6656
    ds_read_b128 a[32:35], v29 offset:8192
    ds_read_b128 a[36:39], v29 offset:8704
    ds_read_b128 a[40:43], v29 offset:10240
    ds_read_b128 a[44:47], v29 offset:10752
    ds_read_b128 a[48:51], v29 offset:12288
    ds_read_b128 a[52:55], v29 offset:12800
    ds_read_b128 a[56:59], v29 offset:14336
    ds_read_b128 a[60:63], v29 offset:14848
    ds_read_b128 a[72:75], v29 offset:18432
    ds_read_b128 a[76:79], v29 offset:18944
    v_bfe_u32 v31, v2, 2, 2
    v_lshl_add_u32 v31, v10, 2, v31
    v_bfe_u32 v34, v2, 4, 1
    v_bfe_u32 v33, v2, 1, 1
    v_lshl_add_u32 v34, v34, 1, v33
    v_lshl_add_u32 v31, v34, 2, v31
    v_and_b32 v31, 15, v31
    v_lshlrev_b32 v31, 4, v31
    v_lshl_add_u32 v31, v34, 8, v31
    v_and_b32_e64 v33, 1, v2
    v_lshl_add_u32 v31, v33, 3, v31
    s_add_u32 s73, s72, 32768
    v_add_u32 v31, s73, v31
    v_xor_b32 v30, 128, v31
    v_lshrrev_b32 v34, 2, v2
    v_lshrrev_b32 v35, 4, v2
    v_xor_b32 v34, v34, v35
    v_and_b32 v34, 1, v34
    v_subrev_u32 v34, 1, v34
    v_and_b32 v34, 0x3f803f80, v34
    v_accvgpr_write_b32 a160, v34
    v_accvgpr_write_b32 a161, v34
    v_accvgpr_write_b32 a162, v34
    v_accvgpr_write_b32 a163, v34
    s_lshl_b32 s48, s56, 1
    s_sub_u32 s48, 8, s48
    s_cmp_eq_u32 s58, 0
    s_cselect_b32 s48, s48, 0
    s_sub_u32 s49, s48, 1
    s_mov_b32 s46, 0x3e8293ee
    s_mov_b32 s47, 0x3e8293ee
    v_mov_b32 v33, 0xf149f2ca
    s_waitcnt lgkmcnt(0)
    v_mfma_f32_32x32x16_bf16 v[40:55], a[0:3], a[232:235], 0
    v_and_b32 v36, 31, v2
    v_lshlrev_b32 v37, 2, v10
    v_sub_u32_e64 v37, v36, v37
    v_cmp_gt_i32 s[16:17], 0, v37
    v_cmp_gt_i32 s[18:19], 1, v37
    v_cmp_gt_i32 s[20:21], 2, v37
    v_mfma_f32_32x32x16_bf16 v[40:55], a[4:7], a[236:239], v[40:55]
    v_cmp_gt_i32 s[22:23], 3, v37
    v_cmp_gt_i32 s[24:25], 8, v37
    v_cmp_gt_i32 s[26:27], 9, v37
    v_cmp_gt_i32 s[28:29], 10, v37
    v_cmp_gt_i32 s[30:31], 11, v37
    v_cmp_gt_i32 s[32:33], 16, v37
    v_mfma_f32_32x32x16_bf16 v[168:183], a[64:67], a[232:235], 0
    v_cmp_gt_i32 s[34:35], 17, v37
    v_cmp_gt_i32 s[36:37], 18, v37
    v_cmp_gt_i32 s[38:39], 19, v37
    v_cmp_gt_i32 s[60:61], 24, v37
    v_cmp_gt_i32 s[66:67], 25, v37
    v_cmp_gt_i32 s[74:75], 26, v37
    v_mfma_f32_32x32x16_bf16 v[168:183], a[68:71], a[236:239], v[168:183]
    v_cmp_gt_i32 s[78:79], 27, v37
    v_mov_b32 v36, 0xffff
    v_mov_b32 v37, 0xffff0000
    v_cndmask_b32 v34, 0, v36, s[16:17]
    v_cndmask_b32 v35, 0, v37, s[18:19]
    v_or_b32_e64 v20, v34, v35
    v_mfma_f32_32x32x16_bf16 v[56:71], a[8:11], a[232:235], 0
    v_cndmask_b32 v34, 0, v36, s[20:21]
    v_cndmask_b32 v35, 0, v37, s[22:23]
    v_or_b32_e64 v21, v34, v35
    v_cndmask_b32 v34, 0, v36, s[24:25]
    v_cndmask_b32 v35, 0, v37, s[26:27]
    v_or_b32_e64 v22, v34, v35
    v_mfma_f32_32x32x16_bf16 v[56:71], a[12:15], a[236:239], v[56:71]
    v_cndmask_b32 v34, 0, v36, s[28:29]
    v_cndmask_b32 v35, 0, v37, s[30:31]
    v_or_b32_e64 v23, v34, v35
    v_cndmask_b32 v34, 0, v36, s[32:33]
    v_cndmask_b32 v35, 0, v37, s[34:35]
    v_or_b32_e64 v24, v34, v35
    v_mfma_f32_32x32x16_bf16 v[72:87], a[16:19], a[232:235], 0
    v_cndmask_b32 v34, 0, v36, s[36:37]
    v_cndmask_b32 v35, 0, v37, s[38:39]
    v_or_b32_e64 v25, v34, v35
    v_cndmask_b32 v34, 0, v36, s[60:61]
    v_cndmask_b32 v35, 0, v37, s[66:67]
    v_or_b32_e64 v26, v34, v35
    v_mfma_f32_32x32x16_bf16 v[72:87], a[20:23], a[236:239], v[72:87]
    v_cndmask_b32 v34, 0, v36, s[74:75]
    v_cndmask_b32 v35, 0, v37, s[78:79]
    v_or_b32 v27, v34, v35
    s_cmp_gt_i32 s48, 0
    s_cbranch_scc1 Lf_m0_0
Lf_nm0_0:
    v_cndmask_b32 v40, v168, v40, s[16:17]
    v_cndmask_b32 v41, v169, v41, s[18:19]
    v_cndmask_b32 v42, v170, v42, s[20:21]
    v_cndmask_b32 v43, v171, v43, s[22:23]
    v_cndmask_b32 v44, v172, v44, s[24:25]
    v_cndmask_b32 v45, v173, v45, s[26:27]
    v_cndmask_b32 v46, v174, v46, s[28:29]
    v_cndmask_b32 v47, v175, v47, s[30:31]
    v_cndmask_b32 v48, v176, v48, s[32:33]
    v_cndmask_b32 v49, v177, v49, s[34:35]
    v_cndmask_b32 v50, v178, v50, s[36:37]
    v_cndmask_b32 v51, v179, v51, s[38:39]
    v_cndmask_b32 v52, v180, v52, s[60:61]
    v_cndmask_b32 v53, v181, v53, s[66:67]
    v_cndmask_b32 v54, v182, v54, s[74:75]
    v_cndmask_b32 v55, v183, v55, s[78:79]
    v_max_f32 v34, v40, v41
    v_max_f32_e64 v35, v42, v43
    v_max3_f32 v34, v34, v44, v45
    v_max3_f32 v35, v35, v46, v47
    v_max3_f32 v34, v34, v48, v49
    v_max3_f32 v35, v35, v50, v51
    v_max3_f32 v34, v34, v52, v53
    v_max3_f32 v35, v35, v54, v55
    v_mfma_f32_32x32x16_bf16 v[88:103], a[24:27], a[232:235], 0
    v_mfma_f32_32x32x16_bf16 v[88:103], a[28:31], a[236:239], v[88:103]
    s_cmp_gt_i32 s48, 1
    s_cbranch_scc1 Lf_m0_1
Lf_nm0_1:
    v_max3_f32 v34, v34, v56, v57
    v_max3_f32 v35, v35, v58, v59
    v_max3_f32 v34, v34, v60, v61
    v_max3_f32 v35, v35, v62, v63
    v_max3_f32 v34, v34, v64, v65
    v_max3_f32 v35, v35, v66, v67
    v_max3_f32 v34, v34, v68, v69
    v_max3_f32 v35, v35, v70, v71
    v_mfma_f32_32x32x16_bf16 v[104:119], a[32:35], a[232:235], 0
    v_mfma_f32_32x32x16_bf16 v[104:119], a[36:39], a[236:239], v[104:119]
    s_cmp_gt_i32 s48, 2
    s_cbranch_scc1 Lf_m0_2
Lf_nm0_2:
    v_max3_f32 v34, v34, v72, v73
    v_max3_f32 v35, v35, v74, v75
    v_max3_f32 v34, v34, v76, v77
    v_max3_f32 v35, v35, v78, v79
    v_max3_f32 v34, v34, v80, v81
    v_max3_f32 v35, v35, v82, v83
    v_max3_f32 v34, v34, v84, v85
    v_max3_f32 v35, v35, v86, v87
    v_mfma_f32_32x32x16_bf16 v[120:135], a[40:43], a[232:235], 0
    v_mfma_f32_32x32x16_bf16 v[120:135], a[44:47], a[236:239], v[120:135]
    s_cmp_gt_i32 s48, 3
    s_cbranch_scc1 Lf_m0_3
Lf_nm0_3:
    v_max3_f32 v34, v34, v88, v89
    v_max3_f32 v35, v35, v90, v91
    v_max3_f32 v34, v34, v92, v93
    v_max3_f32 v35, v35, v94, v95
    v_max3_f32 v34, v34, v96, v97
    v_max3_f32 v35, v35, v98, v99
    v_max3_f32 v34, v34, v100, v101
    v_max3_f32 v35, v35, v102, v103
    v_mfma_f32_32x32x16_bf16 v[136:151], a[48:51], a[232:235], 0
    v_mfma_f32_32x32x16_bf16 v[136:151], a[52:55], a[236:239], v[136:151]
    s_cmp_gt_i32 s48, 4
    s_cbranch_scc1 Lf_m0_4
Lf_nm0_4:
    v_max3_f32 v34, v34, v104, v105
    v_max3_f32 v35, v35, v106, v107
    v_max3_f32 v34, v34, v108, v109
    v_max3_f32 v35, v35, v110, v111
    v_max3_f32 v34, v34, v112, v113
    v_max3_f32 v35, v35, v114, v115
    v_max3_f32 v34, v34, v116, v117
    v_max3_f32 v35, v35, v118, v119
    v_mfma_f32_32x32x16_bf16 v[152:167], a[56:59], a[232:235], 0
    v_mfma_f32_32x32x16_bf16 v[152:167], a[60:63], a[236:239], v[152:167]
    s_cmp_gt_i32 s48, 5
    s_cbranch_scc1 Lf_m0_5
Lf_nm0_5:
    v_max3_f32 v34, v34, v120, v121
    v_max3_f32 v35, v35, v122, v123
    v_max3_f32 v34, v34, v124, v125
    v_max3_f32 v35, v35, v126, v127
    v_max3_f32 v34, v34, v128, v129
    v_max3_f32 v35, v35, v130, v131
    v_max3_f32 v34, v34, v132, v133
    v_max3_f32 v35, v35, v134, v135
    s_cmp_gt_i32 s48, 6
    s_cbranch_scc1 Lf_m0_6
Lf_nm0_6:
    v_max3_f32 v34, v34, v136, v137
    v_max3_f32 v35, v35, v138, v139
    v_max3_f32 v34, v34, v140, v141
    v_max3_f32 v35, v35, v142, v143
    v_max3_f32 v34, v34, v144, v145
    v_max3_f32 v35, v35, v146, v147
    v_max3_f32 v34, v34, v148, v149
    v_max3_f32 v35, v35, v150, v151
    s_nop 1
    s_cmp_gt_i32 s48, 7
    s_cbranch_scc1 Lf_m0_7
Lf_nm0_7:
    v_max3_f32 v34, v34, v152, v153
    v_max3_f32 v35, v35, v154, v155
    v_max3_f32 v34, v34, v156, v157
    v_max3_f32 v35, v35, v158, v159
    v_max3_f32 v34, v34, v160, v161
    v_max3_f32 v35, v35, v162, v163
    v_max3_f32 v34, v34, v164, v165
    v_max3_f32 v35, v35, v166, v167
    v_max_f32 v34, v34, v35
    v_mov_b32 v35, v34
    s_nop 1
    v_permlane32_swap_b32 v34, v35
    v_max_f32 v34, v34, v35
    v_mul_f32 v34, s46, v34
    v_sub_f32 v34, 0, v34
    v_mov_b32 v35, v34
    v_lshrrev_b32 v29, 1, v2
    v_lshlrev_b32 v29, 7, v29
    v_and_b32 v3, 1, v2
    v_lshl_add_u32 v29, v3, 3, v29
    s_add_u32 s65, s65, 16777216
    v_lshlrev_b32_e64 v3, 7, v2
    v_pk_fma_f32 v[40:41], v[40:41], s[46:47], v[34:35]
    v_pk_fma_f32 v[42:43], v[42:43], s[46:47], v[34:35]
    v_pk_fma_f32 v[44:45], v[44:45], s[46:47], v[34:35]
    v_pk_fma_f32 v[46:47], v[46:47], s[46:47], v[34:35]
    v_pk_fma_f32 v[48:49], v[48:49], s[46:47], v[34:35]
    v_pk_fma_f32 v[50:51], v[50:51], s[46:47], v[34:35]
    v_pk_fma_f32 v[52:53], v[52:53], s[46:47], v[34:35]
    v_pk_fma_f32 v[54:55], v[54:55], s[46:47], v[34:35]
    v_mfma_f32_32x32x16_bf16 v[168:183], a[8:11], a[248:251], 0
    v_exp_f32 v40, v40
    v_exp_f32 v41, v41
    v_exp_f32 v42, v42
    v_exp_f32 v43, v43
    v_exp_f32 v44, v44
    v_exp_f32 v45, v45
    v_exp_f32 v46, v46
    v_exp_f32 v47, v47
    v_mfma_f32_32x32x16_bf16 v[168:183], a[12:15], a[252:255], v[168:183]
    v_exp_f32 v48, v48
    v_exp_f32 v49, v49
    v_exp_f32 v50, v50
    v_exp_f32 v51, v51
    v_exp_f32 v52, v52
    v_exp_f32 v53, v53
    v_exp_f32 v54, v54
    v_exp_f32 v55, v55
    v_cvt_pk_bf16_f32 v40, v40, v41
    v_cvt_pk_bf16_f32 v41, v42, v43
    v_cvt_pk_bf16_f32 v42, v44, v45
    v_cvt_pk_bf16_f32 v43, v46, v47
    v_cvt_pk_bf16_f32 v44, v48, v49
    v_cvt_pk_bf16_f32 v45, v50, v51
    v_cvt_pk_bf16_f32 v46, v52, v53
    v_cvt_pk_bf16_f32 v47, v54, v55
    v_bfi_b32 v8, v20, 0, v40
    v_and_b32 v248, v20, v40
    v_bfi_b32 v9, v21, 0, v41
    v_and_b32 v249, v21, v41
    v_bfi_b32 v10, v22, 0, v42
    v_and_b32 v250, v22, v42
    v_bfi_b32 v11, v23, 0, v43
    v_and_b32 v251, v23, v43
    v_bfi_b32 v12, v24, 0, v44
    v_and_b32 v252, v24, v44
    v_bfi_b32 v13, v25, 0, v45
    v_and_b32 v253, v25, v45
    v_bfi_b32 v14, v26, 0, v46
    v_and_b32 v254, v26, v46
    v_bfi_b32 v15, v27, 0, v47
    v_and_b32 v255, v27, v47
    v_pk_fma_f32 v[56:57], v[56:57], s[46:47], v[34:35]
    v_pk_fma_f32 v[58:59], v[58:59], s[46:47], v[34:35]
    v_pk_fma_f32 v[60:61], v[60:61], s[46:47], v[34:35]
    v_pk_fma_f32 v[62:63], v[62:63], s[46:47], v[34:35]
    v_pk_fma_f32 v[64:65], v[64:65], s[46:47], v[34:35]
    v_pk_fma_f32 v[66:67], v[66:67], s[46:47], v[34:35]
    v_pk_fma_f32 v[68:69], v[68:69], s[46:47], v[34:35]
    v_pk_fma_f32 v[70:71], v[70:71], s[46:47], v[34:35]
    v_mfma_f32_16x16x32_bf16 a[164:167], a[160:163], v[40:43], 0
    v_exp_f32 v56, v56
    v_exp_f32 v57, v57
    v_exp_f32 v58, v58
    v_exp_f32 v59, v59
    v_mfma_f32_16x16x32_bf16 a[164:167], a[160:163], v[44:47], a[164:167]
    v_exp_f32 v60, v60
    v_exp_f32 v61, v61
    v_exp_f32 v62, v62
    v_exp_f32 v63, v63
    v_mfma_f32_32x32x16_bf16 v[184:199], a[72:75], a[248:251], 0
    v_exp_f32 v64, v64
    v_exp_f32 v65, v65
    v_exp_f32 v66, v66
    v_exp_f32 v67, v67
    v_mfma_f32_32x32x16_bf16 v[184:199], a[76:79], a[252:255], v[184:199]
    v_exp_f32 v68, v68
    v_exp_f32 v69, v69
    v_exp_f32 v70, v70
    v_exp_f32 v71, v71
    v_cvt_pk_bf16_f32 v48, v56, v57
    v_cvt_pk_bf16_f32 v49, v58, v59
    v_cvt_pk_bf16_f32 v50, v60, v61
    v_cvt_pk_bf16_f32 v51, v62, v63
    v_cvt_pk_bf16_f32 v52, v64, v65
    v_cvt_pk_bf16_f32 v53, v66, v67
    v_cvt_pk_bf16_f32 v54, v68, v69
    v_cvt_pk_bf16_f32 v55, v70, v71
    v_pk_fma_f32 v[72:73], v[72:73], s[46:47], v[34:35]
    v_pk_fma_f32 v[74:75], v[74:75], s[46:47], v[34:35]
    v_pk_fma_f32 v[76:77], v[76:77], s[46:47], v[34:35]
    v_pk_fma_f32 v[78:79], v[78:79], s[46:47], v[34:35]
    v_pk_fma_f32 v[80:81], v[80:81], s[46:47], v[34:35]
    v_pk_fma_f32 v[82:83], v[82:83], s[46:47], v[34:35]
    v_pk_fma_f32 v[84:85], v[84:85], s[46:47], v[34:35]
    v_pk_fma_f32 v[86:87], v[86:87], s[46:47], v[34:35]
    v_mfma_f32_16x16x32_bf16 a[164:167], a[160:163], v[48:51], a[164:167]
    v_exp_f32 v72, v72
    v_exp_f32 v73, v73
    v_exp_f32 v74, v74
    v_exp_f32 v75, v75
    v_mfma_f32_16x16x32_bf16 a[164:167], a[160:163], v[52:55], a[164:167]
    v_exp_f32 v76, v76
    v_exp_f32 v77, v77
    v_exp_f32 v78, v78
    v_exp_f32 v79, v79
    v_mfma_f32_32x32x16_bf16 v[200:215], a[16:19], a[248:251], 0
    v_exp_f32 v80, v80
    v_exp_f32 v81, v81
    v_exp_f32 v82, v82
    v_exp_f32 v83, v83
    v_mfma_f32_32x32x16_bf16 v[200:215], a[20:23], a[252:255], v[200:215]
    v_exp_f32 v84, v84
    v_exp_f32 v85, v85
    v_exp_f32 v86, v86
    v_exp_f32 v87, v87
    v_cvt_pk_bf16_f32 v56, v72, v73
    v_cvt_pk_bf16_f32 v57, v74, v75
    v_cvt_pk_bf16_f32 v58, v76, v77
    v_cvt_pk_bf16_f32 v59, v78, v79
    v_cvt_pk_bf16_f32 v60, v80, v81
    v_cvt_pk_bf16_f32 v61, v82, v83
    v_cvt_pk_bf16_f32 v62, v84, v85
    v_cvt_pk_bf16_f32 v63, v86, v87
    v_pk_fma_f32 v[88:89], v[88:89], s[46:47], v[34:35]
    v_pk_fma_f32 v[90:91], v[90:91], s[46:47], v[34:35]
    v_pk_fma_f32 v[92:93], v[92:93], s[46:47], v[34:35]
    v_pk_fma_f32 v[94:95], v[94:95], s[46:47], v[34:35]
    v_pk_fma_f32 v[96:97], v[96:97], s[46:47], v[34:35]
    v_pk_fma_f32 v[98:99], v[98:99], s[46:47], v[34:35]
    v_pk_fma_f32 v[100:101], v[100:101], s[46:47], v[34:35]
    v_pk_fma_f32 v[102:103], v[102:103], s[46:47], v[34:35]
    v_mfma_f32_16x16x32_bf16 a[164:167], a[160:163], v[56:59], a[164:167]
    v_exp_f32 v88, v88
    v_exp_f32 v89, v89
    v_exp_f32 v90, v90
    v_exp_f32 v91, v91
    v_mfma_f32_16x16x32_bf16 a[164:167], a[160:163], v[60:63], a[164:167]
    v_exp_f32 v92, v92
    v_exp_f32 v93, v93
    v_exp_f32 v94, v94
    v_exp_f32 v95, v95
    v_mfma_f32_32x32x16_bf16 v[216:231], a[24:27], a[248:251], 0
    v_exp_f32 v96, v96
    v_exp_f32 v97, v97
    v_exp_f32 v98, v98
    v_exp_f32 v99, v99
    v_mfma_f32_32x32x16_bf16 v[216:231], a[28:31], a[252:255], v[216:231]
    v_exp_f32 v100, v100
    v_exp_f32 v101, v101
    v_exp_f32 v102, v102
    v_exp_f32 v103, v103
    s_cmp_gt_i32 s49, 0
    s_cbranch_scc1 Lf_m1_0
Lf_nm1_0:
    v_cndmask_b32 v168, v184, v168, s[16:17]
    v_cndmask_b32 v169, v185, v169, s[18:19]
    v_cndmask_b32 v170, v186, v170, s[20:21]
    v_cndmask_b32 v171, v187, v171, s[22:23]
    v_cndmask_b32 v172, v188, v172, s[24:25]
    v_cndmask_b32 v173, v189, v173, s[26:27]
    v_cndmask_b32 v174, v190, v174, s[28:29]
    v_cndmask_b32 v175, v191, v175, s[30:31]
    v_cndmask_b32 v176, v192, v176, s[32:33]
    v_cndmask_b32 v177, v193, v177, s[34:35]
    v_cndmask_b32 v178, v194, v178, s[36:37]
    v_cndmask_b32 v179, v195, v179, s[38:39]
    v_cndmask_b32 v180, v196, v180, s[60:61]
    v_cndmask_b32 v181, v197, v181, s[66:67]
    v_cndmask_b32 v182, v198, v182, s[74:75]
    v_cndmask_b32 v183, v199, v183, s[78:79]
    v_max_f32 v36, v168, v169
    v_max_f32 v37, v170, v171
    v_max3_f32 v36, v36, v172, v173
    v_max3_f32 v37, v37, v174, v175
    v_max3_f32 v36, v36, v176, v177
    v_max3_f32 v37, v37, v178, v179
    v_max3_f32 v36, v36, v180, v181
    v_max3_f32 v37, v37, v182, v183
    v_cvt_pk_bf16_f32 v64, v88, v89
    v_cvt_pk_bf16_f32 v65, v90, v91
    v_cvt_pk_bf16_f32 v66, v92, v93
    v_cvt_pk_bf16_f32 v67, v94, v95
    v_cvt_pk_bf16_f32 v68, v96, v97
    v_cvt_pk_bf16_f32 v69, v98, v99
    v_cvt_pk_bf16_f32 v70, v100, v101
    v_cvt_pk_bf16_f32 v71, v102, v103
    v_pk_fma_f32 v[104:105], v[104:105], s[46:47], v[34:35]
    v_pk_fma_f32 v[106:107], v[106:107], s[46:47], v[34:35]
    v_pk_fma_f32 v[108:109], v[108:109], s[46:47], v[34:35]
    v_pk_fma_f32 v[110:111], v[110:111], s[46:47], v[34:35]
    v_pk_fma_f32 v[112:113], v[112:113], s[46:47], v[34:35]
    v_pk_fma_f32 v[114:115], v[114:115], s[46:47], v[34:35]
    v_pk_fma_f32 v[116:117], v[116:117], s[46:47], v[34:35]
    v_pk_fma_f32 v[118:119], v[118:119], s[46:47], v[34:35]
    v_mfma_f32_16x16x32_bf16 a[164:167], a[160:163], v[64:67], a[164:167]
    v_exp_f32 v104, v104
    v_exp_f32 v105, v105
    v_exp_f32 v106, v106
    v_exp_f32 v107, v107
    v_mfma_f32_16x16x32_bf16 a[164:167], a[160:163], v[68:71], a[164:167]
    v_exp_f32 v108, v108
    v_exp_f32 v109, v109
    v_exp_f32 v110, v110
    v_exp_f32 v111, v111
    v_mfma_f32_32x32x16_bf16 v[232:247], a[32:35], a[248:251], 0
    v_exp_f32 v112, v112
    v_exp_f32 v113, v113
    v_exp_f32 v114, v114
    v_exp_f32 v115, v115
    v_mfma_f32_32x32x16_bf16 v[232:247], a[36:39], a[252:255], v[232:247]
    v_exp_f32 v116, v116
    v_exp_f32 v117, v117
    v_exp_f32 v118, v118
    v_exp_f32 v119, v119
    s_cmp_gt_i32 s49, 1
    s_cbranch_scc1 Lf_m1_1
Lf_nm1_1:
    v_max3_f32 v36, v36, v200, v201
    v_max3_f32 v37, v37, v202, v203
    v_max3_f32 v36, v36, v204, v205
    v_max3_f32 v37, v37, v206, v207
    v_max3_f32 v36, v36, v208, v209
    v_max3_f32 v37, v37, v210, v211
    v_max3_f32 v36, v36, v212, v213
    v_max3_f32 v37, v37, v214, v215
    v_cvt_pk_bf16_f32 v72, v104, v105
    v_cvt_pk_bf16_f32 v73, v106, v107
    v_cvt_pk_bf16_f32 v74, v108, v109
    v_cvt_pk_bf16_f32 v75, v110, v111
    v_cvt_pk_bf16_f32 v76, v112, v113
    v_cvt_pk_bf16_f32 v77, v114, v115
    v_cvt_pk_bf16_f32 v78, v116, v117
    v_cvt_pk_bf16_f32 v79, v118, v119
    s_waitcnt vmcnt(0)
    v_mov_b32 v38, 1
    v_mov_b32 v39, 0
    s_mov_b64 exec, 1
    buffer_store_dword v38, v39, s[4:7], s15 offen sc1
    s_mov_b64 exec, -1
    s_nop 0
    buffer_load_dword v39, v0, s[4:7], 0 offen sc1
    buffer_load_dwordx4 v[4:7], v3, s[4:7], s14 offen sc1
    v_pk_fma_f32 v[120:121], v[120:121], s[46:47], v[34:35]
    v_pk_fma_f32 v[122:123], v[122:123], s[46:47], v[34:35]
    v_pk_fma_f32 v[124:125], v[124:125], s[46:47], v[34:35]
    v_pk_fma_f32 v[126:127], v[126:127], s[46:47], v[34:35]
    v_pk_fma_f32 v[128:129], v[128:129], s[46:47], v[34:35]
    v_pk_fma_f32 v[130:131], v[130:131], s[46:47], v[34:35]
    v_pk_fma_f32 v[132:133], v[132:133], s[46:47], v[34:35]
    v_pk_fma_f32 v[134:135], v[134:135], s[46:47], v[34:35]
    v_mfma_f32_16x16x32_bf16 a[164:167], a[160:163], v[72:75], a[164:167]
    v_exp_f32 v120, v120
    v_exp_f32 v121, v121
    v_exp_f32 v122, v122
    v_exp_f32 v123, v123
    v_mfma_f32_16x16x32_bf16 a[164:167], a[160:163], v[76:79], a[164:167]
    v_exp_f32 v124, v124
    v_exp_f32 v125, v125
    v_exp_f32 v126, v126
    v_exp_f32 v127, v127
    v_mfma_f32_32x32x16_bf16 v[104:119], a[40:43], a[248:251], 0
    v_exp_f32 v128, v128
    v_exp_f32 v129, v129
    v_exp_f32 v130, v130
    v_exp_f32 v131, v131
    v_mfma_f32_32x32x16_bf16 v[104:119], a[44:47], a[252:255], v[104:119]
    v_exp_f32 v132, v132
    v_exp_f32 v133, v133
    v_exp_f32 v134, v134
    v_exp_f32 v135, v135
    s_cmp_gt_i32 s49, 2
    s_cbranch_scc1 Lf_m1_2
Lf_nm1_2:
    v_max3_f32 v36, v36, v216, v217
    v_max3_f32 v37, v37, v218, v219
    v_max3_f32 v36, v36, v220, v221
    v_max3_f32 v37, v37, v222, v223
    v_max3_f32 v36, v36, v224, v225
    v_max3_f32 v37, v37, v226, v227
    v_max3_f32 v36, v36, v228, v229
    v_max3_f32 v37, v37, v230, v231
    v_cvt_pk_bf16_f32 v80, v120, v121
    v_cvt_pk_bf16_f32 v81, v122, v123
    v_cvt_pk_bf16_f32 v82, v124, v125
    v_cvt_pk_bf16_f32 v83, v126, v127
    v_cvt_pk_bf16_f32 v84, v128, v129
    v_cvt_pk_bf16_f32 v85, v130, v131
    v_cvt_pk_bf16_f32 v86, v132, v133
    v_cvt_pk_bf16_f32 v87, v134, v135
    v_pk_fma_f32 v[136:137], v[136:137], s[46:47], v[34:35]
    v_pk_fma_f32 v[138:139], v[138:139], s[46:47], v[34:35]
    v_pk_fma_f32 v[140:141], v[140:141], s[46:47], v[34:35]
    v_pk_fma_f32 v[142:143], v[142:143], s[46:47], v[34:35]
    v_pk_fma_f32 v[144:145], v[144:145], s[46:47], v[34:35]
    v_pk_fma_f32 v[146:147], v[146:147], s[46:47], v[34:35]
    v_pk_fma_f32 v[148:149], v[148:149], s[46:47], v[34:35]
    v_pk_fma_f32 v[150:151], v[150:151], s[46:47], v[34:35]
    v_mfma_f32_16x16x32_bf16 a[164:167], a[160:163], v[80:83], a[164:167]
    v_exp_f32 v136, v136
    v_exp_f32 v137, v137
    v_exp_f32 v138, v138
    v_exp_f32 v139, v139
    v_mfma_f32_16x16x32_bf16 a[164:167], a[160:163], v[84:87], a[164:167]
    v_exp_f32 v140, v140
    v_exp_f32 v141, v141
    v_exp_f32 v142, v142
    v_exp_f32 v143, v143
    v_mfma_f32_32x32x16_bf16 v[120:135], a[48:51], a[248:251], 0
    v_exp_f32 v144, v144
    v_exp_f32 v145, v145
    v_exp_f32 v146, v146
    v_exp_f32 v147, v147
    v_mfma_f32_32x32x16_bf16 v[120:135], a[52:55], a[252:255], v[120:135]
    v_exp_f32 v148, v148
    v_exp_f32 v149, v149
    v_exp_f32 v150, v150
    v_exp_f32 v151, v151
    s_cmp_gt_i32 s49, 3
    s_cbranch_scc1 Lf_m1_3
Lf_nm1_3:
    v_max3_f32 v36, v36, v232, v233
    v_max3_f32 v37, v37, v234, v235
    v_max3_f32 v36, v36, v236, v237
    v_max3_f32 v37, v37, v238, v239
    v_max3_f32 v36, v36, v240, v241
    v_max3_f32 v37, v37, v242, v243
    v_max3_f32 v36, v36, v244, v245
    v_max3_f32 v37, v37, v246, v247
    v_cvt_pk_bf16_f32 v88, v136, v137
    v_cvt_pk_bf16_f32 v89, v138, v139
    v_cvt_pk_bf16_f32 v90, v140, v141
    v_cvt_pk_bf16_f32 v91, v142, v143
    v_cvt_pk_bf16_f32 v92, v144, v145
    v_cvt_pk_bf16_f32 v93, v146, v147
    v_cvt_pk_bf16_f32 v94, v148, v149
    v_cvt_pk_bf16_f32 v95, v150, v151
    s_waitcnt vmcnt(0)
    v_cmp_eq_u32 vcc, 1, v39
    s_nop 1
    s_cmp_eq_u64 vcc, exec
    s_cbranch_scc0 Lf_sl3
Lf_ok3:
    s_add_u32 m0, s53, 32768
    s_add_u32 s73, s55, 0
    buffer_load_dwordx4 v17, s[4:7], s73 offen offset:0 sc1 lds
    buffer_load_dwordx4 v17, s[4:7], s73 offen offset:1024 sc1 lds
    buffer_load_dwordx4 v17, s[4:7], s73 offen offset:2048 sc1 lds
    buffer_load_dwordx4 v17, s[4:7], s73 offen offset:3072 sc1 lds
    v_and_b32 v4, v4, v5
    v_and_b32 v6, v6, v7
    v_and_b32 v4, v4, v6
    v_cmp_eq_u32 vcc, 1, v4
    s_nop 1
    s_cmp_eq_u64 vcc, exec
    s_cbranch_scc0 Lf_sl4
Lf_ok4:
    v_pk_fma_f32 v[152:153], v[152:153], s[46:47], v[34:35]
    v_pk_fma_f32 v[154:155], v[154:155], s[46:47], v[34:35]
    v_pk_fma_f32 v[156:157], v[156:157], s[46:47], v[34:35]
    v_pk_fma_f32 v[158:159], v[158:159], s[46:47], v[34:35]
    v_pk_fma_f32 v[160:161], v[160:161], s[46:47], v[34:35]
    v_pk_fma_f32 v[162:163], v[162:163], s[46:47], v[34:35]
    v_pk_fma_f32 v[164:165], v[164:165], s[46:47], v[34:35]
    v_pk_fma_f32 v[166:167], v[166:167], s[46:47], v[34:35]
    v_mfma_f32_16x16x32_bf16 a[164:167], a[160:163], v[88:91], a[164:167]
    v_exp_f32 v152, v152
    v_exp_f32 v153, v153
    v_exp_f32 v154, v154
    v_exp_f32 v155, v155
    v_mfma_f32_16x16x32_bf16 a[164:167], a[160:163], v[92:95], a[164:167]
    v_exp_f32 v156, v156
    v_exp_f32 v157, v157
    v_exp_f32 v158, v158
    v_exp_f32 v159, v159
    v_mfma_f32_32x32x16_bf16 v[136:151], a[56:59], a[248:251], 0
    v_exp_f32 v160, v160
    v_exp_f32 v161, v161
    v_exp_f32 v162, v162
    v_exp_f32 v163, v163
    v_mfma_f32_32x32x16_bf16 v[136:151], a[60:63], a[252:255], v[136:151]
    v_exp_f32 v164, v164
    v_exp_f32 v165, v165
    v_exp_f32 v166, v166
    v_exp_f32 v167, v167
    s_cmp_gt_i32 s49, 4
    s_cbranch_scc1 Lf_m1_4
Lf_nm1_4:
    v_max3_f32 v36, v36, v104, v105
    v_max3_f32 v37, v37, v106, v107
    v_max3_f32 v36, v36, v108, v109
    v_max3_f32 v37, v37, v110, v111
    v_max3_f32 v36, v36, v112, v113
    v_max3_f32 v37, v37, v114, v115
    v_max3_f32 v36, v36, v116, v117
    v_max3_f32 v37, v37, v118, v119
    v_cvt_pk_bf16_f32 v96, v152, v153
    v_cvt_pk_bf16_f32 v97, v154, v155
    v_cvt_pk_bf16_f32 v98, v156, v157
    v_cvt_pk_bf16_f32 v99, v158, v159
    v_cvt_pk_bf16_f32 v100, v160, v161
    v_cvt_pk_bf16_f32 v101, v162, v163
    v_cvt_pk_bf16_f32 v102, v164, v165
    v_cvt_pk_bf16_f32 v103, v166, v167
    s_add_u32 m0, s53, 36864
    s_add_u32 s73, s55, 4096
    buffer_load_dwordx4 v17, s[4:7], s73 offen offset:0 sc1 lds
    buffer_load_dwordx4 v17, s[4:7], s73 offen offset:1024 sc1 lds
    buffer_load_dwordx4 v17, s[4:7], s73 offen offset:2048 sc1 lds
    buffer_load_dwordx4 v17, s[4:7], s73 offen offset:3072 sc1 lds
    v_mfma_f32_32x32x16_bf16 v[152:167], a[64:67], a[248:251], 0
    v_mfma_f32_32x32x16_bf16 v[152:167], a[68:71], a[252:255], v[152:167]
    s_cmp_gt_i32 s49, 5
    s_cbranch_scc1 Lf_m1_5
Lf_nm1_5:
    v_max3_f32 v36, v36, v120, v121
    v_max3_f32 v37, v37, v122, v123
    v_max3_f32 v36, v36, v124, v125
    v_max3_f32 v37, v37, v126, v127
    v_max3_f32 v36, v36, v128, v129
    v_max3_f32 v37, v37, v130, v131
    v_max3_f32 v36, v36, v132, v133
    v_max3_f32 v37, v37, v134, v135
    s_cmp_gt_i32 s49, 6
    s_cbranch_scc1 Lf_m1_6
Lf_nm1_6:
    v_max3_f32 v36, v36, v136, v137
    v_max3_f32 v37, v37, v138, v139
    v_max3_f32 v36, v36, v140, v141
    v_max3_f32 v37, v37, v142, v143
    v_max3_f32 v36, v36, v144, v145
    v_max3_f32 v37, v37, v146, v147
    v_max3_f32 v36, v36, v148, v149
    v_max3_f32 v37, v37, v150, v151
    s_nop 1
    s_cmp_gt_i32 s49, 7
    s_cbranch_scc1 Lf_m1_7
Lf_nm1_7:
    v_max3_f32 v36, v36, v152, v153
    v_max3_f32 v37, v37, v154, v155
    v_max3_f32 v36, v36, v156, v157
    v_max3_f32 v37, v37, v158, v159
    v_max3_f32 v36, v36, v160, v161
    v_max3_f32 v37, v37, v162, v163
    v_max3_f32 v36, v36, v164, v165
    v_max3_f32 v37, v37, v166, v167
    v_max_f32 v36, v36, v37
    v_mov_b32 v37, v36
    s_nop 1
    v_permlane32_swap_b32 v36, v37
    v_max_f32 v36, v36, v37
    v_mul_f32 v36, s46, v36
    v_sub_f32 v36, 0, v36
    v_mov_b32 v37, v36
    s_lshl_b32 s72, s8, 11
    s_add_u32 s73, s72, 2048
    v_add_u32 v0, s73, v19
    s_sub_u32 s73, 2048, s72
    v_add_u32_e64 v1, s73, v19
    v_pk_fma_f32 v[168:169], v[168:169], s[46:47], v[36:37]
    v_pk_fma_f32 v[170:171], v[170:171], s[46:47], v[36:37]
    v_pk_fma_f32 v[172:173], v[172:173], s[46:47], v[36:37]
    v_pk_fma_f32 v[174:175], v[174:175], s[46:47], v[36:37]
    v_pk_fma_f32 v[176:177], v[176:177], s[46:47], v[36:37]
    v_pk_fma_f32 v[178:179], v[178:179], s[46:47], v[36:37]
    v_pk_fma_f32 v[180:181], v[180:181], s[46:47], v[36:37]
    v_pk_fma_f32 v[182:183], v[182:183], s[46:47], v[36:37]
    v_mfma_f32_16x16x32_bf16 a[164:167], a[160:163], v[96:99], a[164:167]
    v_exp_f32 v168, v168
    v_exp_f32 v169, v169
    v_exp_f32 v170, v170
    v_exp_f32 v171, v171
    v_exp_f32 v172, v172
    v_exp_f32 v173, v173
    s_waitcnt vmcnt(0)
    s_barrier
    v_exp_f32_e64 v174, v174
    ds_read_b64_tr_b16 a[80:81], v31 offset:0
    ds_read_b64_tr_b16 a[82:83], v30 offset:0
    ds_read_b64_tr_b16 a[84:85], v31 offset:1024
    ds_read_b64_tr_b16 a[86:87], v30 offset:1024
    v_exp_f32_e64 v175, v175
    ds_read_b64_tr_b16 a[144:145], v31 offset:16384
    ds_read_b64_tr_b16 a[146:147], v30 offset:16384
    ds_read_b64_tr_b16 a[148:149], v31 offset:17408
    ds_read_b64_tr_b16 a[150:151], v30 offset:17408
    v_mfma_f32_16x16x32_bf16 a[164:167], a[160:163], v[100:103], a[164:167]
    v_exp_f32_e64 v176, v176
    ds_read_b64_tr_b16 a[88:89], v31 offset:2048
    ds_read_b64_tr_b16 a[90:91], v30 offset:2048
    ds_read_b64_tr_b16 a[92:93], v31 offset:3072
    ds_read_b64_tr_b16 a[94:95], v30 offset:3072
    v_exp_f32_e64 v177, v177
    ds_read_b64_tr_b16 a[96:97], v31 offset:4096
    ds_read_b64_tr_b16 a[98:99], v30 offset:4096
    ds_read_b64_tr_b16 a[100:101], v31 offset:5120
    ds_read_b64_tr_b16 a[102:103], v30 offset:5120
    v_exp_f32_e64 v178, v178
    ds_read_b64_tr_b16 a[104:105], v31 offset:6144
    ds_read_b64_tr_b16 a[106:107], v30 offset:6144
    ds_read_b64_tr_b16 a[108:109], v31 offset:7168
    ds_read_b64_tr_b16 a[110:111], v30 offset:7168
    v_exp_f32_e64 v179, v179
    ds_read_b64_tr_b16 a[112:113], v31 offset:8192
    ds_read_b64_tr_b16 a[114:115], v30 offset:8192
    ds_read_b64_tr_b16 a[116:117], v31 offset:9216
    ds_read_b64_tr_b16 a[118:119], v30 offset:9216
    v_exp_f32_e64 v180, v180
    ds_read_b64_tr_b16 a[120:121], v31 offset:10240
    ds_read_b64_tr_b16 a[122:123], v30 offset:10240
    ds_read_b64_tr_b16 a[124:125], v31 offset:11264
    ds_read_b64_tr_b16 a[126:127], v30 offset:11264
    v_exp_f32_e64 v181, v181
    ds_read_b64_tr_b16 a[128:129], v31 offset:12288
    ds_read_b64_tr_b16 a[130:131], v30 offset:12288
    ds_read_b64_tr_b16 a[132:133], v31 offset:13312
    ds_read_b64_tr_b16 a[134:135], v30 offset:13312
    v_exp_f32_e64 v182, v182
    ds_read_b64_tr_b16 a[136:137], v31 offset:14336
    ds_read_b64_tr_b16 a[138:139], v30 offset:14336
    ds_read_b64_tr_b16 a[140:141], v31 offset:15360
    ds_read_b64_tr_b16 a[142:143], v30 offset:15360
    v_exp_f32_e64 v183, v183
    ds_read_b64_tr_b16 a[152:153], v31 offset:18432
    ds_read_b64_tr_b16 a[154:155], v30 offset:18432
    ds_read_b64_tr_b16 a[156:157], v31 offset:19456
    ds_read_b64_tr_b16 a[158:159], v30 offset:19456
    v_cvt_pk_bf16_f32 v168, v168, v169
    v_cvt_pk_bf16_f32 v169, v170, v171
    v_cvt_pk_bf16_f32 v170, v172, v173
    v_cvt_pk_bf16_f32 v171, v174, v175
    v_cvt_pk_bf16_f32 v172, v176, v177
    v_cvt_pk_bf16_f32 v173, v178, v179
    v_cvt_pk_bf16_f32 v174, v180, v181
    v_cvt_pk_bf16_f32 v175, v182, v183
    v_bfi_b32 v184, v20, 0, v168
    v_and_b32 v176, v20, v168
    v_bfi_b32 v185, v21, 0, v169
    v_and_b32 v177, v21, v169
    v_bfi_b32 v186, v22, 0, v170
    v_and_b32 v178, v22, v170
    v_bfi_b32 v187, v23, 0, v171
    v_and_b32 v179, v23, v171
    v_bfi_b32 v188, v24, 0, v172
    v_and_b32 v180, v24, v172
    v_bfi_b32 v189, v25, 0, v173
    v_and_b32 v181, v25, v173
    v_bfi_b32 v190, v26, 0, v174
    v_and_b32 v182, v26, v174
    v_bfi_b32 v191, v27, 0, v175
    v_and_b32 v183, v27, v175
    v_pk_fma_f32 v[200:201], v[200:201], s[46:47], v[36:37]
    v_pk_fma_f32 v[202:203], v[202:203], s[46:47], v[36:37]
    v_pk_fma_f32 v[204:205], v[204:205], s[46:47], v[36:37]
    v_pk_fma_f32 v[206:207], v[206:207], s[46:47], v[36:37]
    v_pk_fma_f32 v[208:209], v[208:209], s[46:47], v[36:37]
    v_pk_fma_f32 v[210:211], v[210:211], s[46:47], v[36:37]
    v_pk_fma_f32 v[212:213], v[212:213], s[46:47], v[36:37]
    v_pk_fma_f32 v[214:215], v[214:215], s[46:47], v[36:37]
    s_waitcnt lgkmcnt(0)
    v_mfma_f32_32x32x16_bf16 a[176:191], a[80:83], v[248:251], 0
    v_exp_f32 v200, v200
    v_exp_f32 v201, v201
    v_mfma_f32_16x16x32_bf16 a[168:171], a[160:163], v[168:171], 0
    v_exp_f32 v202, v202
    v_exp_f32 v203, v203
    v_mfma_f32_32x32x16_bf16 a[176:191], a[84:87], v[252:255], a[176:191]
    v_exp_f32 v204, v204
    v_exp_f32 v205, v205
    v_mfma_f32_16x16x32_bf16 a[168:171], a[160:163], v[172:175], a[168:171]
    v_exp_f32 v206, v206
    v_exp_f32 v207, v207
    v_exp_f32 v208, v208
    v_mfma_f32_32x32x16_bf16 a[176:191], a[144:147], v[8:11], a[176:191]
    v_exp_f32 v209, v209
    v_exp_f32 v210, v210
    v_mfma_f32_32x32x16_bf16 a[192:207], a[88:91], v[176:179], 0
    v_exp_f32 v211, v211
    v_exp_f32 v212, v212
    v_mfma_f32_32x32x16_bf16 a[192:207], a[92:95], v[180:183], a[192:207]
    v_exp_f32 v213, v213
    v_exp_f32 v214, v214
    v_exp_f32_e64 v215, v215
    v_cvt_pk_bf16_f32 v200, v200, v201
    v_cvt_pk_bf16_f32 v201, v202, v203
    v_cvt_pk_bf16_f32 v202, v204, v205
    v_cvt_pk_bf16_f32 v203, v206, v207
    v_cvt_pk_bf16_f32 v204, v208, v209
    v_cvt_pk_bf16_f32 v205, v210, v211
    v_cvt_pk_bf16_f32 v206, v212, v213
    v_cvt_pk_bf16_f32 v207, v214, v215
    v_pk_fma_f32 v[216:217], v[216:217], s[46:47], v[36:37]
    v_pk_fma_f32 v[218:219], v[218:219], s[46:47], v[36:37]
    v_pk_fma_f32 v[220:221], v[220:221], s[46:47], v[36:37]
    v_pk_fma_f32 v[222:223], v[222:223], s[46:47], v[36:37]
    v_pk_fma_f32 v[224:225], v[224:225], s[46:47], v[36:37]
    v_pk_fma_f32 v[226:227], v[226:227], s[46:47], v[36:37]
    v_pk_fma_f32 v[228:229], v[228:229], s[46:47], v[36:37]
    v_pk_fma_f32 v[230:231], v[230:231], s[46:47], v[36:37]
    v_mfma_f32_32x32x16_bf16 a[176:191], a[148:151], v[12:15], a[176:191]
    v_exp_f32 v216, v216
    v_exp_f32 v217, v217
    v_mfma_f32_16x16x32_bf16 a[168:171], a[160:163], v[200:203], a[168:171]
    v_exp_f32 v218, v218
    v_exp_f32 v219, v219
    v_mfma_f32_32x32x16_bf16 a[176:191], a[88:91], v[48:51], a[176:191]
    v_exp_f32 v220, v220
    v_exp_f32 v221, v221
    v_mfma_f32_16x16x32_bf16 a[168:171], a[160:163], v[204:207], a[168:171]
    v_exp_f32 v222, v222
    v_exp_f32 v223, v223
    v_exp_f32 v224, v224
    v_mfma_f32_32x32x16_bf16 a[176:191], a[92:95], v[52:55], a[176:191]
    v_exp_f32 v225, v225
    v_exp_f32 v226, v226
    v_mfma_f32_32x32x16_bf16 a[192:207], a[152:155], v[184:187], a[192:207]
    v_exp_f32 v227, v227
    v_exp_f32 v228, v228
    v_mfma_f32_32x32x16_bf16 a[192:207], a[156:159], v[188:191], a[192:207]
    v_exp_f32 v229, v229
    v_exp_f32 v230, v230
    v_exp_f32 v231, v231
    v_cvt_pk_bf16_f32 v216, v216, v217
    v_cvt_pk_bf16_f32 v217, v218, v219
    v_cvt_pk_bf16_f32 v218, v220, v221
    v_cvt_pk_bf16_f32 v219, v222, v223
    v_cvt_pk_bf16_f32 v220, v224, v225
    v_cvt_pk_bf16_f32 v221, v226, v227
    v_cvt_pk_bf16_f32 v222, v228, v229
    v_cvt_pk_bf16_f32 v223, v230, v231
    buffer_load_dwordx2 v[38:39], v29, s[4:7], s45 offen sc1
    v_pk_fma_f32 v[232:233], v[232:233], s[46:47], v[36:37]
    v_pk_fma_f32 v[234:235], v[234:235], s[46:47], v[36:37]
    v_pk_fma_f32 v[236:237], v[236:237], s[46:47], v[36:37]
    v_pk_fma_f32 v[238:239], v[238:239], s[46:47], v[36:37]
    v_pk_fma_f32 v[240:241], v[240:241], s[46:47], v[36:37]
    v_pk_fma_f32 v[242:243], v[242:243], s[46:47], v[36:37]
    v_pk_fma_f32 v[244:245], v[244:245], s[46:47], v[36:37]
    v_pk_fma_f32 v[246:247], v[246:247], s[46:47], v[36:37]
    v_mfma_f32_32x32x16_bf16 a[176:191], a[96:99], v[56:59], a[176:191]
    v_exp_f32 v232, v232
    v_exp_f32 v233, v233
    v_mfma_f32_16x16x32_bf16 a[168:171], a[160:163], v[216:219], a[168:171]
    v_exp_f32 v234, v234
    v_exp_f32 v235, v235
    v_mfma_f32_32x32x16_bf16 a[176:191], a[100:103], v[60:63], a[176:191]
    v_exp_f32 v236, v236
    v_exp_f32 v237, v237
    v_mfma_f32_16x16x32_bf16 a[168:171], a[160:163], v[220:223], a[168:171]
    v_exp_f32 v238, v238
    v_exp_f32 v239, v239
    v_exp_f32 v240, v240
    v_mfma_f32_32x32x16_bf16 a[176:191], a[104:107], v[64:67], a[176:191]
    v_exp_f32 v241, v241
    v_exp_f32 v242, v242
    v_mfma_f32_32x32x16_bf16 a[192:207], a[96:99], v[200:203], a[192:207]
    v_exp_f32 v243, v243
    v_exp_f32 v244, v244
    v_mfma_f32_32x32x16_bf16 a[192:207], a[100:103], v[204:207], a[192:207]
    v_exp_f32 v245, v245
    v_exp_f32 v246, v246
    v_exp_f32 v247, v247
    v_cvt_pk_bf16_f32 v232, v232, v233
    v_cvt_pk_bf16_f32 v233, v234, v235
    v_cvt_pk_bf16_f32 v234, v236, v237
    v_cvt_pk_bf16_f32 v235, v238, v239
    v_cvt_pk_bf16_f32 v236, v240, v241
    v_cvt_pk_bf16_f32 v237, v242, v243
    v_cvt_pk_bf16_f32 v238, v244, v245
    v_cvt_pk_bf16_f32 v239, v246, v247
    v_pk_fma_f32 v[104:105], v[104:105], s[46:47], v[36:37]
    v_pk_fma_f32 v[106:107], v[106:107], s[46:47], v[36:37]
    v_pk_fma_f32 v[108:109], v[108:109], s[46:47], v[36:37]
    v_pk_fma_f32 v[110:111], v[110:111], s[46:47], v[36:37]
    v_pk_fma_f32 v[112:113], v[112:113], s[46:47], v[36:37]
    v_pk_fma_f32 v[114:115], v[114:115], s[46:47], v[36:37]
    v_pk_fma_f32 v[116:117], v[116:117], s[46:47], v[36:37]
    v_pk_fma_f32 v[118:119], v[118:119], s[46:47], v[36:37]
    v_mfma_f32_32x32x16_bf16 a[176:191], a[108:111], v[68:71], a[176:191]
    v_exp_f32 v104, v104
    v_exp_f32 v105, v105
    v_mfma_f32_16x16x32_bf16 a[168:171], a[160:163], v[232:235], a[168:171]
    v_exp_f32 v106, v106
    v_exp_f32 v107, v107
    v_mfma_f32_32x32x16_bf16 a[176:191], a[112:115], v[72:75], a[176:191]
    v_exp_f32 v108, v108
    v_exp_f32 v109, v109
    v_mfma_f32_16x16x32_bf16 a[168:171], a[160:163], v[236:239], a[168:171]
    v_exp_f32 v110, v110
    v_exp_f32 v111, v111
    v_exp_f32 v112, v112
    v_mfma_f32_32x32x16_bf16 a[176:191], a[116:119], v[76:79], a[176:191]
    v_exp_f32 v113, v113
    v_exp_f32 v114, v114
    v_mfma_f32_32x32x16_bf16 a[192:207], a[104:107], v[216:219], a[192:207]
    v_exp_f32 v115, v115
    v_exp_f32 v116, v116
    v_mfma_f32_32x32x16_bf16 a[192:207], a[108:111], v[220:223], a[192:207]
    v_exp_f32 v117, v117
    v_exp_f32 v118, v118
    v_exp_f32 v119, v119
    v_cvt_pk_bf16_f32 v104, v104, v105
    v_cvt_pk_bf16_f32 v105, v106, v107
    v_cvt_pk_bf16_f32 v106, v108, v109
    v_cvt_pk_bf16_f32 v107, v110, v111
    v_cvt_pk_bf16_f32 v108, v112, v113
    v_cvt_pk_bf16_f32 v109, v114, v115
    v_cvt_pk_bf16_f32 v110, v116, v117
    v_cvt_pk_bf16_f32 v111, v118, v119
    s_waitcnt vmcnt(0)
    v_and_b32 v38, v38, v39
    v_cmp_eq_u32 vcc, 1, v38
    s_nop 1
    s_cmp_eq_u64 vcc, exec
    s_cselect_b32 s62, 1, 0
    s_andn2_b32 s62, s62, s3
    s_or_b32 s3, s3, s62
    s_cmp_eq_u32 s62, 0
    s_cbranch_scc1 Lf_np4_4
    buffer_load_dword v28, v16, s[4:7], s69 offen sc1
    buffer_load_dword v32, v16, s[4:7], s69 offen offset:128 sc1
    s_add_u32 m0, s44, 66560
    s_nop 0
    s_nop 0
    buffer_load_dwordx4 v0, s[4:7], s40 offen offset:0 sc1 lds
    buffer_load_dwordx4 v0, s[4:7], s40 offen offset:1024 sc1 lds
    buffer_load_dwordx4 v1, s[4:7], s40 offen offset:2048 sc1 lds
    buffer_load_dwordx4 v1, s[4:7], s40 offen offset:3072 sc1 lds
    s_add_u32 m0, s44, 74752
    s_add_u32 s40, s40, 262144
    buffer_load_dwordx4 v19, s[4:7], s41 offen offset:0 sc1 lds
    buffer_load_dwordx4 v19, s[4:7], s41 offen offset:1024 sc1 lds
Lf_np4_4:
    v_pk_fma_f32 v[120:121], v[120:121], s[46:47], v[36:37]
    v_pk_fma_f32 v[122:123], v[122:123], s[46:47], v[36:37]
    v_pk_fma_f32 v[124:125], v[124:125], s[46:47], v[36:37]
    v_pk_fma_f32 v[126:127], v[126:127], s[46:47], v[36:37]
    v_pk_fma_f32 v[128:129], v[128:129], s[46:47], v[36:37]
    v_pk_fma_f32 v[130:131], v[130:131], s[46:47], v[36:37]
    v_pk_fma_f32 v[132:133], v[132:133], s[46:47], v[36:37]
    v_pk_fma_f32 v[134:135], v[134:135], s[46:47], v[36:37]
    v_mfma_f32_32x32x16_bf16 a[176:191], a[120:123], v[80:83], a[176:191]
    v_exp_f32 v120, v120
    v_exp_f32 v121, v121
    v_mfma_f32_16x16x32_bf16 a[168:171], a[160:163], v[104:107], a[168:171]
    v_exp_f32 v122, v122
    v_exp_f32 v123, v123
    v_mfma_f32_32x32x16_bf16 a[176:191], a[124:127], v[84:87], a[176:191]
    v_exp_f32 v124, v124
    v_exp_f32 v125, v125
    v_mfma_f32_16x16x32_bf16 a[168:171], a[160:163], v[108:111], a[168:171]
    v_exp_f32 v126, v126
    v_exp_f32 v127, v127
    v_exp_f32 v128, v128
    v_mfma_f32_32x32x16_bf16 a[176:191], a[128:131], v[88:91], a[176:191]
    v_exp_f32 v129, v129
    v_exp_f32 v130, v130
    v_mfma_f32_32x32x16_bf16 a[192:207], a[112:115], v[232:235], a[192:207]
    v_exp_f32 v131, v131
    v_exp_f32 v132, v132
    v_mfma_f32_32x32x16_bf16 a[192:207], a[116:119], v[236:239], a[192:207]
    v_exp_f32 v133, v133
    v_exp_f32 v134, v134
    v_exp_f32 v135, v135
    v_cvt_pk_bf16_f32 v120, v120, v121
    v_cvt_pk_bf16_f32 v121, v122, v123
    v_cvt_pk_bf16_f32 v122, v124, v125
    v_cvt_pk_bf16_f32 v123, v126, v127
    v_cvt_pk_bf16_f32 v124, v128, v129
    v_cvt_pk_bf16_f32 v125, v130, v131
    v_cvt_pk_bf16_f32 v126, v132, v133
    v_cvt_pk_bf16_f32 v127, v134, v135
    s_cmp_eq_u32 s62, 0
    s_cbranch_scc1 Lf_np4_5
    buffer_load_dwordx4 v19, s[4:7], s41 offen offset:2048 sc1 lds
    buffer_load_dwordx4 v19, s[4:7], s41 offen offset:3072 sc1 lds
    s_add_u32 s41, s41, 131072
    s_add_u32 m0, s44, 99328
    s_nop 0
    s_nop 0
    buffer_load_dwordx4 v0, s[4:7], s40 offen offset:0 sc1 lds
    buffer_load_dwordx4 v0, s[4:7], s40 offen offset:1024 sc1 lds
    buffer_load_dwordx4 v1, s[4:7], s40 offen offset:2048 sc1 lds
    buffer_load_dwordx4 v1, s[4:7], s40 offen offset:3072 sc1 lds
Lf_np4_5:
    v_pk_fma_f32 v[136:137], v[136:137], s[46:47], v[36:37]
    v_pk_fma_f32 v[138:139], v[138:139], s[46:47], v[36:37]
    v_pk_fma_f32 v[140:141], v[140:141], s[46:47], v[36:37]
    v_pk_fma_f32 v[142:143], v[142:143], s[46:47], v[36:37]
    v_pk_fma_f32 v[144:145], v[144:145], s[46:47], v[36:37]
    v_pk_fma_f32 v[146:147], v[146:147], s[46:47], v[36:37]
    v_pk_fma_f32 v[148:149], v[148:149], s[46:47], v[36:37]
    v_pk_fma_f32 v[150:151], v[150:151], s[46:47], v[36:37]
    v_mfma_f32_32x32x16_bf16 a[176:191], a[132:135], v[92:95], a[176:191]
    v_exp_f32 v136, v136
    v_exp_f32 v137, v137
    v_mfma_f32_16x16x32_bf16 a[168:171], a[160:163], v[120:123], a[168:171]
    v_exp_f32 v138, v138
    v_exp_f32 v139, v139
    v_mfma_f32_32x32x16_bf16 a[176:191], a[136:139], v[96:99], a[176:191]
    v_exp_f32 v140, v140
    v_exp_f32 v141, v141
    v_mfma_f32_16x16x32_bf16 a[168:171], a[160:163], v[124:127], a[168:171]
    v_exp_f32 v142, v142
    v_exp_f32 v143, v143
    v_exp_f32 v144, v144
    v_mfma_f32_32x32x16_bf16 a[176:191], a[140:143], v[100:103], a[176:191]
    v_exp_f32 v145, v145
    v_exp_f32 v146, v146
    v_mfma_f32_32x32x16_bf16 a[192:207], a[120:123], v[104:107], a[192:207]
    v_exp_f32 v147, v147
    v_exp_f32 v148, v148
    v_mfma_f32_32x32x16_bf16 a[192:207], a[124:127], v[108:111], a[192:207]
    v_exp_f32 v149, v149
    v_exp_f32 v150, v150
    v_exp_f32 v151, v151
    v_cvt_pk_bf16_f32 v136, v136, v137
    v_cvt_pk_bf16_f32 v137, v138, v139
    v_cvt_pk_bf16_f32 v138, v140, v141
    v_cvt_pk_bf16_f32 v139, v142, v143
    v_cvt_pk_bf16_f32 v140, v144, v145
    v_cvt_pk_bf16_f32 v141, v146, v147
    v_cvt_pk_bf16_f32 v142, v148, v149
    v_cvt_pk_bf16_f32 v143, v150, v151
    s_cmp_eq_u32 s62, 0
    s_cbranch_scc1 Lf_np4_6
    s_add_u32 m0, s44, 107520
    s_add_u32 s40, s40, 262144
    buffer_load_dwordx4 v19, s[4:7], s41 offen offset:0 sc1 lds
    buffer_load_dwordx4 v19, s[4:7], s41 offen offset:1024 sc1 lds
    buffer_load_dwordx4 v19, s[4:7], s41 offen offset:2048 sc1 lds
    buffer_load_dwordx4 v19, s[4:7], s41 offen offset:3072 sc1 lds
    s_add_u32 s41, s41, 131072
    s_add_u32 m0, s44, 132096
    s_nop 0
    s_nop 0
    buffer_load_dwordx4 v0, s[4:7], s40 offen offset:0 sc1 lds
    buffer_load_dwordx4 v0, s[4:7], s40 offen offset:1024 sc1 lds
Lf_np4_6:
    v_pk_fma_f32 v[152:153], v[152:153], s[46:47], v[36:37]
    v_pk_fma_f32 v[154:155], v[154:155], s[46:47], v[36:37]
    v_pk_fma_f32 v[156:157], v[156:157], s[46:47], v[36:37]
    v_pk_fma_f32 v[158:159], v[158:159], s[46:47], v[36:37]
    v_pk_fma_f32 v[160:161], v[160:161], s[46:47], v[36:37]
    v_pk_fma_f32 v[162:163], v[162:163], s[46:47], v[36:37]
    v_pk_fma_f32 v[164:165], v[164:165], s[46:47], v[36:37]
    v_pk_fma_f32 v[166:167], v[166:167], s[46:47], v[36:37]
    v_mfma_f32_32x32x16_bf16 a[192:207], a[128:131], v[120:123], a[192:207]
    v_exp_f32 v152, v152
    v_exp_f32 v153, v153
    v_mfma_f32_16x16x32_bf16 a[168:171], a[160:163], v[136:139], a[168:171]
    v_exp_f32 v154, v154
    v_exp_f32 v155, v155
    v_exp_f32 v156, v156
    v_mfma_f32_32x32x16_bf16 a[192:207], a[132:135], v[124:127], a[192:207]
    v_exp_f32 v157, v157
    v_exp_f32 v158, v158
    v_exp_f32 v159, v159
    v_mfma_f32_16x16x32_bf16 a[168:171], a[160:163], v[140:143], a[168:171]
    v_exp_f32 v160, v160
    v_exp_f32 v161, v161
    v_mfma_f32_32x32x16_bf16 a[192:207], a[136:139], v[136:139], a[192:207]
    v_exp_f32 v162, v162
    v_exp_f32 v163, v163
    v_exp_f32 v164, v164
    v_mfma_f32_32x32x16_bf16 a[192:207], a[140:143], v[140:143], a[192:207]
    v_exp_f32 v165, v165
    v_exp_f32 v166, v166
    v_exp_f32 v167, v167
    v_cvt_pk_bf16_f32 v152, v152, v153
    v_cvt_pk_bf16_f32 v153, v154, v155
    v_cvt_pk_bf16_f32 v154, v156, v157
    v_cvt_pk_bf16_f32 v155, v158, v159
    v_cvt_pk_bf16_f32 v156, v160, v161
    v_cvt_pk_bf16_f32 v157, v162, v163
    v_cvt_pk_bf16_f32 v158, v164, v165
    v_cvt_pk_bf16_f32 v159, v166, v167
    s_cmp_eq_u32 s62, 0
    s_cbranch_scc1 Lf_np4_7
    buffer_load_dwordx4 v1, s[4:7], s40 offen offset:2048 sc1 lds
    buffer_load_dwordx4 v1, s[4:7], s40 offen offset:3072 sc1 lds
    s_add_u32 m0, s44, 140288
    s_add_u32 s40, s40, 262144
    buffer_load_dwordx4 v19, s[4:7], s41 offen offset:0 sc1 lds
    buffer_load_dwordx4 v19, s[4:7], s41 offen offset:1024 sc1 lds
    buffer_load_dwordx4 v19, s[4:7], s41 offen offset:2048 sc1 lds
    buffer_load_dwordx4 v19, s[4:7], s41 offen offset:3072 sc1 lds
    s_add_u32 s41, s41, 131072
Lf_np4_7:
    s_nop 1
    v_mfma_f32_16x16x32_bf16 a[168:171], a[160:163], v[152:155], a[168:171]
    v_mfma_f32_16x16x32_bf16 a[168:171], a[160:163], v[156:159], a[168:171]
    v_mfma_f32_32x32x16_bf16 a[192:207], a[144:147], v[152:155], a[192:207]
    v_mfma_f32_32x32x16_bf16 a[192:207], a[148:151], v[156:159], a[192:207]
    s_cmp_eq_u32 s3, 0
    s_cbranch_scc1 Lf_nopref
Lf_pref:
    s_lshl_b32 s72, s70, 12
    v_add_u32 v4, s72, v19
    s_add_u32 s72, s11, 8192
    v_add_u32 v6, s72, v19
    v_add_u32 v7, 65536, v4
    v_add_u32 v9, 65536, v6
    v_add_u32 v30, 131072, v4
    v_mov_b32 v24, -1
    v_mov_b32 v25, -1
    v_mov_b32 v26, -1
    v_mov_b32 v27, -1
    s_waitcnt vmcnt(24)
    s_nop 0
    v_accvgpr_read_b32 v34, a164
    v_accvgpr_read_b32 v40, a176
    v_accvgpr_read_b32 v41, a177
    v_accvgpr_read_b32 v42, a178
    v_accvgpr_read_b32 v43, a179
    v_accvgpr_read_b32 v44, a180
    v_accvgpr_read_b32 v45, a181
    v_accvgpr_read_b32 v46, a182
    v_accvgpr_read_b32 v47, a183
    v_rcp_f32_e64 v34, v34
    buffer_store_dwordx4 v[24:27], v19, s[4:7], s76 offen offset:0 sc1
    v_accvgpr_read_b32 v48, a184
    v_accvgpr_read_b32 v49, a185
    v_accvgpr_read_b32 v50, a186
    v_accvgpr_read_b32 v51, a187
    v_accvgpr_read_b32 v52, a188
    v_accvgpr_read_b32 v53, a189
    v_accvgpr_read_b32 v54, a190
    v_accvgpr_read_b32 v55, a191
    v_mul_f32 v34, v34, v28
    v_mov_b32 v35, v34
    v_pk_mul_f32 v[40:41], v[40:41], v[34:35]
    v_pk_mul_f32 v[42:43], v[42:43], v[34:35]
    v_pk_mul_f32 v[44:45], v[44:45], v[34:35]
    v_pk_mul_f32 v[46:47], v[46:47], v[34:35]
    v_pk_mul_f32 v[48:49], v[48:49], v[34:35]
    v_pk_mul_f32 v[50:51], v[50:51], v[34:35]
    v_pk_mul_f32 v[52:53], v[52:53], v[34:35]
    v_pk_mul_f32 v[54:55], v[54:55], v[34:35]
    v_cvt_pk_bf16_f32 v56, v40, v41
    v_cvt_pk_bf16_f32 v57, v42, v43
    v_cvt_pk_bf16_f32 v58, v44, v45
    v_cvt_pk_bf16_f32 v59, v46, v47
    v_cvt_pk_bf16_f32 v60, v48, v49
    v_cvt_pk_bf16_f32 v61, v50, v51
    v_cvt_pk_bf16_f32 v62, v52, v53
    v_cvt_pk_bf16_f32 v63, v54, v55
    buffer_store_dwordx4 v[24:27], v19, s[4:7], s76 offen offset:1024 sc1
    v_permlane32_swap_b32 v56, v58
    v_permlane32_swap_b32 v57, v59
    v_permlane32_swap_b32 v60, v62
    v_permlane32_swap_b32 v61, v63
    buffer_store_dwordx4 v[56:59], v18, s[4:7], s65 offen offset:0 sc1
    buffer_store_dwordx4 v[60:63], v18, s[4:7], s65 offen offset:512 sc1
    s_waitcnt vmcnt(20)
    s_barrier
    ds_read_b128 a[0:3], v7 offset:0
    ds_read_b128 a[32:35], v7 offset:16384
    ds_read_b128 a[16:19], v9 offset:0
    ds_read_b128 a[48:51], v9 offset:16384
    ds_read_b128 a[20:23], v9 offset:1024
    ds_read_b128 a[52:55], v9 offset:17408
    ds_read_b128 a[24:27], v9 offset:2048
    ds_read_b128 a[56:59], v9 offset:18432
    ds_read_b128 a[28:31], v9 offset:3072
    ds_read_b128 a[60:63], v9 offset:19456
    ds_read_b128 a[4:7], v7 offset:1024
    ds_read_b128 a[36:39], v7 offset:17408
    ds_read_b128 a[8:11], v7 offset:2048
    ds_read_b128 a[40:43], v7 offset:18432
    ds_read_b128 a[12:15], v7 offset:3072
    ds_read_b128 a[44:47], v7 offset:19456
    v_accvgpr_read_b32 v34, a168
    v_accvgpr_read_b32 v72, a192
    v_accvgpr_read_b32 v73, a193
    v_accvgpr_read_b32 v74, a194
    v_accvgpr_read_b32 v75, a195
    v_accvgpr_read_b32 v76, a196
    v_accvgpr_read_b32 v77, a197
    v_accvgpr_read_b32 v78, a198
    v_accvgpr_read_b32 v79, a199
    v_rcp_f32_e64 v34, v34
    buffer_store_dwordx4 v[24:27], v19, s[4:7], s76 offen offset:2048 sc1
    v_accvgpr_read_b32 v80, a200
    v_accvgpr_read_b32 v81, a201
    v_accvgpr_read_b32 v82, a202
    v_accvgpr_read_b32 v83, a203
    v_accvgpr_read_b32 v84, a204
    v_accvgpr_read_b32 v85, a205
    v_accvgpr_read_b32 v86, a206
    v_accvgpr_read_b32 v87, a207
    v_mul_f32 v34, v34, v32
    v_mov_b32 v35, v34
    v_pk_mul_f32 v[72:73], v[72:73], v[34:35]
    v_pk_mul_f32 v[74:75], v[74:75], v[34:35]
    v_pk_mul_f32 v[76:77], v[76:77], v[34:35]
    v_pk_mul_f32 v[78:79], v[78:79], v[34:35]
    v_pk_mul_f32 v[80:81], v[80:81], v[34:35]
    v_pk_mul_f32 v[82:83], v[82:83], v[34:35]
    v_pk_mul_f32 v[84:85], v[84:85], v[34:35]
    v_pk_mul_f32 v[86:87], v[86:87], v[34:35]
    v_cvt_pk_bf16_f32 v88, v72, v73
    v_cvt_pk_bf16_f32 v89, v74, v75
    v_cvt_pk_bf16_f32 v90, v76, v77
    v_cvt_pk_bf16_f32 v91, v78, v79
    v_cvt_pk_bf16_f32 v92, v80, v81
    v_cvt_pk_bf16_f32 v93, v82, v83
    v_cvt_pk_bf16_f32 v94, v84, v85
    v_cvt_pk_bf16_f32 v95, v86, v87
    buffer_store_dwordx4 v[24:27], v19, s[4:7], s76 offen offset:3072 sc1
    v_permlane32_swap_b32 v88, v90
    v_permlane32_swap_b32 v89, v91
    v_permlane32_swap_b32 v92, v94
    v_permlane32_swap_b32 v93, v95
    buffer_store_dwordx4 v[88:91], v18, s[4:7], s65 offen offset:2048 sc1
    buffer_store_dwordx4 v[92:95], v18, s[4:7], s65 offen offset:2560 sc1
    v_add_u32 v32, 131072, v6
    s_waitcnt vmcnt(16) lgkmcnt(0)
    s_barrier
    v_mfma_f32_16x16x32_bf16 v[160:163], a[16:19], a[0:3], 0
    s_add_u32 m0, s44, 1024
    s_nop 0
    s_nop 0
    buffer_load_dwordx4 v0, s[4:7], s40 offen offset:0 sc1 lds
    ds_read_b128 a[64:67], v7 offset:32768
    v_mfma_f32_16x16x32_bf16 v[160:163], a[48:51], a[32:35], v[160:163]
    ds_read_b128 a[96:99], v7 offset:49152
    v_mfma_f32_16x16x32_bf16 v[164:167], a[20:23], a[0:3], 0
    buffer_load_dwordx4 v0, s[4:7], s40 offen offset:1024 sc1 lds
    v_mfma_f32_16x16x32_bf16 v[164:167], a[52:55], a[32:35], v[164:167]
    ds_read_b128 a[80:83], v9 offset:32768
    v_mfma_f32_16x16x32_bf16 v[168:171], a[24:27], a[0:3], 0
    buffer_load_dwordx4 v1, s[4:7], s40 offen offset:2048 sc1 lds
    ds_read_b128 a[112:115], v9 offset:49152
    v_mfma_f32_16x16x32_bf16 v[168:171], a[56:59], a[32:35], v[168:171]
    v_mfma_f32_16x16x32_bf16 v[172:175], a[28:31], a[0:3], 0
    ds_read_b128 a[84:87], v9 offset:33792
    v_mfma_f32_16x16x32_bf16 v[172:175], a[60:63], a[32:35], v[172:175]
    buffer_load_dwordx4 v1, s[4:7], s40 offen offset:3072 sc1 lds
    ds_read_b128 a[116:119], v9 offset:50176
    v_mfma_f32_16x16x32_bf16 v[176:179], a[16:19], a[4:7], 0
    v_mfma_f32_16x16x32_bf16 v[176:179], a[48:51], a[36:39], v[176:179]
    s_add_u32 m0, s44, 9216
    s_add_u32 s40, s40, 262144
    buffer_load_dwordx4 v19, s[4:7], s41 offen offset:0 sc1 lds
    ds_read_b128 a[88:91], v9 offset:34816
    v_mfma_f32_16x16x32_bf16 v[180:183], a[20:23], a[4:7], 0
    ds_read_b128 a[120:123], v9 offset:51200
    v_mfma_f32_16x16x32_bf16 v[180:183], a[52:55], a[36:39], v[180:183]
    v_mfma_f32_16x16x32_bf16 v[184:187], a[24:27], a[4:7], 0
    buffer_load_dwordx4 v19, s[4:7], s41 offen offset:1024 sc1 lds
    ds_read_b128 a[92:95], v9 offset:35840
    v_mfma_f32_16x16x32_bf16 v[184:187], a[56:59], a[36:39], v[184:187]
    ds_read_b128 a[124:127], v9 offset:52224
    v_mfma_f32_16x16x32_bf16 v[188:191], a[28:31], a[4:7], 0
    buffer_load_dwordx4 v19, s[4:7], s41 offen offset:2048 sc1 lds
    v_mfma_f32_16x16x32_bf16 v[188:191], a[60:63], a[36:39], v[188:191]
    ds_read_b128 a[68:71], v7 offset:33792
    v_mfma_f32_16x16x32_bf16 v[192:195], a[16:19], a[8:11], 0
    buffer_load_dwordx4 v19, s[4:7], s41 offen offset:3072 sc1 lds
    s_add_u32 s41, s41, 131072
    ds_read_b128 a[100:103], v7 offset:50176
    v_mfma_f32_16x16x32_bf16 v[192:195], a[48:51], a[40:43], v[192:195]
    v_mfma_f32_16x16x32_bf16 v[196:199], a[20:23], a[8:11], 0
    s_add_u32 m0, s44, 66560
    ds_read_b128 a[72:75], v7 offset:34816
    v_mfma_f32_16x16x32_bf16 v[196:199], a[52:55], a[40:43], v[196:199]
    buffer_load_dwordx4 v0, s[4:7], s40 offen offset:0 sc1 lds
    ds_read_b128 a[104:107], v7 offset:51200
    v_mfma_f32_16x16x32_bf16 v[200:203], a[24:27], a[8:11], 0
    v_mfma_f32_16x16x32_bf16 v[200:203], a[56:59], a[40:43], v[200:203]
    buffer_load_dwordx4 v0, s[4:7], s40 offen offset:1024 sc1 lds
    ds_read_b128 a[76:79], v7 offset:35840
    v_mfma_f32_16x16x32_bf16 v[204:207], a[28:31], a[8:11], 0
    ds_read_b128 a[108:111], v7 offset:52224
    v_mfma_f32_16x16x32_bf16 v[204:207], a[60:63], a[40:43], v[204:207]
    v_mfma_f32_16x16x32_bf16 v[208:211], a[16:19], a[12:15], 0
    v_mfma_f32_16x16x32_bf16 v[208:211], a[48:51], a[44:47], v[208:211]
    v_mfma_f32_16x16x32_bf16 v[212:215], a[20:23], a[12:15], 0
    v_mfma_f32_16x16x32_bf16 v[212:215], a[52:55], a[44:47], v[212:215]
    v_mfma_f32_16x16x32_bf16 v[216:219], a[24:27], a[12:15], 0
    v_mfma_f32_16x16x32_bf16 v[216:219], a[56:59], a[44:47], v[216:219]
    v_mfma_f32_16x16x32_bf16 v[220:223], a[28:31], a[12:15], 0
    s_add_u32 m0, s44, 66560
    v_mfma_f32_16x16x32_bf16 v[220:223], a[60:63], a[44:47], v[220:223]
    s_waitcnt vmcnt(18) lgkmcnt(0)
    s_barrier
    v_mfma_f32_16x16x32_bf16 v[160:163], a[80:83], a[64:67], v[160:163]
    buffer_load_dwordx4 v1, s[4:7], s40 offen offset:2048 sc1 lds
    ds_read_b128 a[0:3], v30 offset:0
    v_mfma_f32_16x16x32_bf16 v[160:163], a[112:115], a[96:99], v[160:163]
    ds_read_b128 a[32:35], v30 offset:16384
    v_mfma_f32_16x16x32_bf16 v[164:167], a[84:87], a[64:67], v[164:167]
    buffer_load_dwordx4 v1, s[4:7], s40 offen offset:3072 sc1 lds
    v_mfma_f32_16x16x32_bf16 v[164:167], a[116:119], a[96:99], v[164:167]
    ds_read_b128 a[16:19], v32 offset:0
    v_mfma_f32_16x16x32_bf16 v[168:171], a[88:91], a[64:67], v[168:171]
    s_add_u32 m0, s44, 74752
    s_add_u32 s40, s40, 262144
    buffer_load_dwordx4 v19, s[4:7], s41 offen offset:0 sc1 lds
    ds_read_b128 a[48:51], v32 offset:16384
    v_mfma_f32_16x16x32_bf16 v[168:171], a[120:123], a[96:99], v[168:171]
    v_mfma_f32_16x16x32_bf16 v[172:175], a[92:95], a[64:67], v[172:175]
    ds_read_b128 a[20:23], v32 offset:1024
    v_mfma_f32_16x16x32_bf16 v[172:175], a[124:127], a[96:99], v[172:175]
    buffer_load_dwordx4 v19, s[4:7], s41 offen offset:1024 sc1 lds
    ds_read_b128 a[52:55], v32 offset:17408
    v_mfma_f32_16x16x32_bf16 v[176:179], a[80:83], a[68:71], v[176:179]
    v_mfma_f32_16x16x32_bf16 v[176:179], a[112:115], a[100:103], v[176:179]
    buffer_load_dwordx4 v19, s[4:7], s41 offen offset:2048 sc1 lds
    ds_read_b128 a[24:27], v32 offset:2048
    v_mfma_f32_16x16x32_bf16 v[180:183], a[84:87], a[68:71], v[180:183]
    ds_read_b128 a[56:59], v32 offset:18432
    v_mfma_f32_16x16x32_bf16 v[180:183], a[116:119], a[100:103], v[180:183]
    v_mfma_f32_16x16x32_bf16 v[184:187], a[88:91], a[68:71], v[184:187]
    buffer_load_dwordx4 v19, s[4:7], s41 offen offset:3072 sc1 lds
    s_add_u32 s41, s41, 131072
    ds_read_b128 a[28:31], v32 offset:3072
    v_mfma_f32_16x16x32_bf16 v[184:187], a[120:123], a[100:103], v[184:187]
    s_add_u32 m0, s44, 99328
    ds_read_b128 a[60:63], v32 offset:19456
    v_mfma_f32_16x16x32_bf16 v[188:191], a[92:95], a[68:71], v[188:191]
    buffer_load_dwordx4 v0, s[4:7], s40 offen offset:0 sc1 lds
    v_mfma_f32_16x16x32_bf16 v[188:191], a[124:127], a[100:103], v[188:191]
    ds_read_b128 a[4:7], v30 offset:1024
    v_mfma_f32_16x16x32_bf16 v[192:195], a[80:83], a[72:75], v[192:195]
    buffer_load_dwordx4 v0, s[4:7], s40 offen offset:1024 sc1 lds
    ds_read_b128 a[36:39], v30 offset:17408
    v_mfma_f32_16x16x32_bf16 v[192:195], a[112:115], a[104:107], v[192:195]
    v_mfma_f32_16x16x32_bf16 v[196:199], a[84:87], a[72:75], v[196:199]
    ds_read_b128 a[8:11], v30 offset:2048
    v_mfma_f32_16x16x32_bf16 v[196:199], a[116:119], a[104:107], v[196:199]
    buffer_load_dwordx4 v1, s[4:7], s40 offen offset:2048 sc1 lds
    ds_read_b128 a[40:43], v30 offset:18432
    v_mfma_f32_16x16x32_bf16 v[200:203], a[88:91], a[72:75], v[200:203]
    v_mfma_f32_16x16x32_bf16 v[200:203], a[120:123], a[104:107], v[200:203]
    buffer_load_dwordx4 v1, s[4:7], s40 offen offset:3072 sc1 lds
    ds_read_b128 a[12:15], v30 offset:3072
    v_mfma_f32_16x16x32_bf16 v[204:207], a[92:95], a[72:75], v[204:207]
    ds_read_b128 a[44:47], v30 offset:19456
    v_mfma_f32_16x16x32_bf16 v[204:207], a[124:127], a[104:107], v[204:207]
    v_mfma_f32_16x16x32_bf16 v[208:211], a[80:83], a[76:79], v[208:211]
    v_mfma_f32_16x16x32_bf16 v[208:211], a[112:115], a[108:111], v[208:211]
    v_mov_b32 v22, 1
    v_mfma_f32_16x16x32_bf16 v[212:215], a[84:87], a[76:79], v[212:215]
    v_mov_b32 v23, 0
    v_mfma_f32_16x16x32_bf16 v[212:215], a[116:119], a[108:111], v[212:215]
    s_add_u32 s48, s15, 32768
    v_mfma_f32_16x16x32_bf16 v[216:219], a[88:91], a[76:79], v[216:219]
    s_load_dwordx2 s[28:29], s[0:1], 64
    v_mfma_f32_16x16x32_bf16 v[216:219], a[120:123], a[108:111], v[216:219]
    v_and_b32 v10, 15, v2
    v_mfma_f32_16x16x32_bf16 v[220:223], a[92:95], a[76:79], v[220:223]
    v_lshlrev_b32 v10, 2, v10
    v_mfma_f32_16x16x32_bf16 v[220:223], a[124:127], a[108:111], v[220:223]
    s_xor_b32 s47, s76, 16384
    s_waitcnt vmcnt(12) lgkmcnt(0)
    s_barrier
    v_mfma_f32_16x16x32_bf16 v[160:163], a[16:19], a[0:3], v[160:163]
    s_add_u32 m0, s44, 107520
    s_add_u32 s40, s40, 262144
    buffer_load_dwordx4 v19, s[4:7], s41 offen offset:0 sc1 lds
    ds_read_b128 a[64:67], v4 offset:0
    v_mfma_f32_16x16x32_bf16 v[160:163], a[48:51], a[32:35], v[160:163]
    ds_read_b128 a[96:99], v4 offset:16384
    v_mfma_f32_16x16x32_bf16 v[164:167], a[20:23], a[0:3], v[164:167]
    buffer_load_dwordx4 v19, s[4:7], s41 offen offset:1024 sc1 lds
    v_mfma_f32_16x16x32_bf16 v[164:167], a[52:55], a[32:35], v[164:167]
    ds_read_b128 a[80:83], v6 offset:0
    v_mfma_f32_16x16x32_bf16 v[168:171], a[24:27], a[0:3], v[168:171]
    buffer_load_dwordx4 v19, s[4:7], s41 offen offset:2048 sc1 lds
    ds_read_b128 a[112:115], v6 offset:16384
    v_mfma_f32_16x16x32_bf16 v[168:171], a[56:59], a[32:35], v[168:171]
    v_mfma_f32_16x16x32_bf16 v[172:175], a[28:31], a[0:3], v[172:175]
    ds_read_b128 a[84:87], v6 offset:1024
    v_mfma_f32_16x16x32_bf16 v[172:175], a[60:63], a[32:35], v[172:175]
    buffer_load_dwordx4 v19, s[4:7], s41 offen offset:3072 sc1 lds
    s_add_u32 s41, s41, 131072
    ds_read_b128 a[116:119], v6 offset:17408
    v_mfma_f32_16x16x32_bf16 v[176:179], a[16:19], a[4:7], v[176:179]
    s_add_u32 m0, s44, 132096
    v_mfma_f32_16x16x32_bf16 v[176:179], a[48:51], a[36:39], v[176:179]
    buffer_load_dwordx4 v0, s[4:7], s40 offen offset:0 sc1 lds
    ds_read_b128 a[88:91], v6 offset:2048
    v_mfma_f32_16x16x32_bf16 v[180:183], a[20:23], a[4:7], v[180:183]
    ds_read_b128 a[120:123], v6 offset:18432
    v_mfma_f32_16x16x32_bf16 v[180:183], a[52:55], a[36:39], v[180:183]
    v_mfma_f32_16x16x32_bf16 v[184:187], a[24:27], a[4:7], v[184:187]
    buffer_load_dwordx4 v0, s[4:7], s40 offen offset:1024 sc1 lds
    ds_read_b128 a[92:95], v6 offset:3072
    v_mfma_f32_16x16x32_bf16 v[184:187], a[56:59], a[36:39], v[184:187]
    ds_read_b128 a[124:127], v6 offset:19456
    v_mfma_f32_16x16x32_bf16 v[188:191], a[28:31], a[4:7], v[188:191]
    buffer_load_dwordx4 v1, s[4:7], s40 offen offset:2048 sc1 lds
    v_mfma_f32_16x16x32_bf16 v[188:191], a[60:63], a[36:39], v[188:191]
    ds_read_b128 a[68:71], v4 offset:1024
    v_mfma_f32_16x16x32_bf16 v[192:195], a[16:19], a[8:11], v[192:195]
    buffer_load_dwordx4 v1, s[4:7], s40 offen offset:3072 sc1 lds
    ds_read_b128 a[100:103], v4 offset:17408
    v_mfma_f32_16x16x32_bf16 v[192:195], a[48:51], a[40:43], v[192:195]
    v_mfma_f32_16x16x32_bf16 v[196:199], a[20:23], a[8:11], v[196:199]
    ds_read_b128 a[72:75], v4 offset:2048
    v_mfma_f32_16x16x32_bf16 v[196:199], a[52:55], a[40:43], v[196:199]
    s_add_u32 m0, s44, 140288
    s_add_u32 s40, s40, 262144
    buffer_load_dwordx4 v19, s[4:7], s41 offen offset:0 sc1 lds
    ds_read_b128 a[104:107], v4 offset:18432
    v_mfma_f32_16x16x32_bf16 v[200:203], a[24:27], a[8:11], v[200:203]
    v_mfma_f32_16x16x32_bf16 v[200:203], a[56:59], a[40:43], v[200:203]
    buffer_load_dwordx4 v19, s[4:7], s41 offen offset:1024 sc1 lds
    ds_read_b128 a[76:79], v4 offset:3072
    v_mfma_f32_16x16x32_bf16 v[204:207], a[28:31], a[8:11], v[204:207]
    ds_read_b128 a[108:111], v4 offset:19456
    v_mfma_f32_16x16x32_bf16 v[204:207], a[60:63], a[40:43], v[204:207]
    v_mfma_f32_16x16x32_bf16 v[208:211], a[16:19], a[12:15], v[208:211]
    v_mfma_f32_16x16x32_bf16 v[208:211], a[48:51], a[44:47], v[208:211]
    s_lshl_b32 s72, s9, 9
    v_mfma_f32_16x16x32_bf16 v[212:215], a[20:23], a[12:15], v[212:215]
    s_lshl_b32 s73, s70, 8
    v_mfma_f32_16x16x32_bf16 v[212:215], a[52:55], a[44:47], v[212:215]
    s_add_u32 s72, s72, s73
    v_mfma_f32_16x16x32_bf16 v[216:219], a[24:27], a[12:15], v[216:219]
    s_add_u32 s72, s72, 50331648
    v_mfma_f32_16x16x32_bf16 v[216:219], a[56:59], a[44:47], v[216:219]
    s_lshl_b32 s73, s8, 7
    v_mfma_f32_16x16x32_bf16 v[220:223], a[28:31], a[12:15], v[220:223]
    s_add_u32 m0, s44, 140288
    s_add_u32 s74, s72, s73
    v_mfma_f32_16x16x32_bf16 v[220:223], a[60:63], a[44:47], v[220:223]
    s_xor_b32 s73, s73, 128
    s_waitcnt vmcnt(14) lgkmcnt(0)
    s_barrier
    s_nop 0
    v_mfma_f32_16x16x32_bf16 v[160:163], a[80:83], a[64:67], v[160:163]
    buffer_load_dwordx4 v19, s[4:7], s41 offen offset:2048 sc1 lds
    ds_read_b128 a[0:3], v7 offset:0
    v_mfma_f32_16x16x32_bf16 v[160:163], a[112:115], a[96:99], v[160:163]
    ds_read_b128 a[32:35], v7 offset:16384
    v_mfma_f32_16x16x32_bf16 v[164:167], a[84:87], a[64:67], v[164:167]
    buffer_load_dwordx4 v19, s[4:7], s41 offen offset:3072 sc1 lds
    s_add_u32 s41, s41, 131072
    v_mfma_f32_16x16x32_bf16 v[164:167], a[116:119], a[96:99], v[164:167]
    s_add_u32 m0, s44, 1024
    ds_read_b128 a[16:19], v9 offset:0
    v_mfma_f32_16x16x32_bf16 v[168:171], a[88:91], a[64:67], v[168:171]
    buffer_load_dwordx4 v0, s[4:7], s40 offen offset:0 sc1 lds
    ds_read_b128 a[48:51], v9 offset:16384
    v_mfma_f32_16x16x32_bf16 v[168:171], a[120:123], a[96:99], v[168:171]
    v_mfma_f32_16x16x32_bf16 v[172:175], a[92:95], a[64:67], v[172:175]
    ds_read_b128 a[20:23], v9 offset:1024
    v_mfma_f32_16x16x32_bf16 v[172:175], a[124:127], a[96:99], v[172:175]
    buffer_load_dwordx4 v0, s[4:7], s40 offen offset:1024 sc1 lds
    ds_read_b128 a[52:55], v9 offset:17408
    v_mfma_f32_16x16x32_bf16 v[176:179], a[80:83], a[68:71], v[176:179]
    v_mfma_f32_16x16x32_bf16 v[176:179], a[112:115], a[100:103], v[176:179]
    buffer_load_dwordx4 v1, s[4:7], s40 offen offset:2048 sc1 lds
    ds_read_b128 a[24:27], v9 offset:2048
    v_mfma_f32_16x16x32_bf16 v[180:183], a[84:87], a[68:71], v[180:183]
    ds_read_b128 a[56:59], v9 offset:18432
    v_mfma_f32_16x16x32_bf16 v[180:183], a[116:119], a[100:103], v[180:183]
    v_mfma_f32_16x16x32_bf16 v[184:187], a[88:91], a[68:71], v[184:187]
    buffer_load_dwordx4 v1, s[4:7], s40 offen offset:3072 sc1 lds
    ds_read_b128 a[28:31], v9 offset:3072
    v_mfma_f32_16x16x32_bf16 v[184:187], a[120:123], a[100:103], v[184:187]
    ds_read_b128 a[60:63], v9 offset:19456
    v_mfma_f32_16x16x32_bf16 v[188:191], a[92:95], a[68:71], v[188:191]
    s_add_u32 m0, s44, 9216
    s_add_u32 s40, s40, 262144
    buffer_load_dwordx4 v19, s[4:7], s41 offen offset:0 sc1 lds
    v_mfma_f32_16x16x32_bf16 v[188:191], a[124:127], a[100:103], v[188:191]
    ds_read_b128 a[4:7], v7 offset:1024
    v_mfma_f32_16x16x32_bf16 v[192:195], a[80:83], a[72:75], v[192:195]
    buffer_load_dwordx4 v19, s[4:7], s41 offen offset:1024 sc1 lds
    ds_read_b128 a[36:39], v7 offset:17408
    v_mfma_f32_16x16x32_bf16 v[192:195], a[112:115], a[104:107], v[192:195]
    v_mfma_f32_16x16x32_bf16 v[196:199], a[84:87], a[72:75], v[196:199]
    ds_read_b128 a[8:11], v7 offset:2048
    v_mfma_f32_16x16x32_bf16 v[196:199], a[116:119], a[104:107], v[196:199]
    buffer_load_dwordx4 v19, s[4:7], s41 offen offset:2048 sc1 lds
    ds_read_b128 a[40:43], v7 offset:18432
    v_mfma_f32_16x16x32_bf16 v[200:203], a[88:91], a[72:75], v[200:203]
    v_mfma_f32_16x16x32_bf16 v[200:203], a[120:123], a[104:107], v[200:203]
    buffer_load_dwordx4 v19, s[4:7], s41 offen offset:3072 sc1 lds
    s_add_u32 s41, s41, 131072
    ds_read_b128 a[12:15], v7 offset:3072
    v_mfma_f32_16x16x32_bf16 v[204:207], a[92:95], a[72:75], v[204:207]
    ds_read_b128 a[44:47], v7 offset:19456
    v_mfma_f32_16x16x32_bf16 v[204:207], a[124:127], a[104:107], v[204:207]
    v_mfma_f32_16x16x32_bf16 v[208:211], a[80:83], a[76:79], v[208:211]
    v_mfma_f32_16x16x32_bf16 v[208:211], a[112:115], a[108:111], v[208:211]
    s_add_u32 s75, s72, s73
    v_mfma_f32_16x16x32_bf16 v[212:215], a[84:87], a[76:79], v[212:215]
    v_and_b32 v11, 0x3ff, v29
    v_mfma_f32_16x16x32_bf16 v[212:215], a[116:119], a[108:111], v[212:215]
    s_lshl_b32 s72, s56, 10
    v_mfma_f32_16x16x32_bf16 v[216:219], a[88:91], a[76:79], v[216:219]
    s_add_u32 s45, s45, s72
    v_mfma_f32_16x16x32_bf16 v[216:219], a[120:123], a[108:111], v[216:219]
    s_add_u32 s45, s45, 32768
    v_mfma_f32_16x16x32_bf16 v[220:223], a[92:95], a[76:79], v[220:223]
    s_add_u32 m0, s44, 66560
    v_mov_b32 v16, 0x3f80
    v_mfma_f32_16x16x32_bf16 v[220:223], a[124:127], a[108:111], v[220:223]
    v_mov_b32 v17, 0x3f800000
    s_waitcnt vmcnt(16) lgkmcnt(0)
    s_barrier
    v_mfma_f32_16x16x32_bf16 v[160:163], a[16:19], a[0:3], v[160:163]
    buffer_load_dwordx4 v0, s[4:7], s40 offen offset:0 sc1 lds
    ds_read_b128 a[64:67], v7 offset:32768
    v_mfma_f32_16x16x32_bf16 v[160:163], a[48:51], a[32:35], v[160:163]
    ds_read_b128 a[96:99], v7 offset:49152
    v_mfma_f32_16x16x32_bf16 v[164:167], a[20:23], a[0:3], v[164:167]
    v_mfma_f32_16x16x32_bf16 v[164:167], a[52:55], a[32:35], v[164:167]
    buffer_load_dwordx4 v0, s[4:7], s40 offen offset:1024 sc1 lds
    ds_read_b128 a[80:83], v9 offset:32768
    v_mfma_f32_16x16x32_bf16 v[168:171], a[24:27], a[0:3], v[168:171]
    ds_read_b128 a[112:115], v9 offset:49152
    v_mfma_f32_16x16x32_bf16 v[168:171], a[56:59], a[32:35], v[168:171]
    v_mfma_f32_16x16x32_bf16 v[172:175], a[28:31], a[0:3], v[172:175]
    buffer_load_dwordx4 v1, s[4:7], s40 offen offset:2048 sc1 lds
    ds_read_b128 a[84:87], v9 offset:33792
    v_mfma_f32_16x16x32_bf16 v[172:175], a[60:63], a[32:35], v[172:175]
    ds_read_b128 a[116:119], v9 offset:50176
    v_mfma_f32_16x16x32_bf16 v[176:179], a[16:19], a[4:7], v[176:179]
    v_mfma_f32_16x16x32_bf16 v[176:179], a[48:51], a[36:39], v[176:179]
    buffer_load_dwordx4 v1, s[4:7], s40 offen offset:3072 sc1 lds
    ds_read_b128 a[88:91], v9 offset:34816
    v_mfma_f32_16x16x32_bf16 v[180:183], a[20:23], a[4:7], v[180:183]
    ds_read_b128 a[120:123], v9 offset:51200
    v_mfma_f32_16x16x32_bf16 v[180:183], a[52:55], a[36:39], v[180:183]
    v_mfma_f32_16x16x32_bf16 v[184:187], a[24:27], a[4:7], v[184:187]
    s_add_u32 m0, s44, 74752
    s_add_u32 s40, s40, 262144
    buffer_load_dwordx4 v19, s[4:7], s41 offen offset:0 sc1 lds
    ds_read_b128 a[92:95], v9 offset:35840
    v_mfma_f32_16x16x32_bf16 v[184:187], a[56:59], a[36:39], v[184:187]
    ds_read_b128 a[124:127], v9 offset:52224
    v_mfma_f32_16x16x32_bf16 v[188:191], a[28:31], a[4:7], v[188:191]
    v_mfma_f32_16x16x32_bf16 v[188:191], a[60:63], a[36:39], v[188:191]
    buffer_load_dwordx4 v19, s[4:7], s41 offen offset:1024 sc1 lds
    ds_read_b128 a[68:71], v7 offset:33792
    v_mfma_f32_16x16x32_bf16 v[192:195], a[16:19], a[8:11], v[192:195]
    ds_read_b128 a[100:103], v7 offset:50176
    v_mfma_f32_16x16x32_bf16 v[192:195], a[48:51], a[40:43], v[192:195]
    v_mfma_f32_16x16x32_bf16 v[196:199], a[20:23], a[8:11], v[196:199]
    buffer_load_dwordx4 v19, s[4:7], s41 offen offset:2048 sc1 lds
    ds_read_b128 a[72:75], v7 offset:34816
    v_mfma_f32_16x16x32_bf16 v[196:199], a[52:55], a[40:43], v[196:199]
    ds_read_b128 a[104:107], v7 offset:51200
    v_mfma_f32_16x16x32_bf16 v[200:203], a[24:27], a[8:11], v[200:203]
    v_mfma_f32_16x16x32_bf16 v[200:203], a[56:59], a[40:43], v[200:203]
    buffer_load_dwordx4 v19, s[4:7], s41 offen offset:3072 sc1 lds
    s_add_u32 s41, s41, 131072
    ds_read_b128 a[76:79], v7 offset:35840
    v_mfma_f32_16x16x32_bf16 v[204:207], a[28:31], a[8:11], v[204:207]
    ds_read_b128 a[108:111], v7 offset:52224
    v_mfma_f32_16x16x32_bf16 v[204:207], a[60:63], a[40:43], v[204:207]
    v_mfma_f32_16x16x32_bf16 v[208:211], a[16:19], a[12:15], v[208:211]
    v_mfma_f32_16x16x32_bf16 v[208:211], a[48:51], a[44:47], v[208:211]
    v_mfma_f32_16x16x32_bf16 v[212:215], a[20:23], a[12:15], v[212:215]
    v_mfma_f32_16x16x32_bf16 v[212:215], a[52:55], a[44:47], v[212:215]
    v_mfma_f32_16x16x32_bf16 v[216:219], a[24:27], a[12:15], v[216:219]
    v_mfma_f32_16x16x32_bf16 v[216:219], a[56:59], a[44:47], v[216:219]
    v_mfma_f32_16x16x32_bf16 v[220:223], a[28:31], a[12:15], v[220:223]
    s_add_u32 m0, s44, 99328
    v_mfma_f32_16x16x32_bf16 v[220:223], a[60:63], a[44:47], v[220:223]
    s_waitcnt vmcnt(16) lgkmcnt(0)
    s_barrier
    v_mfma_f32_16x16x32_bf16 v[160:163], a[80:83], a[64:67], v[160:163]
    buffer_load_dwordx4 v0, s[4:7], s40 offen offset:0 sc1 lds
    ds_read_b128 a[0:3], v30 offset:0
    v_mfma_f32_16x16x32_bf16 v[160:163], a[112:115], a[96:99], v[160:163]
    ds_read_b128 a[32:35], v30 offset:16384
    v_mfma_f32_16x16x32_bf16 v[164:167], a[84:87], a[64:67], v[164:167]
    v_mfma_f32_16x16x32_bf16 v[164:167], a[116:119], a[96:99], v[164:167]
    buffer_load_dwordx4 v0, s[4:7], s40 offen offset:1024 sc1 lds
    ds_read_b128 a[16:19], v32 offset:0
    v_mfma_f32_16x16x32_bf16 v[168:171], a[88:91], a[64:67], v[168:171]
    ds_read_b128 a[48:51], v32 offset:16384
    v_mfma_f32_16x16x32_bf16 v[168:171], a[120:123], a[96:99], v[168:171]
    v_mfma_f32_16x16x32_bf16 v[172:175], a[92:95], a[64:67], v[172:175]
    buffer_load_dwordx4 v1, s[4:7], s40 offen offset:2048 sc1 lds
    ds_read_b128 a[20:23], v32 offset:1024
    v_mfma_f32_16x16x32_bf16 v[172:175], a[124:127], a[96:99], v[172:175]
    ds_read_b128 a[52:55], v32 offset:17408
    v_mfma_f32_16x16x32_bf16 v[176:179], a[80:83], a[68:71], v[176:179]
    v_mfma_f32_16x16x32_bf16 v[176:179], a[112:115], a[100:103], v[176:179]
    buffer_load_dwordx4 v1, s[4:7], s40 offen offset:3072 sc1 lds
    ds_read_b128 a[24:27], v32 offset:2048
    v_mfma_f32_16x16x32_bf16 v[180:183], a[84:87], a[68:71], v[180:183]
    ds_read_b128 a[56:59], v32 offset:18432
    v_mfma_f32_16x16x32_bf16 v[180:183], a[116:119], a[100:103], v[180:183]
    v_mfma_f32_16x16x32_bf16 v[184:187], a[88:91], a[68:71], v[184:187]
    s_add_u32 m0, s44, 107520
    s_add_u32 s40, s40, 262144
    buffer_load_dwordx4 v19, s[4:7], s41 offen offset:0 sc1 lds
    ds_read_b128 a[28:31], v32 offset:3072
    v_mfma_f32_16x16x32_bf16 v[184:187], a[120:123], a[100:103], v[184:187]
    ds_read_b128 a[60:63], v32 offset:19456
    v_mfma_f32_16x16x32_bf16 v[188:191], a[92:95], a[68:71], v[188:191]
    v_mfma_f32_16x16x32_bf16 v[188:191], a[124:127], a[100:103], v[188:191]
    buffer_load_dwordx4 v19, s[4:7], s41 offen offset:1024 sc1 lds
    ds_read_b128 a[4:7], v30 offset:1024
    v_mfma_f32_16x16x32_bf16 v[192:195], a[80:83], a[72:75], v[192:195]
    ds_read_b128 a[36:39], v30 offset:17408
    v_mfma_f32_16x16x32_bf16 v[192:195], a[112:115], a[104:107], v[192:195]
    v_mfma_f32_16x16x32_bf16 v[196:199], a[84:87], a[72:75], v[196:199]
    buffer_load_dwordx4 v19, s[4:7], s41 offen offset:2048 sc1 lds
    ds_read_b128 a[8:11], v30 offset:2048
    v_mfma_f32_16x16x32_bf16 v[196:199], a[116:119], a[104:107], v[196:199]
    ds_read_b128 a[40:43], v30 offset:18432
    v_mfma_f32_16x16x32_bf16 v[200:203], a[88:91], a[72:75], v[200:203]
    v_mfma_f32_16x16x32_bf16 v[200:203], a[120:123], a[104:107], v[200:203]
    buffer_load_dwordx4 v19, s[4:7], s41 offen offset:3072 sc1 lds
    s_add_u32 s41, s41, 131072
    ds_read_b128 a[12:15], v30 offset:3072
    v_mfma_f32_16x16x32_bf16 v[204:207], a[92:95], a[72:75], v[204:207]
    ds_read_b128 a[44:47], v30 offset:19456
    v_mfma_f32_16x16x32_bf16 v[204:207], a[124:127], a[104:107], v[204:207]
    v_mfma_f32_16x16x32_bf16 v[208:211], a[80:83], a[76:79], v[208:211]
    v_mfma_f32_16x16x32_bf16 v[208:211], a[112:115], a[108:111], v[208:211]
    v_mfma_f32_16x16x32_bf16 v[212:215], a[84:87], a[76:79], v[212:215]
    v_mfma_f32_16x16x32_bf16 v[212:215], a[116:119], a[108:111], v[212:215]
    v_mfma_f32_16x16x32_bf16 v[216:219], a[88:91], a[76:79], v[216:219]
    v_mfma_f32_16x16x32_bf16 v[216:219], a[120:123], a[108:111], v[216:219]
    v_mfma_f32_16x16x32_bf16 v[220:223], a[92:95], a[76:79], v[220:223]
    s_add_u32 m0, s44, 132096
    s_mov_b64 exec, 1
    buffer_store_dword v22, v23, s[4:7], s48 offen sc1
    s_mov_b64 exec, -1
    v_mfma_f32_16x16x32_bf16 v[220:223], a[124:127], a[108:111], v[220:223]
    s_waitcnt vmcnt(17) lgkmcnt(0)
    s_barrier
    v_mfma_f32_16x16x32_bf16 v[160:163], a[16:19], a[0:3], v[160:163]
    buffer_load_dwordx4 v0, s[4:7], s40 offen offset:0 sc1 lds
    ds_read_b128 a[64:67], v4 offset:0
    v_mfma_f32_16x16x32_bf16 v[160:163], a[48:51], a[32:35], v[160:163]
    ds_read_b128 a[96:99], v4 offset:16384
    v_mfma_f32_16x16x32_bf16 v[164:167], a[20:23], a[0:3], v[164:167]
    v_mfma_f32_16x16x32_bf16 v[164:167], a[52:55], a[32:35], v[164:167]
    buffer_load_dwordx4 v0, s[4:7], s40 offen offset:1024 sc1 lds
    ds_read_b128 a[80:83], v6 offset:0
    v_mfma_f32_16x16x32_bf16 v[168:171], a[24:27], a[0:3], v[168:171]
    ds_read_b128 a[112:115], v6 offset:16384
    v_mfma_f32_16x16x32_bf16 v[168:171], a[56:59], a[32:35], v[168:171]
    v_mfma_f32_16x16x32_bf16 v[172:175], a[28:31], a[0:3], v[172:175]
    buffer_load_dwordx4 v1, s[4:7], s40 offen offset:2048 sc1 lds
    ds_read_b128 a[84:87], v6 offset:1024
    v_mfma_f32_16x16x32_bf16 v[172:175], a[60:63], a[32:35], v[172:175]
    ds_read_b128 a[116:119], v6 offset:17408
    v_mfma_f32_16x16x32_bf16 v[176:179], a[16:19], a[4:7], v[176:179]
    v_mfma_f32_16x16x32_bf16 v[176:179], a[48:51], a[36:39], v[176:179]
    buffer_load_dwordx4 v1, s[4:7], s40 offen offset:3072 sc1 lds
    ds_read_b128 a[88:91], v6 offset:2048
    v_mfma_f32_16x16x32_bf16 v[180:183], a[20:23], a[4:7], v[180:183]
    ds_read_b128 a[120:123], v6 offset:18432
    v_mfma_f32_16x16x32_bf16 v[180:183], a[52:55], a[36:39], v[180:183]
    v_mfma_f32_16x16x32_bf16 v[184:187], a[24:27], a[4:7], v[184:187]
    s_add_u32 m0, s44, 140288
    s_add_u32 s40, s40, 262144
    buffer_load_dwordx4 v19, s[4:7], s41 offen offset:0 sc1 lds
    ds_read_b128 a[92:95], v6 offset:3072
    v_mfma_f32_16x16x32_bf16 v[184:187], a[56:59], a[36:39], v[184:187]
    ds_read_b128 a[124:127], v6 offset:19456
    v_mfma_f32_16x16x32_bf16 v[188:191], a[28:31], a[4:7], v[188:191]
    v_mfma_f32_16x16x32_bf16 v[188:191], a[60:63], a[36:39], v[188:191]
    buffer_load_dwordx4 v19, s[4:7], s41 offen offset:1024 sc1 lds
    ds_read_b128 a[68:71], v4 offset:1024
    v_mfma_f32_16x16x32_bf16 v[192:195], a[16:19], a[8:11], v[192:195]
    ds_read_b128 a[100:103], v4 offset:17408
    v_mfma_f32_16x16x32_bf16 v[192:195], a[48:51], a[40:43], v[192:195]
    v_mfma_f32_16x16x32_bf16 v[196:199], a[20:23], a[8:11], v[196:199]
    buffer_load_dwordx4 v19, s[4:7], s41 offen offset:2048 sc1 lds
    ds_read_b128 a[72:75], v4 offset:2048
    v_mfma_f32_16x16x32_bf16 v[196:199], a[52:55], a[40:43], v[196:199]
    ds_read_b128 a[104:107], v4 offset:18432
    v_mfma_f32_16x16x32_bf16 v[200:203], a[24:27], a[8:11], v[200:203]
    v_mfma_f32_16x16x32_bf16 v[200:203], a[56:59], a[40:43], v[200:203]
    buffer_load_dwordx4 v19, s[4:7], s41 offen offset:3072 sc1 lds
    s_add_u32 s41, s41, 131072
    ds_read_b128 a[76:79], v4 offset:3072
    v_mfma_f32_16x16x32_bf16 v[204:207], a[28:31], a[8:11], v[204:207]
    ds_read_b128 a[108:111], v4 offset:19456
    v_mfma_f32_16x16x32_bf16 v[204:207], a[60:63], a[40:43], v[204:207]
    buffer_load_dword v12, v10, s[4:7], s74 offen offset:0 sc1
    v_mfma_f32_16x16x32_bf16 v[208:211], a[16:19], a[12:15], v[208:211]
    v_mfma_f32_16x16x32_bf16 v[208:211], a[48:51], a[44:47], v[208:211]
    v_mfma_f32_16x16x32_bf16 v[212:215], a[20:23], a[12:15], v[212:215]
    v_mfma_f32_16x16x32_bf16 v[212:215], a[52:55], a[44:47], v[212:215]
    v_mfma_f32_16x16x32_bf16 v[216:219], a[24:27], a[12:15], v[216:219]
    v_mfma_f32_16x16x32_bf16 v[216:219], a[56:59], a[44:47], v[216:219]
    v_mfma_f32_16x16x32_bf16 v[220:223], a[28:31], a[12:15], v[220:223]
    s_add_u32 m0, s44, 1024
    v_mfma_f32_16x16x32_bf16 v[220:223], a[60:63], a[44:47], v[220:223]
    buffer_load_dword v13, v10, s[4:7], s74 offen offset:64 sc1
    s_waitcnt vmcnt(19) lgkmcnt(0)
    s_barrier
    v_mfma_f32_16x16x32_bf16 v[160:163], a[80:83], a[64:67], v[160:163]
    buffer_load_dwordx4 v0, s[4:7], s40 offen offset:0 sc1 lds
    ds_read_b128 a[0:3], v7 offset:0
    v_mfma_f32_16x16x32_bf16 v[160:163], a[112:115], a[96:99], v[160:163]
    ds_read_b128 a[32:35], v7 offset:16384
    v_mfma_f32_16x16x32_bf16 v[164:167], a[84:87], a[64:67], v[164:167]
    v_mfma_f32_16x16x32_bf16 v[164:167], a[116:119], a[96:99], v[164:167]
    buffer_load_dwordx4 v0, s[4:7], s40 offen offset:1024 sc1 lds
    ds_read_b128 a[16:19], v9 offset:0
    v_mfma_f32_16x16x32_bf16 v[168:171], a[88:91], a[64:67], v[168:171]
    ds_read_b128 a[48:51], v9 offset:16384
    v_mfma_f32_16x16x32_bf16 v[168:171], a[120:123], a[96:99], v[168:171]
    v_mfma_f32_16x16x32_bf16 v[172:175], a[92:95], a[64:67], v[172:175]
    buffer_load_dwordx4 v1, s[4:7], s40 offen offset:2048 sc1 lds
    ds_read_b128 a[20:23], v9 offset:1024
    v_mfma_f32_16x16x32_bf16 v[172:175], a[124:127], a[96:99], v[172:175]
    ds_read_b128 a[52:55], v9 offset:17408
    v_mfma_f32_16x16x32_bf16 v[176:179], a[80:83], a[68:71], v[176:179]
    v_mfma_f32_16x16x32_bf16 v[176:179], a[112:115], a[100:103], v[176:179]
    buffer_load_dwordx4 v1, s[4:7], s40 offen offset:3072 sc1 lds
    ds_read_b128 a[24:27], v9 offset:2048
    v_mfma_f32_16x16x32_bf16 v[180:183], a[84:87], a[68:71], v[180:183]
    ds_read_b128 a[56:59], v9 offset:18432
    v_mfma_f32_16x16x32_bf16 v[180:183], a[116:119], a[100:103], v[180:183]
    v_mfma_f32_16x16x32_bf16 v[184:187], a[88:91], a[68:71], v[184:187]
    s_add_u32 m0, s44, 9216
    s_add_u32 s40, s40, 262144
    buffer_load_dwordx4 v19, s[4:7], s41 offen offset:0 sc1 lds
    ds_read_b128 a[28:31], v9 offset:3072
    v_mfma_f32_16x16x32_bf16 v[184:187], a[120:123], a[100:103], v[184:187]
    ds_read_b128 a[60:63], v9 offset:19456
    v_mfma_f32_16x16x32_bf16 v[188:191], a[92:95], a[68:71], v[188:191]
    v_mfma_f32_16x16x32_bf16 v[188:191], a[124:127], a[100:103], v[188:191]
    buffer_load_dwordx4 v19, s[4:7], s41 offen offset:1024 sc1 lds
    ds_read_b128 a[4:7], v7 offset:1024
    v_mfma_f32_16x16x32_bf16 v[192:195], a[80:83], a[72:75], v[192:195]
    ds_read_b128 a[36:39], v7 offset:17408
    v_mfma_f32_16x16x32_bf16 v[192:195], a[112:115], a[104:107], v[192:195]
    v_mfma_f32_16x16x32_bf16 v[196:199], a[84:87], a[72:75], v[196:199]
    buffer_load_dwordx4 v19, s[4:7], s41 offen offset:2048 sc1 lds
    ds_read_b128 a[8:11], v7 offset:2048
    v_mfma_f32_16x16x32_bf16 v[196:199], a[116:119], a[104:107], v[196:199]
    ds_read_b128 a[40:43], v7 offset:18432
    v_mfma_f32_16x16x32_bf16 v[200:203], a[88:91], a[72:75], v[200:203]
    v_mfma_f32_16x16x32_bf16 v[200:203], a[120:123], a[104:107], v[200:203]
    buffer_load_dwordx4 v19, s[4:7], s41 offen offset:3072 sc1 lds
    s_add_u32 s41, s41, 131072
    ds_read_b128 a[12:15], v7 offset:3072
    v_mfma_f32_16x16x32_bf16 v[204:207], a[92:95], a[72:75], v[204:207]
    ds_read_b128 a[44:47], v7 offset:19456
    v_mfma_f32_16x16x32_bf16 v[204:207], a[124:127], a[104:107], v[204:207]
    v_mfma_f32_16x16x32_bf16 v[208:211], a[80:83], a[76:79], v[208:211]
    buffer_load_dword v14, v10, s[4:7], s75 offen offset:0 sc1
    v_mfma_f32_16x16x32_bf16 v[208:211], a[112:115], a[108:111], v[208:211]
    v_mfma_f32_16x16x32_bf16 v[212:215], a[84:87], a[76:79], v[212:215]
    v_mfma_f32_16x16x32_bf16 v[212:215], a[116:119], a[108:111], v[212:215]
    buffer_load_dword v15, v10, s[4:7], s75 offen offset:64 sc1
    v_mfma_f32_16x16x32_bf16 v[216:219], a[88:91], a[76:79], v[216:219]
    v_mfma_f32_16x16x32_bf16 v[216:219], a[120:123], a[108:111], v[216:219]
    v_mfma_f32_16x16x32_bf16 v[220:223], a[92:95], a[76:79], v[220:223]
    s_add_u32 m0, s44, 66560
    v_mfma_f32_16x16x32_bf16 v[220:223], a[124:127], a[108:111], v[220:223]
    s_mov_b32 s55, 0
    s_nop 0
Lf_loop2:
    s_waitcnt vmcnt(16) lgkmcnt(0)
    s_barrier
    v_mfma_f32_16x16x32_bf16 v[160:163], a[16:19], a[0:3], v[160:163]
    buffer_load_dwordx4 v0, s[4:7], s40 offen offset:0 sc1 lds
    ds_read_b128 a[64:67], v7 offset:32768
    v_mfma_f32_16x16x32_bf16 v[160:163], a[48:51], a[32:35], v[160:163]
    ds_read_b128 a[96:99], v7 offset:49152
    v_mfma_f32_16x16x32_bf16 v[164:167], a[20:23], a[0:3], v[164:167]
    v_mfma_f32_16x16x32_bf16 v[164:167], a[52:55], a[32:35], v[164:167]
    buffer_load_dwordx4 v0, s[4:7], s40 offen offset:1024 sc1 lds
    ds_read_b128 a[80:83], v9 offset:32768
    v_mfma_f32_16x16x32_bf16 v[168:171], a[24:27], a[0:3], v[168:171]
    ds_read_b128 a[112:115], v9 offset:49152
    v_mfma_f32_16x16x32_bf16 v[168:171], a[56:59], a[32:35], v[168:171]
    v_mfma_f32_16x16x32_bf16 v[172:175], a[28:31], a[0:3], v[172:175]
    buffer_load_dwordx4 v1, s[4:7], s40 offen offset:2048 sc1 lds
    ds_read_b128 a[84:87], v9 offset:33792
    v_mfma_f32_16x16x32_bf16 v[172:175], a[60:63], a[32:35], v[172:175]
    ds_read_b128 a[116:119], v9 offset:50176
    v_mfma_f32_16x16x32_bf16 v[176:179], a[16:19], a[4:7], v[176:179]
    v_mfma_f32_16x16x32_bf16 v[176:179], a[48:51], a[36:39], v[176:179]
    buffer_load_dwordx4 v1, s[4:7], s40 offen offset:3072 sc1 lds
    ds_read_b128 a[88:91], v9 offset:34816
    v_mfma_f32_16x16x32_bf16 v[180:183], a[20:23], a[4:7], v[180:183]
    ds_read_b128 a[120:123], v9 offset:51200
    v_mfma_f32_16x16x32_bf16 v[180:183], a[52:55], a[36:39], v[180:183]
    v_mfma_f32_16x16x32_bf16 v[184:187], a[24:27], a[4:7], v[184:187]
    s_add_u32 m0, s44, 74752
    s_add_u32 s40, s40, 262144
    buffer_load_dwordx4 v19, s[4:7], s41 offen offset:0 sc1 lds
    ds_read_b128 a[92:95], v9 offset:35840
    v_mfma_f32_16x16x32_bf16 v[184:187], a[56:59], a[36:39], v[184:187]
    ds_read_b128 a[124:127], v9 offset:52224
    v_mfma_f32_16x16x32_bf16 v[188:191], a[28:31], a[4:7], v[188:191]
    v_mfma_f32_16x16x32_bf16 v[188:191], a[60:63], a[36:39], v[188:191]
    buffer_load_dwordx4 v19, s[4:7], s41 offen offset:1024 sc1 lds
    ds_read_b128 a[68:71], v7 offset:33792
    v_mfma_f32_16x16x32_bf16 v[192:195], a[16:19], a[8:11], v[192:195]
    ds_read_b128 a[100:103], v7 offset:50176
    v_mfma_f32_16x16x32_bf16 v[192:195], a[48:51], a[40:43], v[192:195]
    v_mfma_f32_16x16x32_bf16 v[196:199], a[20:23], a[8:11], v[196:199]
    buffer_load_dwordx4 v19, s[4:7], s41 offen offset:2048 sc1 lds
    ds_read_b128 a[72:75], v7 offset:34816
    v_mfma_f32_16x16x32_bf16 v[196:199], a[52:55], a[40:43], v[196:199]
    ds_read_b128 a[104:107], v7 offset:51200
    v_mfma_f32_16x16x32_bf16 v[200:203], a[24:27], a[8:11], v[200:203]
    v_mfma_f32_16x16x32_bf16 v[200:203], a[56:59], a[40:43], v[200:203]
    buffer_load_dwordx4 v19, s[4:7], s41 offen offset:3072 sc1 lds
    s_add_u32 s41, s41, 131072
    ds_read_b128 a[76:79], v7 offset:35840
    v_mfma_f32_16x16x32_bf16 v[204:207], a[28:31], a[8:11], v[204:207]
    ds_read_b128 a[108:111], v7 offset:52224
    v_mfma_f32_16x16x32_bf16 v[204:207], a[60:63], a[40:43], v[204:207]
    v_mfma_f32_16x16x32_bf16 v[208:211], a[16:19], a[12:15], v[208:211]
    v_mfma_f32_16x16x32_bf16 v[208:211], a[48:51], a[44:47], v[208:211]
    v_mfma_f32_16x16x32_bf16 v[212:215], a[20:23], a[12:15], v[212:215]
    v_mfma_f32_16x16x32_bf16 v[212:215], a[52:55], a[44:47], v[212:215]
    v_mfma_f32_16x16x32_bf16 v[216:219], a[24:27], a[12:15], v[216:219]
    v_mfma_f32_16x16x32_bf16 v[216:219], a[56:59], a[44:47], v[216:219]
    v_mfma_f32_16x16x32_bf16 v[220:223], a[28:31], a[12:15], v[220:223]
    s_add_u32 m0, s44, 99328
    v_mfma_f32_16x16x32_bf16 v[220:223], a[60:63], a[44:47], v[220:223]
    s_waitcnt vmcnt(16) lgkmcnt(0)
    s_barrier
    v_mfma_f32_16x16x32_bf16 v[160:163], a[80:83], a[64:67], v[160:163]
    buffer_load_dwordx4 v0, s[4:7], s40 offen offset:0 sc1 lds
    ds_read_b128 a[0:3], v30 offset:0
    v_mfma_f32_16x16x32_bf16 v[160:163], a[112:115], a[96:99], v[160:163]
    ds_read_b128 a[32:35], v30 offset:16384
    v_mfma_f32_16x16x32_bf16 v[164:167], a[84:87], a[64:67], v[164:167]
    v_mfma_f32_16x16x32_bf16 v[164:167], a[116:119], a[96:99], v[164:167]
    buffer_load_dwordx4 v0, s[4:7], s40 offen offset:1024 sc1 lds
    ds_read_b128 a[16:19], v32 offset:0
    v_mfma_f32_16x16x32_bf16 v[168:171], a[88:91], a[64:67], v[168:171]
    ds_read_b128 a[48:51], v32 offset:16384
    v_mfma_f32_16x16x32_bf16 v[168:171], a[120:123], a[96:99], v[168:171]
    v_mfma_f32_16x16x32_bf16 v[172:175], a[92:95], a[64:67], v[172:175]
    buffer_load_dwordx4 v1, s[4:7], s40 offen offset:2048 sc1 lds
    ds_read_b128 a[20:23], v32 offset:1024
    v_mfma_f32_16x16x32_bf16 v[172:175], a[124:127], a[96:99], v[172:175]
    ds_read_b128 a[52:55], v32 offset:17408
    v_mfma_f32_16x16x32_bf16 v[176:179], a[80:83], a[68:71], v[176:179]
    v_mfma_f32_16x16x32_bf16 v[176:179], a[112:115], a[100:103], v[176:179]
    buffer_load_dwordx4 v1, s[4:7], s40 offen offset:3072 sc1 lds
    ds_read_b128 a[24:27], v32 offset:2048
    v_mfma_f32_16x16x32_bf16 v[180:183], a[84:87], a[68:71], v[180:183]
    ds_read_b128 a[56:59], v32 offset:18432
    v_mfma_f32_16x16x32_bf16 v[180:183], a[116:119], a[100:103], v[180:183]
    v_mfma_f32_16x16x32_bf16 v[184:187], a[88:91], a[68:71], v[184:187]
    s_add_u32 m0, s44, 107520
    s_add_u32 s40, s40, 262144
    buffer_load_dwordx4 v19, s[4:7], s41 offen offset:0 sc1 lds
    ds_read_b128 a[28:31], v32 offset:3072
    v_mfma_f32_16x16x32_bf16 v[184:187], a[120:123], a[100:103], v[184:187]
    ds_read_b128 a[60:63], v32 offset:19456
    v_mfma_f32_16x16x32_bf16 v[188:191], a[92:95], a[68:71], v[188:191]
    v_mfma_f32_16x16x32_bf16 v[188:191], a[124:127], a[100:103], v[188:191]
    buffer_load_dwordx4 v19, s[4:7], s41 offen offset:1024 sc1 lds
    ds_read_b128 a[4:7], v30 offset:1024
    v_mfma_f32_16x16x32_bf16 v[192:195], a[80:83], a[72:75], v[192:195]
    ds_read_b128 a[36:39], v30 offset:17408
    v_mfma_f32_16x16x32_bf16 v[192:195], a[112:115], a[104:107], v[192:195]
    v_mfma_f32_16x16x32_bf16 v[196:199], a[84:87], a[72:75], v[196:199]
    buffer_load_dwordx4 v19, s[4:7], s41 offen offset:2048 sc1 lds
    ds_read_b128 a[8:11], v30 offset:2048
    v_mfma_f32_16x16x32_bf16 v[196:199], a[116:119], a[104:107], v[196:199]
    ds_read_b128 a[40:43], v30 offset:18432
    v_mfma_f32_16x16x32_bf16 v[200:203], a[88:91], a[72:75], v[200:203]
    v_mfma_f32_16x16x32_bf16 v[200:203], a[120:123], a[104:107], v[200:203]
    buffer_load_dwordx4 v19, s[4:7], s41 offen offset:3072 sc1 lds
    s_add_u32 s41, s41, 131072
    ds_read_b128 a[12:15], v30 offset:3072
    v_mfma_f32_16x16x32_bf16 v[204:207], a[92:95], a[72:75], v[204:207]
    ds_read_b128 a[44:47], v30 offset:19456
    v_mfma_f32_16x16x32_bf16 v[204:207], a[124:127], a[104:107], v[204:207]
    v_mfma_f32_16x16x32_bf16 v[208:211], a[80:83], a[76:79], v[208:211]
    v_mfma_f32_16x16x32_bf16 v[208:211], a[112:115], a[108:111], v[208:211]
    v_mfma_f32_16x16x32_bf16 v[212:215], a[84:87], a[76:79], v[212:215]
    v_mfma_f32_16x16x32_bf16 v[212:215], a[116:119], a[108:111], v[212:215]
    v_mfma_f32_16x16x32_bf16 v[216:219], a[88:91], a[76:79], v[216:219]
    v_mfma_f32_16x16x32_bf16 v[216:219], a[120:123], a[108:111], v[216:219]
    v_mfma_f32_16x16x32_bf16 v[220:223], a[92:95], a[76:79], v[220:223]
    s_add_u32 m0, s44, 132096
    v_mfma_f32_16x16x32_bf16 v[220:223], a[124:127], a[108:111], v[220:223]
    s_waitcnt vmcnt(16) lgkmcnt(0)
    s_barrier
    v_mfma_f32_16x16x32_bf16 v[160:163], a[16:19], a[0:3], v[160:163]
    buffer_load_dwordx4 v0, s[4:7], s40 offen offset:0 sc1 lds
    ds_read_b128 a[64:67], v4 offset:0
    v_mfma_f32_16x16x32_bf16 v[160:163], a[48:51], a[32:35], v[160:163]
    ds_read_b128 a[96:99], v4 offset:16384
    v_mfma_f32_16x16x32_bf16 v[164:167], a[20:23], a[0:3], v[164:167]
    v_mfma_f32_16x16x32_bf16 v[164:167], a[52:55], a[32:35], v[164:167]
    buffer_load_dwordx4 v0, s[4:7], s40 offen offset:1024 sc1 lds
    ds_read_b128 a[80:83], v6 offset:0
    v_mfma_f32_16x16x32_bf16 v[168:171], a[24:27], a[0:3], v[168:171]
    ds_read_b128 a[112:115], v6 offset:16384
    v_mfma_f32_16x16x32_bf16 v[168:171], a[56:59], a[32:35], v[168:171]
    v_mfma_f32_16x16x32_bf16 v[172:175], a[28:31], a[0:3], v[172:175]
    buffer_load_dwordx4 v1, s[4:7], s40 offen offset:2048 sc1 lds
    ds_read_b128 a[84:87], v6 offset:1024
    v_mfma_f32_16x16x32_bf16 v[172:175], a[60:63], a[32:35], v[172:175]
    ds_read_b128 a[116:119], v6 offset:17408
    v_mfma_f32_16x16x32_bf16 v[176:179], a[16:19], a[4:7], v[176:179]
    v_mfma_f32_16x16x32_bf16 v[176:179], a[48:51], a[36:39], v[176:179]
    buffer_load_dwordx4 v1, s[4:7], s40 offen offset:3072 sc1 lds
    ds_read_b128 a[88:91], v6 offset:2048
    v_mfma_f32_16x16x32_bf16 v[180:183], a[20:23], a[4:7], v[180:183]
    ds_read_b128 a[120:123], v6 offset:18432
    v_mfma_f32_16x16x32_bf16 v[180:183], a[52:55], a[36:39], v[180:183]
    v_mfma_f32_16x16x32_bf16 v[184:187], a[24:27], a[4:7], v[184:187]
    s_add_u32 m0, s44, 140288
    s_add_u32 s40, s40, 262144
    buffer_load_dwordx4 v19, s[4:7], s41 offen offset:0 sc1 lds
    ds_read_b128 a[92:95], v6 offset:3072
    v_mfma_f32_16x16x32_bf16 v[184:187], a[56:59], a[36:39], v[184:187]
    ds_read_b128 a[124:127], v6 offset:19456
    v_mfma_f32_16x16x32_bf16 v[188:191], a[28:31], a[4:7], v[188:191]
    v_mfma_f32_16x16x32_bf16 v[188:191], a[60:63], a[36:39], v[188:191]
    buffer_load_dwordx4 v19, s[4:7], s41 offen offset:1024 sc1 lds
    ds_read_b128 a[68:71], v4 offset:1024
    v_mfma_f32_16x16x32_bf16 v[192:195], a[16:19], a[8:11], v[192:195]
    ds_read_b128 a[100:103], v4 offset:17408
    v_mfma_f32_16x16x32_bf16 v[192:195], a[48:51], a[40:43], v[192:195]
    v_mfma_f32_16x16x32_bf16 v[196:199], a[20:23], a[8:11], v[196:199]
    buffer_load_dwordx4 v19, s[4:7], s41 offen offset:2048 sc1 lds
    ds_read_b128 a[72:75], v4 offset:2048
    v_mfma_f32_16x16x32_bf16 v[196:199], a[52:55], a[40:43], v[196:199]
    ds_read_b128 a[104:107], v4 offset:18432
    v_mfma_f32_16x16x32_bf16 v[200:203], a[24:27], a[8:11], v[200:203]
    v_mfma_f32_16x16x32_bf16 v[200:203], a[56:59], a[40:43], v[200:203]
    buffer_load_dwordx4 v19, s[4:7], s41 offen offset:3072 sc1 lds
    s_add_u32 s41, s41, 131072
    ds_read_b128 a[76:79], v4 offset:3072
    v_mfma_f32_16x16x32_bf16 v[204:207], a[28:31], a[8:11], v[204:207]
    ds_read_b128 a[108:111], v4 offset:19456
    v_mfma_f32_16x16x32_bf16 v[204:207], a[60:63], a[40:43], v[204:207]
    v_mfma_f32_16x16x32_bf16 v[208:211], a[16:19], a[12:15], v[208:211]
    v_mfma_f32_16x16x32_bf16 v[208:211], a[48:51], a[44:47], v[208:211]
    v_mfma_f32_16x16x32_bf16 v[212:215], a[20:23], a[12:15], v[212:215]
    v_mfma_f32_16x16x32_bf16 v[212:215], a[52:55], a[44:47], v[212:215]
    v_mfma_f32_16x16x32_bf16 v[216:219], a[24:27], a[12:15], v[216:219]
    v_mfma_f32_16x16x32_bf16 v[216:219], a[56:59], a[44:47], v[216:219]
    v_mfma_f32_16x16x32_bf16 v[220:223], a[28:31], a[12:15], v[220:223]
    s_add_u32 m0, s44, 1024
    v_mfma_f32_16x16x32_bf16 v[220:223], a[60:63], a[44:47], v[220:223]
    s_waitcnt vmcnt(16) lgkmcnt(0)
    s_barrier
    v_mfma_f32_16x16x32_bf16 v[160:163], a[80:83], a[64:67], v[160:163]
    buffer_load_dwordx4 v0, s[4:7], s40 offen offset:0 sc1 lds
    ds_read_b128 a[0:3], v7 offset:0
    v_mfma_f32_16x16x32_bf16 v[160:163], a[112:115], a[96:99], v[160:163]
    ds_read_b128 a[32:35], v7 offset:16384
    v_mfma_f32_16x16x32_bf16 v[164:167], a[84:87], a[64:67], v[164:167]
    v_mfma_f32_16x16x32_bf16 v[164:167], a[116:119], a[96:99], v[164:167]
    buffer_load_dwordx4 v0, s[4:7], s40 offen offset:1024 sc1 lds
    ds_read_b128 a[16:19], v9 offset:0
    v_mfma_f32_16x16x32_bf16 v[168:171], a[88:91], a[64:67], v[168:171]
    ds_read_b128 a[48:51], v9 offset:16384
    v_mfma_f32_16x16x32_bf16 v[168:171], a[120:123], a[96:99], v[168:171]
    v_mfma_f32_16x16x32_bf16 v[172:175], a[92:95], a[64:67], v[172:175]
    buffer_load_dwordx4 v1, s[4:7], s40 offen offset:2048 sc1 lds
    ds_read_b128 a[20:23], v9 offset:1024
    v_mfma_f32_16x16x32_bf16 v[172:175], a[124:127], a[96:99], v[172:175]
    ds_read_b128 a[52:55], v9 offset:17408
    v_mfma_f32_16x16x32_bf16 v[176:179], a[80:83], a[68:71], v[176:179]
    v_mfma_f32_16x16x32_bf16 v[176:179], a[112:115], a[100:103], v[176:179]
    buffer_load_dwordx4 v1, s[4:7], s40 offen offset:3072 sc1 lds
    ds_read_b128 a[24:27], v9 offset:2048
    v_mfma_f32_16x16x32_bf16 v[180:183], a[84:87], a[68:71], v[180:183]
    ds_read_b128 a[56:59], v9 offset:18432
    v_mfma_f32_16x16x32_bf16 v[180:183], a[116:119], a[100:103], v[180:183]
    v_mfma_f32_16x16x32_bf16 v[184:187], a[88:91], a[68:71], v[184:187]
    s_add_u32 m0, s44, 9216
    s_add_u32 s40, s40, 262144
    buffer_load_dwordx4 v19, s[4:7], s41 offen offset:0 sc1 lds
    ds_read_b128 a[28:31], v9 offset:3072
    v_mfma_f32_16x16x32_bf16 v[184:187], a[120:123], a[100:103], v[184:187]
    ds_read_b128 a[60:63], v9 offset:19456
    v_mfma_f32_16x16x32_bf16 v[188:191], a[92:95], a[68:71], v[188:191]
    v_mfma_f32_16x16x32_bf16 v[188:191], a[124:127], a[100:103], v[188:191]
    buffer_load_dwordx4 v19, s[4:7], s41 offen offset:1024 sc1 lds
    ds_read_b128 a[4:7], v7 offset:1024
    v_mfma_f32_16x16x32_bf16 v[192:195], a[80:83], a[72:75], v[192:195]
    ds_read_b128 a[36:39], v7 offset:17408
    v_mfma_f32_16x16x32_bf16 v[192:195], a[112:115], a[104:107], v[192:195]
    v_mfma_f32_16x16x32_bf16 v[196:199], a[84:87], a[72:75], v[196:199]
    buffer_load_dwordx4 v19, s[4:7], s41 offen offset:2048 sc1 lds
    ds_read_b128 a[8:11], v7 offset:2048
    v_mfma_f32_16x16x32_bf16 v[196:199], a[116:119], a[104:107], v[196:199]
    ds_read_b128 a[40:43], v7 offset:18432
    v_mfma_f32_16x16x32_bf16 v[200:203], a[88:91], a[72:75], v[200:203]
    v_mfma_f32_16x16x32_bf16 v[200:203], a[120:123], a[104:107], v[200:203]
    buffer_load_dwordx4 v19, s[4:7], s41 offen offset:3072 sc1 lds
    s_add_u32 s41, s41, 131072
    ds_read_b128 a[12:15], v7 offset:3072
    v_mfma_f32_16x16x32_bf16 v[204:207], a[92:95], a[72:75], v[204:207]
    ds_read_b128 a[44:47], v7 offset:19456
    v_mfma_f32_16x16x32_bf16 v[204:207], a[124:127], a[104:107], v[204:207]
    v_mfma_f32_16x16x32_bf16 v[208:211], a[80:83], a[76:79], v[208:211]
    v_mfma_f32_16x16x32_bf16 v[208:211], a[112:115], a[108:111], v[208:211]
    v_mfma_f32_16x16x32_bf16 v[212:215], a[84:87], a[76:79], v[212:215]
    v_mfma_f32_16x16x32_bf16 v[212:215], a[116:119], a[108:111], v[212:215]
    v_mfma_f32_16x16x32_bf16 v[216:219], a[88:91], a[76:79], v[216:219]
    v_mfma_f32_16x16x32_bf16 v[216:219], a[120:123], a[108:111], v[216:219]
    v_mfma_f32_16x16x32_bf16 v[220:223], a[92:95], a[76:79], v[220:223]
    s_add_u32 m0, s44, 66560
    v_mfma_f32_16x16x32_bf16 v[220:223], a[124:127], a[108:111], v[220:223]
    s_add_u32 s55, s55, 1
    s_cmp_lt_u32 s55, 3
    s_cbranch_scc1 Lf_loop2
    s_waitcnt vmcnt(16) lgkmcnt(0)
    s_barrier
    s_nop 0
    v_mfma_f32_16x16x32_bf16 v[160:163], a[16:19], a[0:3], v[160:163]
    buffer_load_dwordx4 v0, s[4:7], s40 offen offset:0 sc1 lds
    ds_read_b128 a[64:67], v7 offset:32768
    v_mfma_f32_16x16x32_bf16 v[160:163], a[48:51], a[32:35], v[160:163]
    ds_read_b128 a[96:99], v7 offset:49152
    v_mfma_f32_16x16x32_bf16 v[164:167], a[20:23], a[0:3], v[164:167]
    v_mfma_f32_16x16x32_bf16 v[164:167], a[52:55], a[32:35], v[164:167]
    buffer_load_dwordx4 v0, s[4:7], s40 offen offset:1024 sc1 lds
    ds_read_b128 a[80:83], v9 offset:32768
    v_mfma_f32_16x16x32_bf16 v[168:171], a[24:27], a[0:3], v[168:171]
    ds_read_b128 a[112:115], v9 offset:49152
    v_mfma_f32_16x16x32_bf16 v[168:171], a[56:59], a[32:35], v[168:171]
    v_mfma_f32_16x16x32_bf16 v[172:175], a[28:31], a[0:3], v[172:175]
    buffer_load_dwordx4 v1, s[4:7], s40 offen offset:2048 sc1 lds
    ds_read_b128 a[84:87], v9 offset:33792
    v_mfma_f32_16x16x32_bf16 v[172:175], a[60:63], a[32:35], v[172:175]
    ds_read_b128 a[116:119], v9 offset:50176
    v_mfma_f32_16x16x32_bf16 v[176:179], a[16:19], a[4:7], v[176:179]
    v_mfma_f32_16x16x32_bf16 v[176:179], a[48:51], a[36:39], v[176:179]
    buffer_load_dwordx4 v1, s[4:7], s40 offen offset:3072 sc1 lds
    ds_read_b128 a[88:91], v9 offset:34816
    v_mfma_f32_16x16x32_bf16 v[180:183], a[20:23], a[4:7], v[180:183]
    ds_read_b128 a[120:123], v9 offset:51200
    v_mfma_f32_16x16x32_bf16 v[180:183], a[52:55], a[36:39], v[180:183]
    v_mfma_f32_16x16x32_bf16 v[184:187], a[24:27], a[4:7], v[184:187]
    s_add_u32 m0, s44, 74752
    s_add_u32 s40, s40, 262144
    buffer_load_dwordx4 v19, s[4:7], s41 offen offset:0 sc1 lds
    ds_read_b128 a[92:95], v9 offset:35840
    v_mfma_f32_16x16x32_bf16 v[184:187], a[56:59], a[36:39], v[184:187]
    ds_read_b128 a[124:127], v9 offset:52224
    v_mfma_f32_16x16x32_bf16 v[188:191], a[28:31], a[4:7], v[188:191]
    v_mfma_f32_16x16x32_bf16 v[188:191], a[60:63], a[36:39], v[188:191]
    buffer_load_dwordx4 v19, s[4:7], s41 offen offset:1024 sc1 lds
    ds_read_b128 a[68:71], v7 offset:33792
    v_mfma_f32_16x16x32_bf16 v[192:195], a[16:19], a[8:11], v[192:195]
    ds_read_b128 a[100:103], v7 offset:50176
    v_mfma_f32_16x16x32_bf16 v[192:195], a[48:51], a[40:43], v[192:195]
    v_mfma_f32_16x16x32_bf16 v[196:199], a[20:23], a[8:11], v[196:199]
    buffer_load_dwordx4 v19, s[4:7], s41 offen offset:2048 sc1 lds
    ds_read_b128 a[72:75], v7 offset:34816
    v_mfma_f32_16x16x32_bf16 v[196:199], a[52:55], a[40:43], v[196:199]
    ds_read_b128 a[104:107], v7 offset:51200
    v_mfma_f32_16x16x32_bf16 v[200:203], a[24:27], a[8:11], v[200:203]
    v_mfma_f32_16x16x32_bf16 v[200:203], a[56:59], a[40:43], v[200:203]
    buffer_load_dwordx4 v19, s[4:7], s41 offen offset:3072 sc1 lds
    s_add_u32 s41, s41, 131072
    ds_read_b128 a[76:79], v7 offset:35840
    v_mfma_f32_16x16x32_bf16 v[204:207], a[28:31], a[8:11], v[204:207]
    ds_read_b128 a[108:111], v7 offset:52224
    v_mfma_f32_16x16x32_bf16 v[204:207], a[60:63], a[40:43], v[204:207]
    v_mfma_f32_16x16x32_bf16 v[208:211], a[16:19], a[12:15], v[208:211]
    v_mfma_f32_16x16x32_bf16 v[208:211], a[48:51], a[44:47], v[208:211]
    v_mfma_f32_16x16x32_bf16 v[212:215], a[20:23], a[12:15], v[212:215]
    v_mfma_f32_16x16x32_bf16 v[212:215], a[52:55], a[44:47], v[212:215]
    v_mfma_f32_16x16x32_bf16 v[216:219], a[24:27], a[12:15], v[216:219]
    v_mfma_f32_16x16x32_bf16 v[216:219], a[56:59], a[44:47], v[216:219]
    v_mfma_f32_16x16x32_bf16 v[220:223], a[28:31], a[12:15], v[220:223]
    s_add_u32 m0, s44, 99328
    buffer_load_dwordx2 v[20:21], v11, s[4:7], s45 offen sc1
    v_mfma_f32_16x16x32_bf16 v[220:223], a[60:63], a[44:47], v[220:223]
    s_waitcnt vmcnt(17) lgkmcnt(0)
    s_barrier
    v_mfma_f32_16x16x32_bf16 v[160:163], a[80:83], a[64:67], v[160:163]
    buffer_load_dwordx4 v0, s[4:7], s40 offen offset:0 sc1 lds
    ds_read_b128 a[0:3], v30 offset:0
    v_mfma_f32_16x16x32_bf16 v[160:163], a[112:115], a[96:99], v[160:163]
    ds_read_b128 a[32:35], v30 offset:16384
    v_mfma_f32_16x16x32_bf16 v[164:167], a[84:87], a[64:67], v[164:167]
    v_mfma_f32_16x16x32_bf16 v[164:167], a[116:119], a[96:99], v[164:167]
    buffer_load_dwordx4 v0, s[4:7], s40 offen offset:1024 sc1 lds
    ds_read_b128 a[16:19], v32 offset:0
    v_mfma_f32_16x16x32_bf16 v[168:171], a[88:91], a[64:67], v[168:171]
    ds_read_b128 a[48:51], v32 offset:16384
    v_mfma_f32_16x16x32_bf16 v[168:171], a[120:123], a[96:99], v[168:171]
    v_mfma_f32_16x16x32_bf16 v[172:175], a[92:95], a[64:67], v[172:175]
    buffer_load_dwordx4 v1, s[4:7], s40 offen offset:2048 sc1 lds
    ds_read_b128 a[20:23], v32 offset:1024
    v_mfma_f32_16x16x32_bf16 v[172:175], a[124:127], a[96:99], v[172:175]
    ds_read_b128 a[52:55], v32 offset:17408
    v_mfma_f32_16x16x32_bf16 v[176:179], a[80:83], a[68:71], v[176:179]
    v_mfma_f32_16x16x32_bf16 v[176:179], a[112:115], a[100:103], v[176:179]
    buffer_load_dwordx4 v1, s[4:7], s40 offen offset:3072 sc1 lds
    ds_read_b128 a[24:27], v32 offset:2048
    v_mfma_f32_16x16x32_bf16 v[180:183], a[84:87], a[68:71], v[180:183]
    ds_read_b128 a[56:59], v32 offset:18432
    v_mfma_f32_16x16x32_bf16 v[180:183], a[116:119], a[100:103], v[180:183]
    v_mfma_f32_16x16x32_bf16 v[184:187], a[88:91], a[68:71], v[184:187]
    s_add_u32 m0, s44, 107520
    s_add_u32 s40, s40, 262144
    buffer_load_dwordx4 v19, s[4:7], s41 offen offset:0 sc1 lds
    ds_read_b128 a[28:31], v32 offset:3072
    v_mfma_f32_16x16x32_bf16 v[184:187], a[120:123], a[100:103], v[184:187]
    ds_read_b128 a[60:63], v32 offset:19456
    v_mfma_f32_16x16x32_bf16 v[188:191], a[92:95], a[68:71], v[188:191]
    v_mfma_f32_16x16x32_bf16 v[188:191], a[124:127], a[100:103], v[188:191]
    buffer_load_dwordx4 v19, s[4:7], s41 offen offset:1024 sc1 lds
    ds_read_b128 a[4:7], v30 offset:1024
    v_mfma_f32_16x16x32_bf16 v[192:195], a[80:83], a[72:75], v[192:195]
    ds_read_b128 a[36:39], v30 offset:17408
    v_mfma_f32_16x16x32_bf16 v[192:195], a[112:115], a[104:107], v[192:195]
    v_mfma_f32_16x16x32_bf16 v[196:199], a[84:87], a[72:75], v[196:199]
    buffer_load_dwordx4 v19, s[4:7], s41 offen offset:2048 sc1 lds
    ds_read_b128 a[8:11], v30 offset:2048
    v_mfma_f32_16x16x32_bf16 v[196:199], a[116:119], a[104:107], v[196:199]
    ds_read_b128 a[40:43], v30 offset:18432
    v_mfma_f32_16x16x32_bf16 v[200:203], a[88:91], a[72:75], v[200:203]
    v_mfma_f32_16x16x32_bf16 v[200:203], a[120:123], a[104:107], v[200:203]
    buffer_load_dwordx4 v19, s[4:7], s41 offen offset:3072 sc1 lds
    s_add_u32 s41, s41, 131072
    ds_read_b128 a[12:15], v30 offset:3072
    v_mfma_f32_16x16x32_bf16 v[204:207], a[92:95], a[72:75], v[204:207]
    ds_read_b128 a[44:47], v30 offset:19456
    v_mfma_f32_16x16x32_bf16 v[204:207], a[124:127], a[104:107], v[204:207]
    v_mfma_f32_16x16x32_bf16 v[208:211], a[80:83], a[76:79], v[208:211]
    v_mfma_f32_16x16x32_bf16 v[208:211], a[112:115], a[108:111], v[208:211]
    v_mfma_f32_16x16x32_bf16 v[212:215], a[84:87], a[76:79], v[212:215]
    v_mfma_f32_16x16x32_bf16 v[212:215], a[116:119], a[108:111], v[212:215]
    v_mfma_f32_16x16x32_bf16 v[216:219], a[88:91], a[76:79], v[216:219]
    v_mfma_f32_16x16x32_bf16 v[216:219], a[120:123], a[108:111], v[216:219]
    v_mfma_f32_16x16x32_bf16 v[220:223], a[92:95], a[76:79], v[220:223]
    s_add_u32 m0, s44, 132096
    v_mfma_f32_16x16x32_bf16 v[220:223], a[124:127], a[108:111], v[220:223]
    s_waitcnt vmcnt(17) lgkmcnt(0)
    s_barrier
    v_mfma_f32_16x16x32_bf16 v[160:163], a[16:19], a[0:3], v[160:163]
    buffer_load_dwordx4 v0, s[4:7], s40 offen offset:0 sc1 lds
    ds_read_b128 a[64:67], v4 offset:0
    v_mfma_f32_16x16x32_bf16 v[160:163], a[48:51], a[32:35], v[160:163]
    ds_read_b128 a[96:99], v4 offset:16384
    v_mfma_f32_16x16x32_bf16 v[164:167], a[20:23], a[0:3], v[164:167]
    v_mfma_f32_16x16x32_bf16 v[164:167], a[52:55], a[32:35], v[164:167]
    buffer_load_dwordx4 v0, s[4:7], s40 offen offset:1024 sc1 lds
    ds_read_b128 a[80:83], v6 offset:0
    v_mfma_f32_16x16x32_bf16 v[168:171], a[24:27], a[0:3], v[168:171]
    ds_read_b128 a[112:115], v6 offset:16384
    v_mfma_f32_16x16x32_bf16 v[168:171], a[56:59], a[32:35], v[168:171]
    v_mfma_f32_16x16x32_bf16 v[172:175], a[28:31], a[0:3], v[172:175]
    buffer_load_dwordx4 v1, s[4:7], s40 offen offset:2048 sc1 lds
    ds_read_b128 a[84:87], v6 offset:1024
    v_mfma_f32_16x16x32_bf16 v[172:175], a[60:63], a[32:35], v[172:175]
    ds_read_b128 a[116:119], v6 offset:17408
    v_mfma_f32_16x16x32_bf16 v[176:179], a[16:19], a[4:7], v[176:179]
    v_mfma_f32_16x16x32_bf16 v[176:179], a[48:51], a[36:39], v[176:179]
    buffer_load_dwordx4 v1, s[4:7], s40 offen offset:3072 sc1 lds
    ds_read_b128 a[88:91], v6 offset:2048
    v_mfma_f32_16x16x32_bf16 v[180:183], a[20:23], a[4:7], v[180:183]
    ds_read_b128 a[120:123], v6 offset:18432
    v_mfma_f32_16x16x32_bf16 v[180:183], a[52:55], a[36:39], v[180:183]
    v_mfma_f32_16x16x32_bf16 v[184:187], a[24:27], a[4:7], v[184:187]
    s_add_u32 m0, s44, 140288
    s_add_u32 s40, s40, 262144
    buffer_load_dwordx4 v19, s[4:7], s41 offen offset:0 sc1 lds
    ds_read_b128 a[92:95], v6 offset:3072
    v_mfma_f32_16x16x32_bf16 v[184:187], a[56:59], a[36:39], v[184:187]
    ds_read_b128 a[124:127], v6 offset:19456
    v_mfma_f32_16x16x32_bf16 v[188:191], a[28:31], a[4:7], v[188:191]
    v_mfma_f32_16x16x32_bf16 v[188:191], a[60:63], a[36:39], v[188:191]
    buffer_load_dwordx4 v19, s[4:7], s41 offen offset:1024 sc1 lds
    ds_read_b128 a[68:71], v4 offset:1024
    v_mfma_f32_16x16x32_bf16 v[192:195], a[16:19], a[8:11], v[192:195]
    ds_read_b128 a[100:103], v4 offset:17408
    v_mfma_f32_16x16x32_bf16 v[192:195], a[48:51], a[40:43], v[192:195]
    v_mfma_f32_16x16x32_bf16 v[196:199], a[20:23], a[8:11], v[196:199]
    buffer_load_dwordx4 v19, s[4:7], s41 offen offset:2048 sc1 lds
    ds_read_b128 a[72:75], v4 offset:2048
    v_mfma_f32_16x16x32_bf16 v[196:199], a[52:55], a[40:43], v[196:199]
    ds_read_b128 a[104:107], v4 offset:18432
    v_mfma_f32_16x16x32_bf16 v[200:203], a[24:27], a[8:11], v[200:203]
    v_mfma_f32_16x16x32_bf16 v[200:203], a[56:59], a[40:43], v[200:203]
    buffer_load_dwordx4 v19, s[4:7], s41 offen offset:3072 sc1 lds
    s_add_u32 s41, s41, 131072
    ds_read_b128 a[76:79], v4 offset:3072
    v_mfma_f32_16x16x32_bf16 v[204:207], a[28:31], a[8:11], v[204:207]
    ds_read_b128 a[108:111], v4 offset:19456
    v_mfma_f32_16x16x32_bf16 v[204:207], a[60:63], a[40:43], v[204:207]
    v_mfma_f32_16x16x32_bf16 v[208:211], a[16:19], a[12:15], v[208:211]
    v_mfma_f32_16x16x32_bf16 v[208:211], a[48:51], a[44:47], v[208:211]
    v_mfma_f32_16x16x32_bf16 v[212:215], a[20:23], a[12:15], v[212:215]
    v_mfma_f32_16x16x32_bf16 v[212:215], a[52:55], a[44:47], v[212:215]
    v_mfma_f32_16x16x32_bf16 v[216:219], a[24:27], a[12:15], v[216:219]
    v_mfma_f32_16x16x32_bf16 v[216:219], a[56:59], a[44:47], v[216:219]
    v_mfma_f32_16x16x32_bf16 v[220:223], a[28:31], a[12:15], v[220:223]
    s_add_u32 m0, s44, 1024
    v_mfma_f32_16x16x32_bf16 v[220:223], a[60:63], a[44:47], v[220:223]
    s_waitcnt vmcnt(17) lgkmcnt(0)
    s_barrier
    v_mfma_f32_16x16x32_bf16 v[160:163], a[80:83], a[64:67], v[160:163]
    buffer_load_dwordx4 v0, s[4:7], s40 offen offset:0 sc1 lds
    ds_read_b128 a[0:3], v7 offset:0
    v_mfma_f32_16x16x32_bf16 v[160:163], a[112:115], a[96:99], v[160:163]
    ds_read_b128 a[32:35], v7 offset:16384
    v_mfma_f32_16x16x32_bf16 v[164:167], a[84:87], a[64:67], v[164:167]
    v_mfma_f32_16x16x32_bf16 v[164:167], a[116:119], a[96:99], v[164:167]
    buffer_load_dwordx4 v0, s[4:7], s40 offen offset:1024 sc1 lds
    ds_read_b128 a[16:19], v9 offset:0
    v_mfma_f32_16x16x32_bf16 v[168:171], a[88:91], a[64:67], v[168:171]
    ds_read_b128 a[48:51], v9 offset:16384
    v_mfma_f32_16x16x32_bf16 v[168:171], a[120:123], a[96:99], v[168:171]
    v_mfma_f32_16x16x32_bf16 v[172:175], a[92:95], a[64:67], v[172:175]
    buffer_load_dwordx4 v1, s[4:7], s40 offen offset:2048 sc1 lds
    ds_read_b128 a[20:23], v9 offset:1024
    v_mfma_f32_16x16x32_bf16 v[172:175], a[124:127], a[96:99], v[172:175]
    ds_read_b128 a[52:55], v9 offset:17408
    v_mfma_f32_16x16x32_bf16 v[176:179], a[80:83], a[68:71], v[176:179]
    v_mfma_f32_16x16x32_bf16 v[176:179], a[112:115], a[100:103], v[176:179]
    buffer_load_dwordx4 v1, s[4:7], s40 offen offset:3072 sc1 lds
    ds_read_b128 a[24:27], v9 offset:2048
    v_mfma_f32_16x16x32_bf16 v[180:183], a[84:87], a[68:71], v[180:183]
    ds_read_b128 a[56:59], v9 offset:18432
    v_mfma_f32_16x16x32_bf16 v[180:183], a[116:119], a[100:103], v[180:183]
    v_mfma_f32_16x16x32_bf16 v[184:187], a[88:91], a[68:71], v[184:187]
    s_add_u32 m0, s44, 9216
    s_add_u32 s40, s40, 262144
    buffer_load_dwordx4 v19, s[4:7], s41 offen offset:0 sc1 lds
    ds_read_b128 a[28:31], v9 offset:3072
    v_mfma_f32_16x16x32_bf16 v[184:187], a[120:123], a[100:103], v[184:187]
    ds_read_b128 a[60:63], v9 offset:19456
    v_mfma_f32_16x16x32_bf16 v[188:191], a[92:95], a[68:71], v[188:191]
    v_mfma_f32_16x16x32_bf16 v[188:191], a[124:127], a[100:103], v[188:191]
    buffer_load_dwordx4 v19, s[4:7], s41 offen offset:1024 sc1 lds
    ds_read_b128 a[4:7], v7 offset:1024
    v_mfma_f32_16x16x32_bf16 v[192:195], a[80:83], a[72:75], v[192:195]
    ds_read_b128 a[36:39], v7 offset:17408
    v_mfma_f32_16x16x32_bf16 v[192:195], a[112:115], a[104:107], v[192:195]
    v_mfma_f32_16x16x32_bf16 v[196:199], a[84:87], a[72:75], v[196:199]
    buffer_load_dwordx4 v19, s[4:7], s41 offen offset:2048 sc1 lds
    ds_read_b128 a[8:11], v7 offset:2048
    v_mfma_f32_16x16x32_bf16 v[196:199], a[116:119], a[104:107], v[196:199]
    ds_read_b128 a[40:43], v7 offset:18432
    v_mfma_f32_16x16x32_bf16 v[200:203], a[88:91], a[72:75], v[200:203]
    v_mfma_f32_16x16x32_bf16 v[200:203], a[120:123], a[104:107], v[200:203]
    buffer_load_dwordx4 v19, s[4:7], s41 offen offset:3072 sc1 lds
    s_add_u32 s41, s41, 131072
    ds_read_b128 a[12:15], v7 offset:3072
    v_mfma_f32_16x16x32_bf16 v[204:207], a[92:95], a[72:75], v[204:207]
    ds_read_b128 a[44:47], v7 offset:19456
    v_mfma_f32_16x16x32_bf16 v[204:207], a[124:127], a[104:107], v[204:207]
    v_mfma_f32_16x16x32_bf16 v[208:211], a[80:83], a[76:79], v[208:211]
    v_mfma_f32_16x16x32_bf16 v[208:211], a[112:115], a[108:111], v[208:211]
    v_mfma_f32_16x16x32_bf16 v[212:215], a[84:87], a[76:79], v[212:215]
    v_mfma_f32_16x16x32_bf16 v[212:215], a[116:119], a[108:111], v[212:215]
    v_mfma_f32_16x16x32_bf16 v[216:219], a[88:91], a[76:79], v[216:219]
    v_mfma_f32_16x16x32_bf16 v[216:219], a[120:123], a[108:111], v[216:219]
    v_mfma_f32_16x16x32_bf16 v[220:223], a[92:95], a[76:79], v[220:223]
    s_add_u32 m0, s44, 66560
    v_mfma_f32_16x16x32_bf16 v[220:223], a[124:127], a[108:111], v[220:223]
    s_waitcnt vmcnt(16) lgkmcnt(0)
    v_and_b32 v20, v20, v21
    v_cmp_eq_u32 vcc, 1, v20
    s_nop 1
    s_cmp_eq_u64 vcc, exec
    s_cbranch_scc0 Lf_sl6
Lf_ok6:
    s_mov_b32 s40, s42
    s_mov_b32 s41, s43
    s_barrier
    s_nop 0
    v_mfma_f32_16x16x32_bf16 v[160:163], a[16:19], a[0:3], v[160:163]
    buffer_load_dwordx4 v0, s[4:7], s40 offen offset:0 sc1 lds
    ds_read_b128 a[64:67], v7 offset:32768
    v_mfma_f32_16x16x32_bf16 v[160:163], a[48:51], a[32:35], v[160:163]
    ds_read_b128 a[96:99], v7 offset:49152
    v_mfma_f32_16x16x32_bf16 v[164:167], a[20:23], a[0:3], v[164:167]
    v_mfma_f32_16x16x32_bf16 v[164:167], a[52:55], a[32:35], v[164:167]
    buffer_load_dwordx4 v0, s[4:7], s40 offen offset:1024 sc1 lds
    ds_read_b128 a[80:83], v9 offset:32768
    v_mfma_f32_16x16x32_bf16 v[168:171], a[24:27], a[0:3], v[168:171]
    ds_read_b128 a[112:115], v9 offset:49152
    v_mfma_f32_16x16x32_bf16 v[168:171], a[56:59], a[32:35], v[168:171]
    v_mfma_f32_16x16x32_bf16 v[172:175], a[28:31], a[0:3], v[172:175]
    buffer_load_dwordx4 v1, s[4:7], s40 offen offset:2048 sc1 lds
    ds_read_b128 a[84:87], v9 offset:33792
    v_mfma_f32_16x16x32_bf16 v[172:175], a[60:63], a[32:35], v[172:175]
    ds_read_b128 a[116:119], v9 offset:50176
    v_mfma_f32_16x16x32_bf16 v[176:179], a[16:19], a[4:7], v[176:179]
    v_mfma_f32_16x16x32_bf16 v[176:179], a[48:51], a[36:39], v[176:179]
    buffer_load_dwordx4 v1, s[4:7], s40 offen offset:3072 sc1 lds
    ds_read_b128 a[88:91], v9 offset:34816
    v_mfma_f32_16x16x32_bf16 v[180:183], a[20:23], a[4:7], v[180:183]
    ds_read_b128 a[120:123], v9 offset:51200
    v_mfma_f32_16x16x32_bf16 v[180:183], a[52:55], a[36:39], v[180:183]
    v_mfma_f32_16x16x32_bf16 v[184:187], a[24:27], a[4:7], v[184:187]
    s_add_u32 m0, s44, 74752
    s_add_u32 s40, s40, 262144
    buffer_load_dwordx4 v19, s[4:7], s41 offen offset:0 sc1 lds
    ds_read_b128 a[92:95], v9 offset:35840
    v_mfma_f32_16x16x32_bf16 v[184:187], a[56:59], a[36:39], v[184:187]
    ds_read_b128 a[124:127], v9 offset:52224
    v_mfma_f32_16x16x32_bf16 v[188:191], a[28:31], a[4:7], v[188:191]
    v_mfma_f32_16x16x32_bf16 v[188:191], a[60:63], a[36:39], v[188:191]
    buffer_load_dwordx4 v19, s[4:7], s41 offen offset:1024 sc1 lds
    ds_read_b128 a[68:71], v7 offset:33792
    v_mfma_f32_16x16x32_bf16 v[192:195], a[16:19], a[8:11], v[192:195]
    ds_read_b128 a[100:103], v7 offset:50176
    v_mfma_f32_16x16x32_bf16 v[192:195], a[48:51], a[40:43], v[192:195]
    v_mfma_f32_16x16x32_bf16 v[196:199], a[20:23], a[8:11], v[196:199]
    buffer_load_dwordx4 v19, s[4:7], s41 offen offset:2048 sc1 lds
    ds_read_b128 a[72:75], v7 offset:34816
    v_mfma_f32_16x16x32_bf16 v[196:199], a[52:55], a[40:43], v[196:199]
    ds_read_b128 a[104:107], v7 offset:51200
    v_mfma_f32_16x16x32_bf16 v[200:203], a[24:27], a[8:11], v[200:203]
    v_mfma_f32_16x16x32_bf16 v[200:203], a[56:59], a[40:43], v[200:203]
    buffer_load_dwordx4 v19, s[4:7], s41 offen offset:3072 sc1 lds
    s_add_u32 s41, s41, 131072
    ds_read_b128 a[76:79], v7 offset:35840
    v_mfma_f32_16x16x32_bf16 v[204:207], a[28:31], a[8:11], v[204:207]
    ds_read_b128 a[108:111], v7 offset:52224
    v_mfma_f32_16x16x32_bf16 v[204:207], a[60:63], a[40:43], v[204:207]
    v_mfma_f32_16x16x32_bf16 v[208:211], a[16:19], a[12:15], v[208:211]
    v_mfma_f32_16x16x32_bf16 v[208:211], a[48:51], a[44:47], v[208:211]
    v_mfma_f32_16x16x32_bf16 v[212:215], a[20:23], a[12:15], v[212:215]
    v_mfma_f32_16x16x32_bf16 v[212:215], a[52:55], a[44:47], v[212:215]
    v_mfma_f32_16x16x32_bf16 v[216:219], a[24:27], a[12:15], v[216:219]
    v_mfma_f32_16x16x32_bf16 v[216:219], a[56:59], a[44:47], v[216:219]
    v_mfma_f32_16x16x32_bf16 v[220:223], a[28:31], a[12:15], v[220:223]
    s_add_u32 m0, s44, 99328
    v_mfma_f32_16x16x32_bf16 v[220:223], a[60:63], a[44:47], v[220:223]
    s_waitcnt vmcnt(16) lgkmcnt(0)
    s_barrier
    v_mfma_f32_16x16x32_bf16 v[160:163], a[80:83], a[64:67], v[160:163]
    buffer_load_dwordx4 v0, s[4:7], s40 offen offset:0 sc1 lds
    ds_read_b128 a[0:3], v30 offset:0
    v_mfma_f32_16x16x32_bf16 v[160:163], a[112:115], a[96:99], v[160:163]
    ds_read_b128 a[32:35], v30 offset:16384
    v_mfma_f32_16x16x32_bf16 v[164:167], a[84:87], a[64:67], v[164:167]
    v_mfma_f32_16x16x32_bf16 v[164:167], a[116:119], a[96:99], v[164:167]
    buffer_load_dwordx4 v0, s[4:7], s40 offen offset:1024 sc1 lds
    ds_read_b128 a[16:19], v32 offset:0
    v_mfma_f32_16x16x32_bf16 v[168:171], a[88:91], a[64:67], v[168:171]
    ds_read_b128 a[48:51], v32 offset:16384
    v_mfma_f32_16x16x32_bf16 v[168:171], a[120:123], a[96:99], v[168:171]
    v_mfma_f32_16x16x32_bf16 v[172:175], a[92:95], a[64:67], v[172:175]
    buffer_load_dwordx4 v1, s[4:7], s40 offen offset:2048 sc1 lds
    ds_read_b128 a[20:23], v32 offset:1024
    v_mfma_f32_16x16x32_bf16 v[172:175], a[124:127], a[96:99], v[172:175]
    ds_read_b128 a[52:55], v32 offset:17408
    v_mfma_f32_16x16x32_bf16 v[176:179], a[80:83], a[68:71], v[176:179]
    v_mfma_f32_16x16x32_bf16 v[176:179], a[112:115], a[100:103], v[176:179]
    buffer_load_dwordx4 v1, s[4:7], s40 offen offset:3072 sc1 lds
    ds_read_b128 a[24:27], v32 offset:2048
    v_mfma_f32_16x16x32_bf16 v[180:183], a[84:87], a[68:71], v[180:183]
    ds_read_b128 a[56:59], v32 offset:18432
    v_mfma_f32_16x16x32_bf16 v[180:183], a[116:119], a[100:103], v[180:183]
    v_mfma_f32_16x16x32_bf16 v[184:187], a[88:91], a[68:71], v[184:187]
    s_add_u32 m0, s44, 107520
    s_add_u32 s40, s40, 262144
    buffer_load_dwordx4 v19, s[4:7], s41 offen offset:0 sc1 lds
    ds_read_b128 a[28:31], v32 offset:3072
    v_mfma_f32_16x16x32_bf16 v[184:187], a[120:123], a[100:103], v[184:187]
    ds_read_b128 a[60:63], v32 offset:19456
    v_mfma_f32_16x16x32_bf16 v[188:191], a[92:95], a[68:71], v[188:191]
    v_mfma_f32_16x16x32_bf16 v[188:191], a[124:127], a[100:103], v[188:191]
    buffer_load_dwordx4 v19, s[4:7], s41 offen offset:1024 sc1 lds
    ds_read_b128 a[4:7], v30 offset:1024
    v_mfma_f32_16x16x32_bf16 v[192:195], a[80:83], a[72:75], v[192:195]
    ds_read_b128 a[36:39], v30 offset:17408
    v_mfma_f32_16x16x32_bf16 v[192:195], a[112:115], a[104:107], v[192:195]
    v_mfma_f32_16x16x32_bf16 v[196:199], a[84:87], a[72:75], v[196:199]
    buffer_load_dwordx4 v19, s[4:7], s41 offen offset:2048 sc1 lds
    ds_read_b128 a[8:11], v30 offset:2048
    v_mfma_f32_16x16x32_bf16 v[196:199], a[116:119], a[104:107], v[196:199]
    ds_read_b128 a[40:43], v30 offset:18432
    v_mfma_f32_16x16x32_bf16 v[200:203], a[88:91], a[72:75], v[200:203]
    v_mfma_f32_16x16x32_bf16 v[200:203], a[120:123], a[104:107], v[200:203]
    buffer_load_dwordx4 v19, s[4:7], s41 offen offset:3072 sc1 lds
    s_add_u32 s41, s41, 131072
    ds_read_b128 a[12:15], v30 offset:3072
    v_mfma_f32_16x16x32_bf16 v[204:207], a[92:95], a[72:75], v[204:207]
    ds_read_b128 a[44:47], v30 offset:19456
    v_mfma_f32_16x16x32_bf16 v[204:207], a[124:127], a[104:107], v[204:207]
    v_mfma_f32_16x16x32_bf16 v[208:211], a[80:83], a[76:79], v[208:211]
    v_mfma_f32_16x16x32_bf16 v[208:211], a[112:115], a[108:111], v[208:211]
    v_mfma_f32_16x16x32_bf16 v[212:215], a[84:87], a[76:79], v[212:215]
    v_mfma_f32_16x16x32_bf16 v[212:215], a[116:119], a[108:111], v[212:215]
    v_mfma_f32_16x16x32_bf16 v[216:219], a[88:91], a[76:79], v[216:219]
    v_mfma_f32_16x16x32_bf16 v[216:219], a[120:123], a[108:111], v[216:219]
    v_mfma_f32_16x16x32_bf16 v[220:223], a[92:95], a[76:79], v[220:223]
    s_add_u32 m0, s44, 132096
    v_mfma_f32_16x16x32_bf16 v[220:223], a[124:127], a[108:111], v[220:223]
    s_waitcnt vmcnt(16) lgkmcnt(0)
    s_barrier
    v_mfma_f32_16x16x32_bf16 v[160:163], a[16:19], a[0:3], v[160:163]
    buffer_load_dwordx4 v0, s[4:7], s40 offen offset:0 sc1 lds
    ds_read_b128 a[64:67], v4 offset:0
    v_mfma_f32_16x16x32_bf16 v[160:163], a[48:51], a[32:35], v[160:163]
    ds_read_b128 a[96:99], v4 offset:16384
    v_mfma_f32_16x16x32_bf16 v[164:167], a[20:23], a[0:3], v[164:167]
    v_mfma_f32_16x16x32_bf16 v[164:167], a[52:55], a[32:35], v[164:167]
    buffer_load_dwordx4 v0, s[4:7], s40 offen offset:1024 sc1 lds
    ds_read_b128 a[80:83], v6 offset:0
    v_mfma_f32_16x16x32_bf16 v[168:171], a[24:27], a[0:3], v[168:171]
    ds_read_b128 a[112:115], v6 offset:16384
    v_mfma_f32_16x16x32_bf16 v[168:171], a[56:59], a[32:35], v[168:171]
    v_mfma_f32_16x16x32_bf16 v[172:175], a[28:31], a[0:3], v[172:175]
    buffer_load_dwordx4 v1, s[4:7], s40 offen offset:2048 sc1 lds
    ds_read_b128 a[84:87], v6 offset:1024
    v_mfma_f32_16x16x32_bf16 v[172:175], a[60:63], a[32:35], v[172:175]
    ds_read_b128 a[116:119], v6 offset:17408
    v_mfma_f32_16x16x32_bf16 v[176:179], a[16:19], a[4:7], v[176:179]
    v_mfma_f32_16x16x32_bf16 v[176:179], a[48:51], a[36:39], v[176:179]
    buffer_load_dwordx4 v1, s[4:7], s40 offen offset:3072 sc1 lds
    ds_read_b128 a[88:91], v6 offset:2048
    v_mfma_f32_16x16x32_bf16 v[180:183], a[20:23], a[4:7], v[180:183]
    ds_read_b128 a[120:123], v6 offset:18432
    v_mfma_f32_16x16x32_bf16 v[180:183], a[52:55], a[36:39], v[180:183]
    v_mfma_f32_16x16x32_bf16 v[184:187], a[24:27], a[4:7], v[184:187]
    s_add_u32 m0, s44, 140288
    s_add_u32 s40, s40, 262144
    buffer_load_dwordx4 v19, s[4:7], s41 offen offset:0 sc1 lds
    ds_read_b128 a[92:95], v6 offset:3072
    v_mfma_f32_16x16x32_bf16 v[184:187], a[56:59], a[36:39], v[184:187]
    ds_read_b128 a[124:127], v6 offset:19456
    v_mfma_f32_16x16x32_bf16 v[188:191], a[28:31], a[4:7], v[188:191]
    v_mfma_f32_16x16x32_bf16 v[188:191], a[60:63], a[36:39], v[188:191]
    buffer_load_dwordx4 v19, s[4:7], s41 offen offset:1024 sc1 lds
    ds_read_b128 a[68:71], v4 offset:1024
    v_mfma_f32_16x16x32_bf16 v[192:195], a[16:19], a[8:11], v[192:195]
    ds_read_b128 a[100:103], v4 offset:17408
    v_mfma_f32_16x16x32_bf16 v[192:195], a[48:51], a[40:43], v[192:195]
    v_mfma_f32_16x16x32_bf16 v[196:199], a[20:23], a[8:11], v[196:199]
    buffer_load_dwordx4 v19, s[4:7], s41 offen offset:2048 sc1 lds
    ds_read_b128 a[72:75], v4 offset:2048
    v_mfma_f32_16x16x32_bf16 v[196:199], a[52:55], a[40:43], v[196:199]
    ds_read_b128 a[104:107], v4 offset:18432
    v_mfma_f32_16x16x32_bf16 v[200:203], a[24:27], a[8:11], v[200:203]
    v_mfma_f32_16x16x32_bf16 v[200:203], a[56:59], a[40:43], v[200:203]
    buffer_load_dwordx4 v19, s[4:7], s41 offen offset:3072 sc1 lds
    s_add_u32 s41, s41, 131072
    ds_read_b128 a[76:79], v4 offset:3072
    v_mfma_f32_16x16x32_bf16 v[204:207], a[28:31], a[8:11], v[204:207]
    ds_read_b128 a[108:111], v4 offset:19456
    v_mfma_f32_16x16x32_bf16 v[204:207], a[60:63], a[40:43], v[204:207]
    v_mfma_f32_16x16x32_bf16 v[208:211], a[16:19], a[12:15], v[208:211]
    v_mfma_f32_16x16x32_bf16 v[208:211], a[48:51], a[44:47], v[208:211]
    v_mfma_f32_16x16x32_bf16 v[212:215], a[20:23], a[12:15], v[212:215]
    v_mfma_f32_16x16x32_bf16 v[212:215], a[52:55], a[44:47], v[212:215]
    v_mfma_f32_16x16x32_bf16 v[216:219], a[24:27], a[12:15], v[216:219]
    v_mfma_f32_16x16x32_bf16 v[216:219], a[56:59], a[44:47], v[216:219]
    v_mfma_f32_16x16x32_bf16 v[220:223], a[28:31], a[12:15], v[220:223]
    s_add_u32 m0, s44, 1024
    v_mfma_f32_16x16x32_bf16 v[220:223], a[60:63], a[44:47], v[220:223]
    s_waitcnt vmcnt(16) lgkmcnt(0)
    s_barrier
    v_mfma_f32_16x16x32_bf16 v[160:163], a[80:83], a[64:67], v[160:163]
    buffer_load_dwordx4 v0, s[4:7], s40 offen offset:0 sc1 lds
    ds_read_b128 a[0:3], v7 offset:0
    v_mfma_f32_16x16x32_bf16 v[160:163], a[112:115], a[96:99], v[160:163]
    ds_read_b128 a[32:35], v7 offset:16384
    v_mfma_f32_16x16x32_bf16 v[164:167], a[84:87], a[64:67], v[164:167]
    v_mfma_f32_16x16x32_bf16 v[164:167], a[116:119], a[96:99], v[164:167]
    buffer_load_dwordx4 v0, s[4:7], s40 offen offset:1024 sc1 lds
    ds_read_b128 a[16:19], v9 offset:0
    v_mfma_f32_16x16x32_bf16 v[168:171], a[88:91], a[64:67], v[168:171]
    ds_read_b128 a[48:51], v9 offset:16384
    v_mfma_f32_16x16x32_bf16 v[168:171], a[120:123], a[96:99], v[168:171]
    v_mfma_f32_16x16x32_bf16 v[172:175], a[92:95], a[64:67], v[172:175]
    buffer_load_dwordx4 v1, s[4:7], s40 offen offset:2048 sc1 lds
    ds_read_b128 a[20:23], v9 offset:1024
    v_mfma_f32_16x16x32_bf16 v[172:175], a[124:127], a[96:99], v[172:175]
    ds_read_b128 a[52:55], v9 offset:17408
    v_mfma_f32_16x16x32_bf16 v[176:179], a[80:83], a[68:71], v[176:179]
    v_mfma_f32_16x16x32_bf16 v[176:179], a[112:115], a[100:103], v[176:179]
    buffer_load_dwordx4 v1, s[4:7], s40 offen offset:3072 sc1 lds
    ds_read_b128 a[24:27], v9 offset:2048
    v_mfma_f32_16x16x32_bf16 v[180:183], a[84:87], a[68:71], v[180:183]
    ds_read_b128 a[56:59], v9 offset:18432
    v_mfma_f32_16x16x32_bf16 v[180:183], a[116:119], a[100:103], v[180:183]
    v_mfma_f32_16x16x32_bf16 v[184:187], a[88:91], a[68:71], v[184:187]
    s_add_u32 m0, s44, 9216
    s_add_u32 s40, s40, 262144
    buffer_load_dwordx4 v19, s[4:7], s41 offen offset:0 sc1 lds
    ds_read_b128 a[28:31], v9 offset:3072
    v_mfma_f32_16x16x32_bf16 v[184:187], a[120:123], a[100:103], v[184:187]
    ds_read_b128 a[60:63], v9 offset:19456
    v_mfma_f32_16x16x32_bf16 v[188:191], a[92:95], a[68:71], v[188:191]
    v_mfma_f32_16x16x32_bf16 v[188:191], a[124:127], a[100:103], v[188:191]
    buffer_load_dwordx4 v19, s[4:7], s41 offen offset:1024 sc1 lds
    ds_read_b128 a[4:7], v7 offset:1024
    v_mfma_f32_16x16x32_bf16 v[192:195], a[80:83], a[72:75], v[192:195]
    ds_read_b128 a[36:39], v7 offset:17408
    v_mfma_f32_16x16x32_bf16 v[192:195], a[112:115], a[104:107], v[192:195]
    v_mfma_f32_16x16x32_bf16 v[196:199], a[84:87], a[72:75], v[196:199]
    buffer_load_dwordx4 v19, s[4:7], s41 offen offset:2048 sc1 lds
    ds_read_b128 a[8:11], v7 offset:2048
    v_mfma_f32_16x16x32_bf16 v[196:199], a[116:119], a[104:107], v[196:199]
    ds_read_b128 a[40:43], v7 offset:18432
    v_mfma_f32_16x16x32_bf16 v[200:203], a[88:91], a[72:75], v[200:203]
    v_mfma_f32_16x16x32_bf16 v[200:203], a[120:123], a[104:107], v[200:203]
    buffer_load_dwordx4 v19, s[4:7], s41 offen offset:3072 sc1 lds
    s_add_u32 s41, s41, 131072
    ds_read_b128 a[12:15], v7 offset:3072
    v_mfma_f32_16x16x32_bf16 v[204:207], a[92:95], a[72:75], v[204:207]
    ds_read_b128 a[44:47], v7 offset:19456
    v_mfma_f32_16x16x32_bf16 v[204:207], a[124:127], a[104:107], v[204:207]
    v_mfma_f32_16x16x32_bf16 v[208:211], a[80:83], a[76:79], v[208:211]
    v_mfma_f32_16x16x32_bf16 v[208:211], a[112:115], a[108:111], v[208:211]
    v_mfma_f32_16x16x32_bf16 v[212:215], a[84:87], a[76:79], v[212:215]
    v_mfma_f32_16x16x32_bf16 v[212:215], a[116:119], a[108:111], v[212:215]
    v_mfma_f32_16x16x32_bf16 v[216:219], a[88:91], a[76:79], v[216:219]
    v_mfma_f32_16x16x32_bf16 v[216:219], a[120:123], a[108:111], v[216:219]
    v_mfma_f32_16x16x32_bf16 v[220:223], a[92:95], a[76:79], v[220:223]
    s_add_u32 m0, s44, 66560
    v_mfma_f32_16x16x32_bf16 v[220:223], a[124:127], a[108:111], v[220:223]
    s_waitcnt vmcnt(16) lgkmcnt(0)
    s_nop 4
    v_sub_f32 v12, 1.0, v12
    v_sub_f32 v13, 1.0, v13
    v_sub_f32 v14, 1.0, v14
    v_sub_f32 v15, 1.0, v15
    v_pk_mul_f32 v[160:161], v[160:161], v[12:13] op_sel:[0,0] op_sel_hi:[1,0]
    v_pk_mul_f32 v[162:163], v[162:163], v[12:13] op_sel:[0,0] op_sel_hi:[1,0]
    v_pk_mul_f32 v[164:165], v[164:165], v[12:13] op_sel:[0,0] op_sel_hi:[1,0]
    v_pk_mul_f32 v[166:167], v[166:167], v[12:13] op_sel:[0,0] op_sel_hi:[1,0]
    v_pk_mul_f32 v[168:169], v[168:169], v[12:13] op_sel:[0,0] op_sel_hi:[1,0]
    v_pk_mul_f32 v[170:171], v[170:171], v[12:13] op_sel:[0,0] op_sel_hi:[1,0]
    v_pk_mul_f32 v[172:173], v[172:173], v[12:13] op_sel:[0,0] op_sel_hi:[1,0]
    v_pk_mul_f32 v[174:175], v[174:175], v[12:13] op_sel:[0,0] op_sel_hi:[1,0]
    v_pk_mul_f32 v[176:177], v[176:177], v[12:13] op_sel:[0,1] op_sel_hi:[1,1]
    v_pk_mul_f32 v[178:179], v[178:179], v[12:13] op_sel:[0,1] op_sel_hi:[1,1]
    v_pk_mul_f32 v[180:181], v[180:181], v[12:13] op_sel:[0,1] op_sel_hi:[1,1]
    v_pk_mul_f32 v[182:183], v[182:183], v[12:13] op_sel:[0,1] op_sel_hi:[1,1]
    v_pk_mul_f32 v[184:185], v[184:185], v[12:13] op_sel:[0,1] op_sel_hi:[1,1]
    v_pk_mul_f32 v[186:187], v[186:187], v[12:13] op_sel:[0,1] op_sel_hi:[1,1]
    v_pk_mul_f32 v[188:189], v[188:189], v[12:13] op_sel:[0,1] op_sel_hi:[1,1]
    v_pk_mul_f32 v[190:191], v[190:191], v[12:13] op_sel:[0,1] op_sel_hi:[1,1]
    v_pk_mul_f32 v[192:193], v[192:193], v[14:15] op_sel:[0,0] op_sel_hi:[1,0]
    v_pk_mul_f32 v[194:195], v[194:195], v[14:15] op_sel:[0,0] op_sel_hi:[1,0]
    v_pk_mul_f32 v[196:197], v[196:197], v[14:15] op_sel:[0,0] op_sel_hi:[1,0]
    v_pk_mul_f32 v[198:199], v[198:199], v[14:15] op_sel:[0,0] op_sel_hi:[1,0]
    v_pk_mul_f32 v[200:201], v[200:201], v[14:15] op_sel:[0,0] op_sel_hi:[1,0]
    v_pk_mul_f32 v[202:203], v[202:203], v[14:15] op_sel:[0,0] op_sel_hi:[1,0]
    v_pk_mul_f32 v[204:205], v[204:205], v[14:15] op_sel:[0,0] op_sel_hi:[1,0]
    v_pk_mul_f32 v[206:207], v[206:207], v[14:15] op_sel:[0,0] op_sel_hi:[1,0]
    v_pk_mul_f32 v[208:209], v[208:209], v[14:15] op_sel:[0,1] op_sel_hi:[1,1]
    v_pk_mul_f32 v[210:211], v[210:211], v[14:15] op_sel:[0,1] op_sel_hi:[1,1]
    v_pk_mul_f32 v[212:213], v[212:213], v[14:15] op_sel:[0,1] op_sel_hi:[1,1]
    v_pk_mul_f32 v[214:215], v[214:215], v[14:15] op_sel:[0,1] op_sel_hi:[1,1]
    v_pk_mul_f32 v[216:217], v[216:217], v[14:15] op_sel:[0,1] op_sel_hi:[1,1]
    v_pk_mul_f32 v[218:219], v[218:219], v[14:15] op_sel:[0,1] op_sel_hi:[1,1]
    v_pk_mul_f32 v[220:221], v[220:221], v[14:15] op_sel:[0,1] op_sel_hi:[1,1]
    v_pk_mul_f32 v[222:223], v[222:223], v[14:15] op_sel:[0,1] op_sel_hi:[1,1]
    s_nop 0
    s_barrier
    v_mfma_f32_16x16x32_bf16 v[160:163], a[16:19], a[0:3], v[160:163]
    buffer_load_dwordx4 v0, s[4:7], s40 offen offset:0 sc1 lds
    ds_read_b128 a[64:67], v7 offset:32768
    v_mfma_f32_16x16x32_bf16 v[160:163], a[48:51], a[32:35], v[160:163]
    ds_read_b128 a[96:99], v7 offset:49152
    v_mfma_f32_16x16x32_bf16 v[164:167], a[20:23], a[0:3], v[164:167]
    v_mfma_f32_16x16x32_bf16 v[164:167], a[52:55], a[32:35], v[164:167]
    buffer_load_dwordx4 v0, s[4:7], s40 offen offset:1024 sc1 lds
    ds_read_b128 a[80:83], v9 offset:32768
    v_mfma_f32_16x16x32_bf16 v[168:171], a[24:27], a[0:3], v[168:171]
    ds_read_b128 a[112:115], v9 offset:49152
    v_mfma_f32_16x16x32_bf16 v[168:171], a[56:59], a[32:35], v[168:171]
    v_mfma_f32_16x16x32_bf16 v[172:175], a[28:31], a[0:3], v[172:175]
    buffer_load_dwordx4 v1, s[4:7], s40 offen offset:2048 sc1 lds
    ds_read_b128 a[84:87], v9 offset:33792
    v_mfma_f32_16x16x32_bf16 v[172:175], a[60:63], a[32:35], v[172:175]
    ds_read_b128 a[116:119], v9 offset:50176
    v_mfma_f32_16x16x32_bf16 v[176:179], a[16:19], a[4:7], v[176:179]
    v_mfma_f32_16x16x32_bf16 v[176:179], a[48:51], a[36:39], v[176:179]
    buffer_load_dwordx4 v1, s[4:7], s40 offen offset:3072 sc1 lds
    ds_read_b128 a[88:91], v9 offset:34816
    v_mfma_f32_16x16x32_bf16 v[180:183], a[20:23], a[4:7], v[180:183]
    ds_read_b128 a[120:123], v9 offset:51200
    v_mfma_f32_16x16x32_bf16 v[180:183], a[52:55], a[36:39], v[180:183]
    v_mfma_f32_16x16x32_bf16 v[184:187], a[24:27], a[4:7], v[184:187]
    s_add_u32 m0, s44, 74752
    s_add_u32 s40, s40, 262144
    buffer_load_dwordx4 v19, s[4:7], s41 offen offset:0 sc1 lds
    ds_read_b128 a[92:95], v9 offset:35840
    v_mfma_f32_16x16x32_bf16 v[184:187], a[56:59], a[36:39], v[184:187]
    ds_read_b128 a[124:127], v9 offset:52224
    v_mfma_f32_16x16x32_bf16 v[188:191], a[28:31], a[4:7], v[188:191]
    v_mfma_f32_16x16x32_bf16 v[188:191], a[60:63], a[36:39], v[188:191]
    buffer_load_dwordx4 v19, s[4:7], s41 offen offset:1024 sc1 lds
    ds_read_b128 a[68:71], v7 offset:33792
    v_mfma_f32_16x16x32_bf16 v[192:195], a[16:19], a[8:11], v[192:195]
    ds_read_b128 a[100:103], v7 offset:50176
    v_mfma_f32_16x16x32_bf16 v[192:195], a[48:51], a[40:43], v[192:195]
    v_mfma_f32_16x16x32_bf16 v[196:199], a[20:23], a[8:11], v[196:199]
    buffer_load_dwordx4 v19, s[4:7], s41 offen offset:2048 sc1 lds
    ds_read_b128 a[72:75], v7 offset:34816
    v_mfma_f32_16x16x32_bf16 v[196:199], a[52:55], a[40:43], v[196:199]
    ds_read_b128 a[104:107], v7 offset:51200
    v_mfma_f32_16x16x32_bf16 v[200:203], a[24:27], a[8:11], v[200:203]
    v_mfma_f32_16x16x32_bf16 v[200:203], a[56:59], a[40:43], v[200:203]
    buffer_load_dwordx4 v19, s[4:7], s41 offen offset:3072 sc1 lds
    s_add_u32 s41, s41, 131072
    ds_read_b128 a[76:79], v7 offset:35840
    v_mfma_f32_16x16x32_bf16 v[204:207], a[28:31], a[8:11], v[204:207]
    ds_read_b128 a[108:111], v7 offset:52224
    v_mfma_f32_16x16x32_bf16 v[204:207], a[60:63], a[40:43], v[204:207]
    v_mfma_f32_16x16x32_bf16 v[208:211], a[16:19], a[12:15], v[208:211]
    v_mfma_f32_16x16x32_bf16 v[208:211], a[48:51], a[44:47], v[208:211]
    s_mov_b32 s30, 4194304
    v_mfma_f32_16x16x32_bf16 v[212:215], a[20:23], a[12:15], v[212:215]
    s_mov_b32 s31, 0x20000
    v_mfma_f32_16x16x32_bf16 v[212:215], a[52:55], a[44:47], v[212:215]
    s_mul_i32 s63, s56, 4608
    v_mfma_f32_16x16x32_bf16 v[216:219], a[24:27], a[12:15], v[216:219]
    s_add_u32 s63, s63, 32768
    v_mfma_f32_16x16x32_bf16 v[216:219], a[56:59], a[44:47], v[216:219]
    v_and_b32_e64 v5, 15, v2
    v_mfma_f32_16x16x32_bf16 v[220:223], a[28:31], a[12:15], v[220:223]
    s_add_u32 m0, s44, 99328
    v_mul_u32_u24 v5, 144, v5
    v_mfma_f32_16x16x32_bf16 v[220:223], a[60:63], a[44:47], v[220:223]
    v_lshrrev_b32 v8, 4, v2
    s_waitcnt vmcnt(16) lgkmcnt(0)
    s_barrier
    s_nop 0
    v_mfma_f32_16x16x32_bf16 v[160:163], a[80:83], a[64:67], v[160:163]
    buffer_load_dwordx4 v0, s[4:7], s40 offen offset:0 sc1 lds
    ds_read_b128 a[0:3], v30 offset:0
    v_mfma_f32_16x16x32_bf16 v[160:163], a[112:115], a[96:99], v[160:163]
    ds_read_b128 a[32:35], v30 offset:16384
    v_mfma_f32_16x16x32_bf16 v[164:167], a[84:87], a[64:67], v[164:167]
    v_mfma_f32_16x16x32_bf16 v[164:167], a[116:119], a[96:99], v[164:167]
    buffer_load_dwordx4 v0, s[4:7], s40 offen offset:1024 sc1 lds
    ds_read_b128 a[16:19], v32 offset:0
    v_mfma_f32_16x16x32_bf16 v[168:171], a[88:91], a[64:67], v[168:171]
    ds_read_b128 a[48:51], v32 offset:16384
    v_mfma_f32_16x16x32_bf16 v[168:171], a[120:123], a[96:99], v[168:171]
    v_mfma_f32_16x16x32_bf16 v[172:175], a[92:95], a[64:67], v[172:175]
    buffer_load_dwordx4 v1, s[4:7], s40 offen offset:2048 sc1 lds
    ds_read_b128 a[20:23], v32 offset:1024
    v_mfma_f32_16x16x32_bf16 v[172:175], a[124:127], a[96:99], v[172:175]
    ds_read_b128 a[52:55], v32 offset:17408
    v_mfma_f32_16x16x32_bf16 v[176:179], a[80:83], a[68:71], v[176:179]
    v_mfma_f32_16x16x32_bf16 v[176:179], a[112:115], a[100:103], v[176:179]
    buffer_load_dwordx4 v1, s[4:7], s40 offen offset:3072 sc1 lds
    ds_read_b128 a[24:27], v32 offset:2048
    v_mfma_f32_16x16x32_bf16 v[180:183], a[84:87], a[68:71], v[180:183]
    ds_read_b128 a[56:59], v32 offset:18432
    v_mfma_f32_16x16x32_bf16 v[180:183], a[116:119], a[100:103], v[180:183]
    v_mfma_f32_16x16x32_bf16 v[184:187], a[88:91], a[68:71], v[184:187]
    s_add_u32 m0, s44, 107520
    s_add_u32 s40, s40, 262144
    buffer_load_dwordx4 v19, s[4:7], s41 offen offset:0 sc1 lds
    ds_read_b128 a[28:31], v32 offset:3072
    v_mfma_f32_16x16x32_bf16 v[184:187], a[120:123], a[100:103], v[184:187]
    ds_read_b128 a[60:63], v32 offset:19456
    v_mfma_f32_16x16x32_bf16 v[188:191], a[92:95], a[68:71], v[188:191]
    v_mfma_f32_16x16x32_bf16 v[188:191], a[124:127], a[100:103], v[188:191]
    buffer_load_dwordx4 v19, s[4:7], s41 offen offset:1024 sc1 lds
    ds_read_b128 a[4:7], v30 offset:1024
    v_mfma_f32_16x16x32_bf16 v[192:195], a[80:83], a[72:75], v[192:195]
    ds_read_b128 a[36:39], v30 offset:17408
    v_mfma_f32_16x16x32_bf16 v[192:195], a[112:115], a[104:107], v[192:195]
    v_mfma_f32_16x16x32_bf16 v[196:199], a[84:87], a[72:75], v[196:199]
    buffer_load_dwordx4 v19, s[4:7], s41 offen offset:2048 sc1 lds
    ds_read_b128 a[8:11], v30 offset:2048
    v_mfma_f32_16x16x32_bf16 v[196:199], a[116:119], a[104:107], v[196:199]
    ds_read_b128 a[40:43], v30 offset:18432
    v_mfma_f32_16x16x32_bf16 v[200:203], a[88:91], a[72:75], v[200:203]
    v_mfma_f32_16x16x32_bf16 v[200:203], a[120:123], a[104:107], v[200:203]
    buffer_load_dwordx4 v19, s[4:7], s41 offen offset:3072 sc1 lds
    s_add_u32 s41, s41, 131072
    ds_read_b128 a[12:15], v30 offset:3072
    v_mfma_f32_16x16x32_bf16 v[204:207], a[92:95], a[72:75], v[204:207]
    ds_read_b128 a[44:47], v30 offset:19456
    v_mfma_f32_16x16x32_bf16 v[204:207], a[124:127], a[104:107], v[204:207]
    v_mfma_f32_16x16x32_bf16 v[208:211], a[80:83], a[76:79], v[208:211]
    v_mfma_f32_16x16x32_bf16 v[208:211], a[112:115], a[108:111], v[208:211]
    v_lshl_add_u32 v5, v8, 3, v5
    v_mfma_f32_16x16x32_bf16 v[212:215], a[84:87], a[76:79], v[212:215]
    v_add_u32 v5, s63, v5
    v_mfma_f32_16x16x32_bf16 v[212:215], a[116:119], a[108:111], v[212:215]
    v_lshrrev_b32 v8, 3, v2
    v_mfma_f32_16x16x32_bf16 v[216:219], a[88:91], a[76:79], v[216:219]
    v_mul_u32_u24 v10, 144, v8
    v_mfma_f32_16x16x32_bf16 v[216:219], a[120:123], a[108:111], v[216:219]
    v_and_b32_e64 v11, 7, v2
    v_mfma_f32_16x16x32_bf16 v[220:223], a[92:95], a[76:79], v[220:223]
    s_add_u32 m0, s44, 132096
    v_lshl_add_u32 v10, v11, 4, v10
    v_mfma_f32_16x16x32_bf16 v[220:223], a[124:127], a[108:111], v[220:223]
    v_add_u32 v10, s63, v10
    s_waitcnt vmcnt(16) lgkmcnt(0)
    s_barrier
    v_mfma_f32_16x16x32_bf16 v[160:163], a[16:19], a[0:3], v[160:163]
    s_mul_i32 s72, s8, 2621440
    s_sub_u32 s40, s40, s72
    s_lshr_b32 s72, s72, 1
    s_sub_u32 s41, s41, s72
    buffer_load_dwordx4 v0, s[4:7], s40 offen offset:0 sc1 lds
    ds_read_b128 a[64:67], v4 offset:0
    v_mfma_f32_16x16x32_bf16 v[160:163], a[48:51], a[32:35], v[160:163]
    ds_read_b128 a[96:99], v4 offset:16384
    v_mfma_f32_16x16x32_bf16 v[164:167], a[20:23], a[0:3], v[164:167]
    v_mfma_f32_16x16x32_bf16 v[164:167], a[52:55], a[32:35], v[164:167]
    ds_read_b128 a[80:83], v6 offset:0
    v_mfma_f32_16x16x32_bf16 v[168:171], a[24:27], a[0:3], v[168:171]
    buffer_load_dwordx4 v0, s[4:7], s40 offen offset:1024 sc1 lds
    ds_read_b128 a[112:115], v6 offset:16384
    v_mfma_f32_16x16x32_bf16 v[168:171], a[56:59], a[32:35], v[168:171]
    v_mfma_f32_16x16x32_bf16 v[172:175], a[28:31], a[0:3], v[172:175]
    ds_read_b128 a[84:87], v6 offset:1024
    v_mfma_f32_16x16x32_bf16 v[172:175], a[60:63], a[32:35], v[172:175]
    ds_read_b128 a[116:119], v6 offset:17408
    v_mfma_f32_16x16x32_bf16 v[176:179], a[16:19], a[4:7], v[176:179]
    s_add_u32 m0, s44, 140288
    s_add_u32 s40, s40, 262144
    buffer_load_dwordx4 v19, s[4:7], s41 offen offset:0 sc1 lds
    v_mfma_f32_16x16x32_bf16 v[176:179], a[48:51], a[36:39], v[176:179]
    ds_read_b128 a[88:91], v6 offset:2048
    v_mfma_f32_16x16x32_bf16 v[180:183], a[20:23], a[4:7], v[180:183]
    ds_read_b128 a[120:123], v6 offset:18432
    v_mfma_f32_16x16x32_bf16 v[180:183], a[52:55], a[36:39], v[180:183]
    v_mfma_f32_16x16x32_bf16 v[184:187], a[24:27], a[4:7], v[184:187]
    buffer_load_dwordx4 v19, s[4:7], s41 offen offset:1024 sc1 lds
    ds_read_b128 a[92:95], v6 offset:3072
    v_mfma_f32_16x16x32_bf16 v[184:187], a[56:59], a[36:39], v[184:187]
    ds_read_b128 a[124:127], v6 offset:19456
    v_mfma_f32_16x16x32_bf16 v[188:191], a[28:31], a[4:7], v[188:191]
    v_mfma_f32_16x16x32_bf16 v[188:191], a[60:63], a[36:39], v[188:191]
    ds_read_b128 a[68:71], v4 offset:1024
    v_mfma_f32_16x16x32_bf16 v[192:195], a[16:19], a[8:11], v[192:195]
    buffer_load_dwordx4 v19, s[4:7], s41 offen offset:2048 sc1 lds
    ds_read_b128 a[100:103], v4 offset:17408
    v_mfma_f32_16x16x32_bf16 v[192:195], a[48:51], a[40:43], v[192:195]
    v_mfma_f32_16x16x32_bf16 v[196:199], a[20:23], a[8:11], v[196:199]
    ds_read_b128 a[72:75], v4 offset:2048
    v_mfma_f32_16x16x32_bf16 v[196:199], a[52:55], a[40:43], v[196:199]
    ds_read_b128 a[104:107], v4 offset:18432
    v_mfma_f32_16x16x32_bf16 v[200:203], a[24:27], a[8:11], v[200:203]
    buffer_load_dwordx4 v19, s[4:7], s41 offen offset:3072 sc1 lds
    s_add_u32 s41, s41, 131072
    v_mfma_f32_16x16x32_bf16 v[200:203], a[56:59], a[40:43], v[200:203]
    ds_read_b128 a[76:79], v4 offset:3072
    v_mfma_f32_16x16x32_bf16 v[204:207], a[28:31], a[8:11], v[204:207]
    ds_read_b128 a[108:111], v4 offset:19456
    v_mfma_f32_16x16x32_bf16 v[204:207], a[60:63], a[40:43], v[204:207]
    v_mfma_f32_16x16x32_bf16 v[208:211], a[16:19], a[12:15], v[208:211]
    v_mfma_f32_16x16x32_bf16 v[208:211], a[48:51], a[44:47], v[208:211]
    v_lshlrev_b32_e64 v8, 11, v8
    v_mfma_f32_16x16x32_bf16 v[212:215], a[20:23], a[12:15], v[212:215]
    v_lshl_add_u32 v8, v11, 4, v8
    v_mfma_f32_16x16x32_bf16 v[212:215], a[52:55], a[44:47], v[212:215]
    s_lshl_b32 s42, s9, 18
    v_mfma_f32_16x16x32_bf16 v[216:219], a[24:27], a[12:15], v[216:219]
    s_lshl_b32 s43, s70, 17
    v_mfma_f32_16x16x32_bf16 v[216:219], a[56:59], a[44:47], v[216:219]
    s_add_u32 s42, s42, s43
    v_mfma_f32_16x16x32_bf16 v[220:223], a[28:31], a[12:15], v[220:223]
    s_add_u32 m0, s44, 1024
    s_lshl_b32 s43, s8, 16
    v_mfma_f32_16x16x32_bf16 v[220:223], a[60:63], a[44:47], v[220:223]
    s_add_u32 s42, s42, s43
    s_waitcnt vmcnt(14) lgkmcnt(0)
    s_barrier
    s_nop 0
    v_mfma_f32_16x16x32_bf16 v[160:163], a[80:83], a[64:67], v[160:163]
    buffer_load_dwordx4 v0, s[4:7], s40 offen offset:0 sc1 lds
    ds_read_b128 a[0:3], v7 offset:0
    v_mfma_f32_16x16x32_bf16 v[160:163], a[112:115], a[96:99], v[160:163]
    ds_read_b128 a[32:35], v7 offset:16384
    v_mfma_f32_16x16x32_bf16 v[164:167], a[84:87], a[64:67], v[164:167]
    v_mfma_f32_16x16x32_bf16 v[164:167], a[116:119], a[96:99], v[164:167]
    ds_read_b128 a[16:19], v9 offset:0
    v_mfma_f32_16x16x32_bf16 v[168:171], a[88:91], a[64:67], v[168:171]
    buffer_load_dwordx4 v0, s[4:7], s40 offen offset:1024 sc1 lds
    ds_read_b128 a[48:51], v9 offset:16384
    v_mfma_f32_16x16x32_bf16 v[168:171], a[120:123], a[96:99], v[168:171]
    v_mfma_f32_16x16x32_bf16 v[172:175], a[92:95], a[64:67], v[172:175]
    ds_read_b128 a[20:23], v9 offset:1024
    v_mfma_f32_16x16x32_bf16 v[172:175], a[124:127], a[96:99], v[172:175]
    ds_read_b128 a[52:55], v9 offset:17408
    v_mfma_f32_16x16x32_bf16 v[176:179], a[80:83], a[68:71], v[176:179]
    s_add_u32 m0, s44, 9216
    s_add_u32 s40, s40, 262144
    buffer_load_dwordx4 v19, s[4:7], s41 offen offset:0 sc1 lds
    v_mfma_f32_16x16x32_bf16 v[176:179], a[112:115], a[100:103], v[176:179]
    ds_read_b128 a[24:27], v9 offset:2048
    v_mfma_f32_16x16x32_bf16 v[180:183], a[84:87], a[68:71], v[180:183]
    ds_read_b128 a[56:59], v9 offset:18432
    v_mfma_f32_16x16x32_bf16 v[180:183], a[116:119], a[100:103], v[180:183]
    v_mfma_f32_16x16x32_bf16 v[184:187], a[88:91], a[68:71], v[184:187]
    buffer_load_dwordx4 v19, s[4:7], s41 offen offset:1024 sc1 lds
    ds_read_b128 a[28:31], v9 offset:3072
    v_mfma_f32_16x16x32_bf16 v[184:187], a[120:123], a[100:103], v[184:187]
    ds_read_b128 a[60:63], v9 offset:19456
    v_mfma_f32_16x16x32_bf16 v[188:191], a[92:95], a[68:71], v[188:191]
    v_mfma_f32_16x16x32_bf16 v[188:191], a[124:127], a[100:103], v[188:191]
    ds_read_b128 a[4:7], v7 offset:1024
    v_mfma_f32_16x16x32_bf16 v[192:195], a[80:83], a[72:75], v[192:195]
    buffer_load_dwordx4 v19, s[4:7], s41 offen offset:2048 sc1 lds
    ds_read_b128 a[36:39], v7 offset:17408
    v_mfma_f32_16x16x32_bf16 v[192:195], a[112:115], a[104:107], v[192:195]
    v_mfma_f32_16x16x32_bf16 v[196:199], a[84:87], a[72:75], v[196:199]
    ds_read_b128 a[8:11], v7 offset:2048
    v_mfma_f32_16x16x32_bf16 v[196:199], a[116:119], a[104:107], v[196:199]
    ds_read_b128 a[40:43], v7 offset:18432
    v_mfma_f32_16x16x32_bf16 v[200:203], a[88:91], a[72:75], v[200:203]
    buffer_load_dwordx4 v19, s[4:7], s41 offen offset:3072 sc1 lds
    s_add_u32 s41, s41, 131072
    v_mfma_f32_16x16x32_bf16 v[200:203], a[120:123], a[104:107], v[200:203]
    ds_read_b128 a[12:15], v7 offset:3072
    v_mfma_f32_16x16x32_bf16 v[204:207], a[92:95], a[72:75], v[204:207]
    ds_read_b128 a[44:47], v7 offset:19456
    v_mfma_f32_16x16x32_bf16 v[204:207], a[124:127], a[104:107], v[204:207]
    v_mfma_f32_16x16x32_bf16 v[208:211], a[80:83], a[76:79], v[208:211]
    v_mfma_f32_16x16x32_bf16 v[208:211], a[112:115], a[108:111], v[208:211]
    s_lshl_b32 s43, s10, 8
    v_mfma_f32_16x16x32_bf16 v[212:215], a[84:87], a[76:79], v[212:215]
    s_add_u32 s42, s42, s43
    v_mfma_f32_16x16x32_bf16 v[212:215], a[116:119], a[108:111], v[212:215]
    s_lshl_b32 s43, s71, 7
    v_mfma_f32_16x16x32_bf16 v[216:219], a[88:91], a[76:79], v[216:219]
    s_add_u32 s42, s42, s43
    v_mfma_f32_16x16x32_bf16 v[216:219], a[120:123], a[108:111], v[216:219]
    v_mfma_f32_16x16x32_bf16 v[220:223], a[92:95], a[76:79], v[220:223]
    s_add_u32 m0, s44, 66560
    v_mfma_f32_16x16x32_bf16 v[220:223], a[124:127], a[108:111], v[220:223]
    s_waitcnt vmcnt(12) lgkmcnt(0)
    s_barrier
    v_mfma_f32_16x16x32_bf16 v[160:163], a[16:19], a[0:3], v[160:163]
    buffer_load_dwordx4 v0, s[4:7], s40 offen offset:0 sc1 lds
    ds_read_b128 a[64:67], v7 offset:32768
    v_mfma_f32_16x16x32_bf16 v[160:163], a[48:51], a[32:35], v[160:163]
    ds_read_b128 a[96:99], v7 offset:49152
    v_mfma_f32_16x16x32_bf16 v[164:167], a[20:23], a[0:3], v[164:167]
    v_mfma_f32_16x16x32_bf16 v[164:167], a[52:55], a[32:35], v[164:167]
    ds_read_b128 a[80:83], v9 offset:32768
    v_mfma_f32_16x16x32_bf16 v[168:171], a[24:27], a[0:3], v[168:171]
    buffer_load_dwordx4 v0, s[4:7], s40 offen offset:1024 sc1 lds
    ds_read_b128 a[112:115], v9 offset:49152
    v_mfma_f32_16x16x32_bf16 v[168:171], a[56:59], a[32:35], v[168:171]
    v_mfma_f32_16x16x32_bf16 v[172:175], a[28:31], a[0:3], v[172:175]
    ds_read_b128 a[84:87], v9 offset:33792
    v_mfma_f32_16x16x32_bf16 v[172:175], a[60:63], a[32:35], v[172:175]
    ds_read_b128 a[116:119], v9 offset:50176
    v_mfma_f32_16x16x32_bf16 v[176:179], a[16:19], a[4:7], v[176:179]
    s_add_u32 m0, s44, 74752
    s_add_u32 s40, s40, 262144
    buffer_load_dwordx4 v19, s[4:7], s41 offen offset:0 sc1 lds
    v_mfma_f32_16x16x32_bf16 v[176:179], a[48:51], a[36:39], v[176:179]
    ds_read_b128 a[88:91], v9 offset:34816
    v_mfma_f32_16x16x32_bf16 v[180:183], a[20:23], a[4:7], v[180:183]
    ds_read_b128 a[120:123], v9 offset:51200
    v_mfma_f32_16x16x32_bf16 v[180:183], a[52:55], a[36:39], v[180:183]
    v_mfma_f32_16x16x32_bf16 v[184:187], a[24:27], a[4:7], v[184:187]
    buffer_load_dwordx4 v19, s[4:7], s41 offen offset:1024 sc1 lds
    ds_read_b128 a[92:95], v9 offset:35840
    v_mfma_f32_16x16x32_bf16 v[184:187], a[56:59], a[36:39], v[184:187]
    ds_read_b128 a[124:127], v9 offset:52224
    v_mfma_f32_16x16x32_bf16 v[188:191], a[28:31], a[4:7], v[188:191]
    v_mfma_f32_16x16x32_bf16 v[188:191], a[60:63], a[36:39], v[188:191]
    ds_read_b128 a[68:71], v7 offset:33792
    v_mfma_f32_16x16x32_bf16 v[192:195], a[16:19], a[8:11], v[192:195]
    buffer_load_dwordx4 v19, s[4:7], s41 offen offset:2048 sc1 lds
    ds_read_b128 a[100:103], v7 offset:50176
    v_mfma_f32_16x16x32_bf16 v[192:195], a[48:51], a[40:43], v[192:195]
    v_mfma_f32_16x16x32_bf16 v[196:199], a[20:23], a[8:11], v[196:199]
    ds_read_b128 a[72:75], v7 offset:34816
    v_mfma_f32_16x16x32_bf16 v[196:199], a[52:55], a[40:43], v[196:199]
    ds_read_b128 a[104:107], v7 offset:51200
    v_mfma_f32_16x16x32_bf16 v[200:203], a[24:27], a[8:11], v[200:203]
    buffer_load_dwordx4 v19, s[4:7], s41 offen offset:3072 sc1 lds
    s_add_u32 s41, s41, 131072
    v_mfma_f32_16x16x32_bf16 v[200:203], a[56:59], a[40:43], v[200:203]
    ds_read_b128 a[76:79], v7 offset:35840
    v_mfma_f32_16x16x32_bf16 v[204:207], a[28:31], a[8:11], v[204:207]
    ds_read_b128 a[108:111], v7 offset:52224
    v_mfma_f32_16x16x32_bf16 v[204:207], a[60:63], a[40:43], v[204:207]
    v_mfma_f32_16x16x32_bf16 v[208:211], a[16:19], a[12:15], v[208:211]
    v_mfma_f32_16x16x32_bf16 v[208:211], a[48:51], a[44:47], v[208:211]
    v_mfma_f32_16x16x32_bf16 v[212:215], a[20:23], a[12:15], v[212:215]
    v_mfma_f32_16x16x32_bf16 v[212:215], a[52:55], a[44:47], v[212:215]
    v_mfma_f32_16x16x32_bf16 v[216:219], a[24:27], a[12:15], v[216:219]
    v_mfma_f32_16x16x32_bf16 v[216:219], a[56:59], a[44:47], v[216:219]
    v_mfma_f32_16x16x32_bf16 v[220:223], a[28:31], a[12:15], v[220:223]
    s_add_u32 m0, s44, 99328
    v_mfma_f32_16x16x32_bf16 v[220:223], a[60:63], a[44:47], v[220:223]
    s_waitcnt vmcnt(12) lgkmcnt(0)
    s_barrier
    v_mfma_f32_16x16x32_bf16 v[192:195], a[80:83], a[72:75], v[192:195]
    buffer_load_dwordx4 v0, s[4:7], s40 offen offset:0 sc1 lds
    ds_read_b128 a[0:3], v30 offset:0
    v_mfma_f32_16x16x32_bf16 v[192:195], a[112:115], a[104:107], v[192:195]
    v_mfma_f32_16x16x32_bf16 v[196:199], a[84:87], a[72:75], v[196:199]
    ds_read_b128 a[32:35], v30 offset:16384
    v_mfma_f32_16x16x32_bf16 v[196:199], a[116:119], a[104:107], v[196:199]
    v_mfma_f32_16x16x32_bf16 v[200:203], a[88:91], a[72:75], v[200:203]
    buffer_load_dwordx4 v0, s[4:7], s40 offen offset:1024 sc1 lds
    ds_read_b128 a[16:19], v32 offset:0
    v_mfma_f32_16x16x32_bf16 v[200:203], a[120:123], a[104:107], v[200:203]
    v_mfma_f32_16x16x32_bf16 v[204:207], a[92:95], a[72:75], v[204:207]
    ds_read_b128 a[48:51], v32 offset:16384
    v_mfma_f32_16x16x32_bf16 v[204:207], a[124:127], a[104:107], v[204:207]
    v_mfma_f32_16x16x32_bf16 v[208:211], a[80:83], a[76:79], v[208:211]
    s_add_u32 m0, s44, 107520
    s_add_u32 s40, s40, 262144
    buffer_load_dwordx4 v19, s[4:7], s41 offen offset:0 sc1 lds
    ds_read_b128 a[20:23], v32 offset:1024
    v_mfma_f32_16x16x32_bf16 v[208:211], a[112:115], a[108:111], v[208:211]
    v_mfma_f32_16x16x32_bf16 v[212:215], a[84:87], a[76:79], v[212:215]
    ds_read_b128 a[52:55], v32 offset:17408
    v_mfma_f32_16x16x32_bf16 v[212:215], a[116:119], a[108:111], v[212:215]
    v_mfma_f32_16x16x32_bf16 v[216:219], a[88:91], a[76:79], v[216:219]
    buffer_load_dwordx4 v19, s[4:7], s41 offen offset:1024 sc1 lds
    ds_read_b128 a[24:27], v32 offset:2048
    v_mfma_f32_16x16x32_bf16 v[216:219], a[120:123], a[108:111], v[216:219]
    v_mfma_f32_16x16x32_bf16 v[220:223], a[92:95], a[76:79], v[220:223]
    ds_read_b128 a[56:59], v32 offset:18432
    v_mfma_f32_16x16x32_bf16 v[220:223], a[124:127], a[108:111], v[220:223]
    v_mfma_f32_16x16x32_bf16 v[160:163], a[80:83], a[64:67], v[160:163]
    buffer_load_dwordx4 v19, s[4:7], s41 offen offset:2048 sc1 lds
    ds_read_b128 a[28:31], v32 offset:3072
    v_mfma_f32_16x16x32_bf16 v[160:163], a[112:115], a[96:99], v[160:163]
    v_mfma_f32_16x16x32_bf16 v[164:167], a[84:87], a[64:67], v[164:167]
    ds_read_b128 a[60:63], v32 offset:19456
    v_cvt_pk_bf16_f32 v240, v192, v193
    v_cvt_pk_bf16_f32 v241, v194, v195
    v_mfma_f32_16x16x32_bf16 v[164:167], a[116:119], a[96:99], v[164:167]
    v_cvt_pk_bf16_f32 v242, v196, v197
    v_mfma_f32_16x16x32_bf16 v[168:171], a[88:91], a[64:67], v[168:171]
    buffer_load_dwordx4 v19, s[4:7], s41 offen offset:3072 sc1 lds
    s_add_u32 s41, s41, 131072
    ds_read_b128 a[4:7], v30 offset:1024
    v_cvt_pk_bf16_f32 v243, v198, v199
    buffer_store_dwordx4 v[240:243], v19, s[4:7], s76 offen offset:0 sc1
    v_mfma_f32_16x16x32_bf16 v[168:171], a[120:123], a[96:99], v[168:171]
    v_cvt_pk_bf16_f32 v244, v200, v201
    v_mfma_f32_16x16x32_bf16 v[172:175], a[92:95], a[64:67], v[172:175]
    ds_read_b128 a[36:39], v30 offset:17408
    v_cvt_pk_bf16_f32 v245, v202, v203
    v_cvt_pk_bf16_f32 v246, v204, v205
    v_mfma_f32_16x16x32_bf16 v[172:175], a[124:127], a[96:99], v[172:175]
    v_cvt_pk_bf16_f32 v247, v206, v207
    v_mfma_f32_16x16x32_bf16 v[176:179], a[80:83], a[68:71], v[176:179]
    buffer_store_dwordx4 v[244:247], v19, s[4:7], s76 offen offset:1024 sc1
    v_mfma_f32_16x16x32_bf16 v[176:179], a[112:115], a[100:103], v[176:179]
    v_cvt_pk_bf16_f32 v248, v208, v209
    v_cvt_pk_bf16_f32 v249, v210, v211
    v_mfma_f32_16x16x32_bf16 v[180:183], a[84:87], a[68:71], v[180:183]
    v_cvt_pk_bf16_f32 v250, v212, v213
    v_mfma_f32_16x16x32_bf16 v[180:183], a[116:119], a[100:103], v[180:183]
    v_cvt_pk_bf16_f32 v251, v214, v215
    buffer_store_dwordx4 v[248:251], v19, s[4:7], s76 offen offset:2048 sc1
    v_mfma_f32_16x16x32_bf16 v[184:187], a[88:91], a[68:71], v[184:187]
    v_cvt_pk_bf16_f32 v252, v216, v217
    v_mfma_f32_16x16x32_bf16 v[184:187], a[120:123], a[100:103], v[184:187]
    v_cvt_pk_bf16_f32 v253, v218, v219
    v_cvt_pk_bf16_f32 v254, v220, v221
    v_mfma_f32_16x16x32_bf16 v[188:191], a[92:95], a[68:71], v[188:191]
    v_cvt_pk_bf16_f32 v255, v222, v223
    v_mfma_f32_16x16x32_bf16 v[188:191], a[124:127], a[100:103], v[188:191]
    buffer_store_dwordx4 v[252:255], v19, s[4:7], s76 offen offset:3072 sc1
    s_waitcnt vmcnt(16) lgkmcnt(0)
    s_barrier
    v_mfma_f32_16x16x32_bf16 v[160:163], a[16:19], a[0:3], v[160:163]
    ds_read_b128 a[64:67], v4 offset:0
    ds_read_b128 a[96:99], v4 offset:16384
    v_mfma_f32_16x16x32_bf16 v[160:163], a[48:51], a[32:35], v[160:163]
    ds_read_b128 a[80:83], v6 offset:0
    v_mfma_f32_16x16x32_bf16 v[164:167], a[20:23], a[0:3], v[164:167]
    ds_read_b128 a[112:115], v6 offset:16384
    v_mfma_f32_16x16x32_bf16 v[164:167], a[52:55], a[32:35], v[164:167]
    ds_read_b128 a[84:87], v6 offset:1024
    ds_read_b128 a[116:119], v6 offset:17408
    v_mfma_f32_16x16x32_bf16 v[168:171], a[24:27], a[0:3], v[168:171]
    ds_read_b128 a[88:91], v6 offset:2048
    v_mfma_f32_16x16x32_bf16 v[168:171], a[56:59], a[32:35], v[168:171]
    ds_read_b128 a[120:123], v6 offset:18432
    v_mfma_f32_16x16x32_bf16 v[172:175], a[28:31], a[0:3], v[172:175]
    ds_read_b128 a[92:95], v6 offset:3072
    ds_read_b128 a[124:127], v6 offset:19456
    v_mfma_f32_16x16x32_bf16 v[172:175], a[60:63], a[32:35], v[172:175]
    ds_read_b128 a[68:71], v4 offset:1024
    v_mfma_f32_16x16x32_bf16 v[176:179], a[16:19], a[4:7], v[176:179]
    ds_read_b128 a[100:103], v4 offset:17408
    v_mfma_f32_16x16x32_bf16 v[176:179], a[48:51], a[36:39], v[176:179]
    v_mfma_f32_16x16x32_bf16 v[180:183], a[20:23], a[4:7], v[180:183]
    v_mfma_f32_16x16x32_bf16 v[180:183], a[52:55], a[36:39], v[180:183]
    v_mfma_f32_16x16x32_bf16 v[184:187], a[24:27], a[4:7], v[184:187]
    v_mfma_f32_16x16x32_bf16 v[184:187], a[56:59], a[36:39], v[184:187]
    v_mfma_f32_16x16x32_bf16 v[188:191], a[28:31], a[4:7], v[188:191]
    v_mfma_f32_16x16x32_bf16 v[188:191], a[60:63], a[36:39], v[188:191]
    s_waitcnt vmcnt(10) lgkmcnt(0)
    s_barrier
    v_mfma_f32_16x16x32_bf16 v[160:163], a[80:83], a[64:67], v[160:163]
    ds_read_b128 a[0:3], v7 offset:0
    ds_read_b128 a[32:35], v7 offset:16384
    v_mfma_f32_16x16x32_bf16 v[160:163], a[112:115], a[96:99], v[160:163]
    ds_read_b128 a[16:19], v9 offset:0
    v_mfma_f32_16x16x32_bf16 v[164:167], a[84:87], a[64:67], v[164:167]
    ds_read_b128 a[48:51], v9 offset:16384
    v_mfma_f32_16x16x32_bf16 v[164:167], a[116:119], a[96:99], v[164:167]
    ds_read_b128 a[20:23], v9 offset:1024
    ds_read_b128 a[52:55], v9 offset:17408
    v_mfma_f32_16x16x32_bf16 v[168:171], a[88:91], a[64:67], v[168:171]
    ds_read_b128 a[24:27], v9 offset:2048
    v_mfma_f32_16x16x32_bf16 v[168:171], a[120:123], a[96:99], v[168:171]
    ds_read_b128 a[56:59], v9 offset:18432
    v_mfma_f32_16x16x32_bf16 v[172:175], a[92:95], a[64:67], v[172:175]
    ds_read_b128 a[28:31], v9 offset:3072
    ds_read_b128 a[60:63], v9 offset:19456
    v_mfma_f32_16x16x32_bf16 v[172:175], a[124:127], a[96:99], v[172:175]
    ds_read_b128 a[4:7], v7 offset:1024
    v_mfma_f32_16x16x32_bf16 v[176:179], a[80:83], a[68:71], v[176:179]
    ds_read_b128 a[36:39], v7 offset:17408
    v_mfma_f32_16x16x32_bf16 v[176:179], a[112:115], a[100:103], v[176:179]
    v_mfma_f32_16x16x32_bf16 v[180:183], a[84:87], a[68:71], v[180:183]
    v_mfma_f32_16x16x32_bf16 v[180:183], a[116:119], a[100:103], v[180:183]
    v_mfma_f32_16x16x32_bf16 v[184:187], a[88:91], a[68:71], v[184:187]
    v_mfma_f32_16x16x32_bf16 v[184:187], a[120:123], a[100:103], v[184:187]
    v_mfma_f32_16x16x32_bf16 v[188:191], a[92:95], a[68:71], v[188:191]
    v_mfma_f32_16x16x32_bf16 v[188:191], a[124:127], a[100:103], v[188:191]
    s_waitcnt vmcnt(4) lgkmcnt(0)
    s_barrier
    v_mfma_f32_16x16x32_bf16 v[160:163], a[16:19], a[0:3], v[160:163]
    ds_read_b128 a[64:67], v7 offset:32768
    ds_read_b128 a[96:99], v7 offset:49152
    v_mfma_f32_16x16x32_bf16 v[160:163], a[48:51], a[32:35], v[160:163]
    ds_read_b128 a[80:83], v9 offset:32768
    v_mfma_f32_16x16x32_bf16 v[164:167], a[20:23], a[0:3], v[164:167]
    ds_read_b128 a[112:115], v9 offset:49152
    v_mfma_f32_16x16x32_bf16 v[164:167], a[52:55], a[32:35], v[164:167]
    ds_read_b128 a[84:87], v9 offset:33792
    ds_read_b128 a[116:119], v9 offset:50176
    v_mfma_f32_16x16x32_bf16 v[168:171], a[24:27], a[0:3], v[168:171]
    ds_read_b128 a[88:91], v9 offset:34816
    v_mfma_f32_16x16x32_bf16 v[168:171], a[56:59], a[32:35], v[168:171]
    ds_read_b128 a[120:123], v9 offset:51200
    v_mfma_f32_16x16x32_bf16 v[172:175], a[28:31], a[0:3], v[172:175]
    ds_read_b128 a[92:95], v9 offset:35840
    ds_read_b128 a[124:127], v9 offset:52224
    v_mfma_f32_16x16x32_bf16 v[172:175], a[60:63], a[32:35], v[172:175]
    ds_read_b128 a[68:71], v7 offset:33792
    v_mfma_f32_16x16x32_bf16 v[176:179], a[16:19], a[4:7], v[176:179]
    ds_read_b128 a[100:103], v7 offset:50176
    v_mfma_f32_16x16x32_bf16 v[176:179], a[48:51], a[36:39], v[176:179]
    v_mfma_f32_16x16x32_bf16 v[180:183], a[20:23], a[4:7], v[180:183]
    v_mfma_f32_16x16x32_bf16 v[180:183], a[52:55], a[36:39], v[180:183]
    v_mfma_f32_16x16x32_bf16 v[184:187], a[24:27], a[4:7], v[184:187]
    v_mfma_f32_16x16x32_bf16 v[184:187], a[56:59], a[36:39], v[184:187]
    v_mfma_f32_16x16x32_bf16 v[188:191], a[28:31], a[4:7], v[188:191]
    v_mfma_f32_16x16x32_bf16 v[188:191], a[60:63], a[36:39], v[188:191]
    s_waitcnt vmcnt(63) lgkmcnt(0)
    s_nop 0
    v_mfma_f32_16x16x32_bf16 v[160:163], a[80:83], a[64:67], v[160:163]
    v_mfma_f32_16x16x32_bf16 v[160:163], a[112:115], a[96:99], v[160:163]
    v_mfma_f32_16x16x32_bf16 v[164:167], a[84:87], a[64:67], v[164:167]
    v_mfma_f32_16x16x32_bf16 v[164:167], a[116:119], a[96:99], v[164:167]
    v_mfma_f32_16x16x32_bf16 v[168:171], a[88:91], a[64:67], v[168:171]
    v_mfma_f32_16x16x32_bf16 v[168:171], a[120:123], a[96:99], v[168:171]
    v_mfma_f32_16x16x32_bf16 v[172:175], a[92:95], a[64:67], v[172:175]
    v_mfma_f32_16x16x32_bf16 v[172:175], a[124:127], a[96:99], v[172:175]
    v_mfma_f32_16x16x32_bf16 v[176:179], a[80:83], a[68:71], v[176:179]
    buffer_load_dwordx4 v[224:227], v19, s[4:7], s47 offen offset:0 sc1
    v_mfma_f32_16x16x32_bf16 v[176:179], a[112:115], a[100:103], v[176:179]
    v_mfma_f32_16x16x32_bf16 v[180:183], a[84:87], a[68:71], v[180:183]
    buffer_load_dwordx4 v[228:231], v19, s[4:7], s47 offen offset:1024 sc1
    v_mfma_f32_16x16x32_bf16 v[180:183], a[116:119], a[100:103], v[180:183]
    v_mfma_f32_16x16x32_bf16 v[184:187], a[88:91], a[68:71], v[184:187]
    buffer_load_dwordx4 v[232:235], v19, s[4:7], s47 offen offset:2048 sc1
    v_mfma_f32_16x16x32_bf16 v[184:187], a[120:123], a[100:103], v[184:187]
    v_mfma_f32_16x16x32_bf16 v[188:191], a[92:95], a[68:71], v[188:191]
    buffer_load_dwordx4 v[236:239], v19, s[4:7], s47 offen offset:3072 sc1
    v_mfma_f32_16x16x32_bf16 v[188:191], a[124:127], a[100:103], v[188:191]
    s_waitcnt vmcnt(0)
    s_nop 0
    v_max3_u32 v6, v224, v225, v226
    v_max3_u32 v7, v227, v228, v229
    v_max3_u32 v7, v7, v230, v231
    v_max3_u32 v6, v6, v232, v233
    v_max3_u32 v7, v7, v234, v235
    v_max3_u32 v6, v6, v236, v237
    v_max3_u32 v7, v7, v238, v239
    v_max_u32 v6, v6, v7
    v_cmp_eq_u32 vcc, -1, v6
    s_nop 1
    s_cbranch_vccnz Lf_x
Lf_xd:
    v_dot2_f32_bf16 v160, v224, v16, v160
    v_dot2_f32_bf16 v161, v224, v17, v161
    v_dot2_f32_bf16 v162, v225, v16, v162
    v_dot2_f32_bf16 v163, v225, v17, v163
    v_dot2_f32_bf16 v164, v226, v16, v164
    v_dot2_f32_bf16 v165, v226, v17, v165
    v_dot2_f32_bf16 v166, v227, v16, v166
    v_dot2_f32_bf16 v167, v227, v17, v167
    v_dot2_f32_bf16 v168, v228, v16, v168
    v_dot2_f32_bf16 v169, v228, v17, v169
    v_dot2_f32_bf16 v170, v229, v16, v170
    v_dot2_f32_bf16 v171, v229, v17, v171
    v_dot2_f32_bf16 v172, v230, v16, v172
    v_dot2_f32_bf16 v173, v230, v17, v173
    v_dot2_f32_bf16 v174, v231, v16, v174
    v_dot2_f32_bf16 v175, v231, v17, v175
    v_cvt_pk_bf16_f32 v40, v160, v161
    v_cvt_pk_bf16_f32 v41, v162, v163
    ds_write_b64 v5, v[40:41] offset:0
    v_cvt_pk_bf16_f32 v42, v164, v165
    v_cvt_pk_bf16_f32 v43, v166, v167
    ds_write_b64 v5, v[42:43] offset:32
    v_dot2_f32_bf16 v176, v232, v16, v176
    v_dot2_f32_bf16 v177, v232, v17, v177
    v_dot2_f32_bf16 v178, v233, v16, v178
    v_dot2_f32_bf16 v179, v233, v17, v179
    v_dot2_f32_bf16 v180, v234, v16, v180
    v_dot2_f32_bf16 v181, v234, v17, v181
    v_dot2_f32_bf16 v182, v235, v16, v182
    v_dot2_f32_bf16 v183, v235, v17, v183
    v_cvt_pk_bf16_f32 v44, v168, v169
    v_cvt_pk_bf16_f32 v45, v170, v171
    ds_write_b64 v5, v[44:45] offset:64
    v_cvt_pk_bf16_f32 v46, v172, v173
    v_cvt_pk_bf16_f32 v47, v174, v175
    ds_write_b64 v5, v[46:47] offset:96
    ds_read_b128 v[96:99], v10 offset:0
    ds_read_b128 v[100:103], v10 offset:1152
    v_dot2_f32_bf16 v184, v236, v16, v184
    v_dot2_f32_bf16 v185, v236, v17, v185
    v_dot2_f32_bf16 v186, v237, v16, v186
    v_dot2_f32_bf16 v187, v237, v17, v187
    v_dot2_f32_bf16 v188, v238, v16, v188
    v_dot2_f32_bf16 v189, v238, v17, v189
    v_dot2_f32_bf16 v190, v239, v16, v190
    v_dot2_f32_bf16 v191, v239, v17, v191
    v_cvt_pk_bf16_f32 v48, v176, v177
    v_cvt_pk_bf16_f32 v49, v178, v179
    ds_write_b64 v5, v[48:49] offset:2304
    v_cvt_pk_bf16_f32 v50, v180, v181
    v_cvt_pk_bf16_f32 v51, v182, v183
    ds_write_b64 v5, v[50:51] offset:2336
    s_nop 2
    s_nop 0
    v_cvt_pk_bf16_f32 v52, v184, v185
    v_cvt_pk_bf16_f32 v53, v186, v187
    ds_write_b64 v5, v[52:53] offset:2368
    v_cvt_pk_bf16_f32 v54, v188, v189
    v_cvt_pk_bf16_f32 v55, v190, v191
    ds_write_b64 v5, v[54:55] offset:2400
    ds_read_b128 v[104:107], v10 offset:2304
    ds_read_b128 v[108:111], v10 offset:3456
    s_waitcnt lgkmcnt(6)
    buffer_store_dwordx4 v[96:99], v8, s[28:31], s42 offen nt
    s_add_u32 s42, s42, 16384
    buffer_store_dwordx4 v[100:103], v8, s[28:31], s42 offen nt
    s_add_u32 s42, s42, 16384
    s_waitcnt lgkmcnt(1)
    buffer_store_dwordx4 v[104:107], v8, s[28:31], s42 offen nt
    s_add_u32 s42, s42, 16384
    s_waitcnt lgkmcnt(0)
    buffer_store_dwordx4 v[108:111], v8, s[28:31], s42 offen nt
    s_add_u32 s42, s42, 16384
    s_endpgm
Lf_end:
    s_endpgm
Lf_zb1:
    v_mov_b32 v20, s2
    v_mov_b32 v21, 1
    s_mov_b64 exec, 1
    global_store_byte v20, v21, s[100:101] sc1
    s_mov_b64 exec, -1
    s_branch Lf_nb1
Lf_zb2:
    v_mov_b32 v20, s2
    v_mov_b32 v21, 1
    s_mov_b64 exec, 1
    global_store_byte v20, v21, s[100:101] sc1
    s_mov_b64 exec, -1
    s_branch Lf_nb2
Lf_zb3:
    v_mov_b32 v20, s2
    v_mov_b32 v21, 1
    s_mov_b64 exec, 1
    global_store_byte v20, v21, s[100:101] sc1
    s_mov_b64 exec, -1
    s_branch Lf_nb3
Lf_zb4:
    v_mov_b32 v20, s2
    v_mov_b32 v21, 1
    s_mov_b64 exec, 1
    global_store_byte v20, v21, s[100:101] sc1
    s_mov_b64 exec, -1
    s_branch Lf_nb4
Lf_zb5:
    v_mov_b32 v20, s2
    v_mov_b32 v21, 1
    s_mov_b64 exec, 1
    global_store_byte v20, v21, s[100:101] sc1
    s_mov_b64 exec, -1
    s_branch Lf_nb5
Lf_zb6:
    v_mov_b32 v20, s2
    v_mov_b32 v21, 1
    s_mov_b64 exec, 1
    global_store_byte v20, v21, s[100:101] sc1
    s_mov_b64 exec, -1
    s_branch Lf_nb6
Lf_zb7:
    v_mov_b32 v20, s2
    v_mov_b32 v21, 1
    s_mov_b64 exec, 1
    global_store_byte v20, v21, s[100:101] sc1
    s_mov_b64 exec, -1
    s_branch Lf_nb7
Lf_zb8:
    v_mov_b32 v20, s2
    v_mov_b32 v21, 1
    s_mov_b64 exec, 1
    global_store_byte v20, v21, s[100:101] sc1
    s_mov_b64 exec, -1
    s_branch Lf_nb8
Lf_sl1:
    s_mov_b32 s72, 0
Lf_ck1:
    s_sleep 2
    global_load_dword v45, v9, s[100:101] sc1
    s_add_u32 s72, s72, 1
    s_waitcnt vmcnt(0)
    v_cmp_eq_u32 vcc, 0x01010101, v45
    s_nop 1
    s_cmp_eq_u64 vcc, exec
    s_cbranch_scc1 Lf_ok1
    s_cmp_lt_u32 s72, 131072
    s_cbranch_scc1 Lf_ck1
    s_branch Lf_ok1
Lf_sl2:
    s_mov_b32 s72, 0
Lf_ck2:
    s_sleep 2
    buffer_load_dword v45, v7, s[4:7], 0 offen sc1
    s_add_u32 s72, s72, 1
    s_waitcnt vmcnt(0)
    v_cmp_eq_u32 vcc, 1, v45
    s_nop 1
    s_cmp_eq_u64 vcc, exec
    s_cbranch_scc1 Lf_ok2
    s_cmp_lt_u32 s72, 131072
    s_cbranch_scc1 Lf_ck2
    s_branch Lf_ok2
Lf_m0_0:
    v_mov_b32 v40, v33
    v_mov_b32 v41, v33
    v_mov_b32 v42, v33
    v_mov_b32 v43, v33
    v_mov_b32 v44, v33
    v_mov_b32 v45, v33
    v_mov_b32 v46, v33
    v_mov_b32 v47, v33
    v_mov_b32 v48, v33
    v_mov_b32 v49, v33
    v_mov_b32 v50, v33
    v_mov_b32 v51, v33
    v_mov_b32 v52, v33
    v_mov_b32 v53, v33
    v_mov_b32 v54, v33
    v_mov_b32 v55, v33
    s_branch Lf_nm0_0
Lf_m0_1:
    v_mov_b32 v56, v33
    v_mov_b32 v57, v33
    v_mov_b32 v58, v33
    v_mov_b32 v59, v33
    v_mov_b32 v60, v33
    v_mov_b32 v61, v33
    v_mov_b32 v62, v33
    v_mov_b32 v63, v33
    v_mov_b32 v64, v33
    v_mov_b32 v65, v33
    v_mov_b32 v66, v33
    v_mov_b32 v67, v33
    v_mov_b32 v68, v33
    v_mov_b32 v69, v33
    v_mov_b32 v70, v33
    v_mov_b32 v71, v33
    s_branch Lf_nm0_1
Lf_m0_2:
    v_mov_b32 v72, v33
    v_mov_b32 v73, v33
    v_mov_b32 v74, v33
    v_mov_b32 v75, v33
    v_mov_b32 v76, v33
    v_mov_b32 v77, v33
    v_mov_b32 v78, v33
    v_mov_b32 v79, v33
    v_mov_b32 v80, v33
    v_mov_b32 v81, v33
    v_mov_b32 v82, v33
    v_mov_b32 v83, v33
    v_mov_b32 v84, v33
    v_mov_b32 v85, v33
    v_mov_b32 v86, v33
    v_mov_b32 v87, v33
    s_branch Lf_nm0_2
Lf_m0_3:
    v_mov_b32 v88, v33
    v_mov_b32 v89, v33
    v_mov_b32 v90, v33
    v_mov_b32 v91, v33
    v_mov_b32 v92, v33
    v_mov_b32 v93, v33
    v_mov_b32 v94, v33
    v_mov_b32 v95, v33
    v_mov_b32 v96, v33
    v_mov_b32 v97, v33
    v_mov_b32 v98, v33
    v_mov_b32 v99, v33
    v_mov_b32 v100, v33
    v_mov_b32 v101, v33
    v_mov_b32 v102, v33
    v_mov_b32 v103, v33
    s_branch Lf_nm0_3
Lf_m0_4:
    v_mov_b32 v104, v33
    v_mov_b32 v105, v33
    v_mov_b32 v106, v33
    v_mov_b32 v107, v33
    v_mov_b32 v108, v33
    v_mov_b32 v109, v33
    v_mov_b32 v110, v33
    v_mov_b32 v111, v33
    v_mov_b32 v112, v33
    v_mov_b32 v113, v33
    v_mov_b32 v114, v33
    v_mov_b32 v115, v33
    v_mov_b32 v116, v33
    v_mov_b32 v117, v33
    v_mov_b32 v118, v33
    v_mov_b32 v119, v33
    s_branch Lf_nm0_4
Lf_m0_5:
    v_mov_b32 v120, v33
    v_mov_b32 v121, v33
    v_mov_b32 v122, v33
    v_mov_b32 v123, v33
    v_mov_b32 v124, v33
    v_mov_b32 v125, v33
    v_mov_b32 v126, v33
    v_mov_b32 v127, v33
    v_mov_b32 v128, v33
    v_mov_b32 v129, v33
    v_mov_b32 v130, v33
    v_mov_b32 v131, v33
    v_mov_b32 v132, v33
    v_mov_b32 v133, v33
    v_mov_b32 v134, v33
    v_mov_b32 v135, v33
    s_branch Lf_nm0_5
Lf_m0_6:
    v_mov_b32 v136, v33
    v_mov_b32 v137, v33
    v_mov_b32 v138, v33
    v_mov_b32 v139, v33
    v_mov_b32 v140, v33
    v_mov_b32 v141, v33
    v_mov_b32 v142, v33
    v_mov_b32 v143, v33
    v_mov_b32 v144, v33
    v_mov_b32 v145, v33
    v_mov_b32 v146, v33
    v_mov_b32 v147, v33
    v_mov_b32 v148, v33
    v_mov_b32 v149, v33
    v_mov_b32 v150, v33
    v_mov_b32 v151, v33
    s_branch Lf_nm0_6
Lf_m0_7:
    v_mov_b32 v152, v33
    v_mov_b32 v153, v33
    v_mov_b32 v154, v33
    v_mov_b32 v155, v33
    v_mov_b32 v156, v33
    v_mov_b32 v157, v33
    v_mov_b32 v158, v33
    v_mov_b32 v159, v33
    v_mov_b32 v160, v33
    v_mov_b32 v161, v33
    v_mov_b32 v162, v33
    v_mov_b32 v163, v33
    v_mov_b32 v164, v33
    v_mov_b32 v165, v33
    v_mov_b32 v166, v33
    v_mov_b32 v167, v33
    s_branch Lf_nm0_7
Lf_m1_0:
    v_mov_b32 v168, v33
    v_mov_b32 v169, v33
    v_mov_b32 v170, v33
    v_mov_b32 v171, v33
    v_mov_b32 v172, v33
    v_mov_b32 v173, v33
    v_mov_b32 v174, v33
    v_mov_b32 v175, v33
    v_mov_b32 v176, v33
    v_mov_b32 v177, v33
    v_mov_b32 v178, v33
    v_mov_b32 v179, v33
    v_mov_b32 v180, v33
    v_mov_b32 v181, v33
    v_mov_b32 v182, v33
    v_mov_b32 v183, v33
    s_branch Lf_nm1_0
Lf_m1_1:
    v_mov_b32 v200, v33
    v_mov_b32 v201, v33
    v_mov_b32 v202, v33
    v_mov_b32 v203, v33
    v_mov_b32 v204, v33
    v_mov_b32 v205, v33
    v_mov_b32 v206, v33
    v_mov_b32 v207, v33
    v_mov_b32 v208, v33
    v_mov_b32 v209, v33
    v_mov_b32 v210, v33
    v_mov_b32 v211, v33
    v_mov_b32 v212, v33
    v_mov_b32 v213, v33
    v_mov_b32 v214, v33
    v_mov_b32 v215, v33
    s_branch Lf_nm1_1
Lf_m1_2:
    v_mov_b32 v216, v33
    v_mov_b32 v217, v33
    v_mov_b32 v218, v33
    v_mov_b32 v219, v33
    v_mov_b32 v220, v33
    v_mov_b32 v221, v33
    v_mov_b32 v222, v33
    v_mov_b32 v223, v33
    v_mov_b32 v224, v33
    v_mov_b32 v225, v33
    v_mov_b32 v226, v33
    v_mov_b32 v227, v33
    v_mov_b32 v228, v33
    v_mov_b32 v229, v33
    v_mov_b32 v230, v33
    v_mov_b32 v231, v33
    s_branch Lf_nm1_2
Lf_m1_3:
    v_mov_b32 v232, v33
    v_mov_b32 v233, v33
    v_mov_b32 v234, v33
    v_mov_b32 v235, v33
    v_mov_b32 v236, v33
    v_mov_b32 v237, v33
    v_mov_b32 v238, v33
    v_mov_b32 v239, v33
    v_mov_b32 v240, v33
    v_mov_b32 v241, v33
    v_mov_b32 v242, v33
    v_mov_b32 v243, v33
    v_mov_b32 v244, v33
    v_mov_b32 v245, v33
    v_mov_b32 v246, v33
    v_mov_b32 v247, v33
    s_branch Lf_nm1_3
Lf_sl3:
    s_mov_b32 s72, 0
Lf_ck3:
    s_sleep 2
    buffer_load_dword v39, v0, s[4:7], 0 offen sc1
    s_add_u32 s72, s72, 1
    s_waitcnt vmcnt(0)
    v_cmp_eq_u32 vcc, 1, v39
    s_nop 1
    s_cmp_eq_u64 vcc, exec
    s_cbranch_scc1 Lf_ok3
    s_cmp_lt_u32 s72, 131072
    s_cbranch_scc1 Lf_ck3
    s_branch Lf_ok3
Lf_sl4:
    s_mov_b32 s72, 0
Lf_ck4:
    s_sleep 2
    buffer_load_dwordx4 v[4:7], v3, s[4:7], s14 offen sc1
    s_add_u32 s72, s72, 1
    s_waitcnt vmcnt(0)
    v_and_b32 v4, v4, v5
    v_and_b32 v6, v6, v7
    v_and_b32 v4, v4, v6
    v_cmp_eq_u32 vcc, 1, v4
    s_nop 1
    s_cmp_eq_u64 vcc, exec
    s_cbranch_scc1 Lf_ok4
    s_cmp_lt_u32 s72, 131072
    s_cbranch_scc1 Lf_ck4
    s_branch Lf_ok4
Lf_m1_4:
    v_mov_b32 v104, v33
    v_mov_b32 v105, v33
    v_mov_b32 v106, v33
    v_mov_b32 v107, v33
    v_mov_b32 v108, v33
    v_mov_b32 v109, v33
    v_mov_b32 v110, v33
    v_mov_b32 v111, v33
    v_mov_b32 v112, v33
    v_mov_b32 v113, v33
    v_mov_b32 v114, v33
    v_mov_b32 v115, v33
    v_mov_b32 v116, v33
    v_mov_b32 v117, v33
    v_mov_b32 v118, v33
    v_mov_b32 v119, v33
    s_branch Lf_nm1_4
Lf_m1_5:
    v_mov_b32 v120, v33
    v_mov_b32 v121, v33
    v_mov_b32 v122, v33
    v_mov_b32 v123, v33
    v_mov_b32 v124, v33
    v_mov_b32 v125, v33
    v_mov_b32 v126, v33
    v_mov_b32 v127, v33
    v_mov_b32 v128, v33
    v_mov_b32 v129, v33
    v_mov_b32 v130, v33
    v_mov_b32 v131, v33
    v_mov_b32 v132, v33
    v_mov_b32 v133, v33
    v_mov_b32 v134, v33
    v_mov_b32 v135, v33
    s_branch Lf_nm1_5
Lf_m1_6:
    v_mov_b32 v136, v33
    v_mov_b32 v137, v33
    v_mov_b32 v138, v33
    v_mov_b32 v139, v33
    v_mov_b32 v140, v33
    v_mov_b32 v141, v33
    v_mov_b32 v142, v33
    v_mov_b32 v143, v33
    v_mov_b32 v144, v33
    v_mov_b32 v145, v33
    v_mov_b32 v146, v33
    v_mov_b32 v147, v33
    v_mov_b32 v148, v33
    v_mov_b32 v149, v33
    v_mov_b32 v150, v33
    v_mov_b32 v151, v33
    s_branch Lf_nm1_6
Lf_m1_7:
    v_mov_b32 v152, v33
    v_mov_b32 v153, v33
    v_mov_b32 v154, v33
    v_mov_b32 v155, v33
    v_mov_b32 v156, v33
    v_mov_b32 v157, v33
    v_mov_b32 v158, v33
    v_mov_b32 v159, v33
    v_mov_b32 v160, v33
    v_mov_b32 v161, v33
    v_mov_b32 v162, v33
    v_mov_b32 v163, v33
    v_mov_b32 v164, v33
    v_mov_b32 v165, v33
    v_mov_b32 v166, v33
    v_mov_b32 v167, v33
    s_branch Lf_nm1_7
Lf_sl5:
    s_mov_b32 s72, 0
Lf_ck5:
    s_sleep 2
    buffer_load_dwordx2 v[38:39], v29, s[4:7], s45 offen sc1
    s_add_u32 s72, s72, 1
    s_waitcnt vmcnt(0)
    v_and_b32 v38, v38, v39
    v_cmp_eq_u32 vcc, 1, v38
    s_nop 1
    s_cmp_eq_u64 vcc, exec
    s_cbranch_scc1 Lf_ok5
    s_cmp_lt_u32 s72, 131072
    s_cbranch_scc1 Lf_ck5
    s_branch Lf_ok5
Lf_nopref:
    buffer_load_dwordx2 v[38:39], v29, s[4:7], s45 offen sc1
    s_waitcnt vmcnt(0)
    v_and_b32 v38, v38, v39
    v_cmp_eq_u32 vcc, 1, v38
    s_nop 1
    s_cmp_eq_u64 vcc, exec
    s_cbranch_scc0 Lf_sl5
Lf_ok5:
    buffer_load_dword v28, v16, s[4:7], s69 offen sc1
    buffer_load_dword v32, v16, s[4:7], s69 offen offset:128 sc1
    s_add_u32 m0, s44, 66560
    s_nop 0
    s_nop 0
    buffer_load_dwordx4 v0, s[4:7], s40 offen offset:0 sc1 lds
    buffer_load_dwordx4 v0, s[4:7], s40 offen offset:1024 sc1 lds
    buffer_load_dwordx4 v1, s[4:7], s40 offen offset:2048 sc1 lds
    buffer_load_dwordx4 v1, s[4:7], s40 offen offset:3072 sc1 lds
    s_add_u32 m0, s44, 74752
    s_add_u32 s40, s40, 262144
    buffer_load_dwordx4 v19, s[4:7], s41 offen offset:0 sc1 lds
    buffer_load_dwordx4 v19, s[4:7], s41 offen offset:1024 sc1 lds
    buffer_load_dwordx4 v19, s[4:7], s41 offen offset:2048 sc1 lds
    buffer_load_dwordx4 v19, s[4:7], s41 offen offset:3072 sc1 lds
    s_add_u32 s41, s41, 131072
    s_add_u32 m0, s44, 99328
    s_nop 0
    s_nop 0
    buffer_load_dwordx4 v0, s[4:7], s40 offen offset:0 sc1 lds
    buffer_load_dwordx4 v0, s[4:7], s40 offen offset:1024 sc1 lds
    buffer_load_dwordx4 v1, s[4:7], s40 offen offset:2048 sc1 lds
    buffer_load_dwordx4 v1, s[4:7], s40 offen offset:3072 sc1 lds
    s_add_u32 m0, s44, 107520
    s_add_u32 s40, s40, 262144
    buffer_load_dwordx4 v19, s[4:7], s41 offen offset:0 sc1 lds
    buffer_load_dwordx4 v19, s[4:7], s41 offen offset:1024 sc1 lds
    buffer_load_dwordx4 v19, s[4:7], s41 offen offset:2048 sc1 lds
    buffer_load_dwordx4 v19, s[4:7], s41 offen offset:3072 sc1 lds
    s_add_u32 s41, s41, 131072
    s_add_u32 m0, s44, 132096
    s_nop 0
    s_nop 0
    buffer_load_dwordx4 v0, s[4:7], s40 offen offset:0 sc1 lds
    buffer_load_dwordx4 v0, s[4:7], s40 offen offset:1024 sc1 lds
    buffer_load_dwordx4 v1, s[4:7], s40 offen offset:2048 sc1 lds
    buffer_load_dwordx4 v1, s[4:7], s40 offen offset:3072 sc1 lds
    s_add_u32 m0, s44, 140288
    s_add_u32 s40, s40, 262144
    buffer_load_dwordx4 v19, s[4:7], s41 offen offset:0 sc1 lds
    buffer_load_dwordx4 v19, s[4:7], s41 offen offset:1024 sc1 lds
    buffer_load_dwordx4 v19, s[4:7], s41 offen offset:2048 sc1 lds
    buffer_load_dwordx4 v19, s[4:7], s41 offen offset:3072 sc1 lds
    s_add_u32 s41, s41, 131072
    s_branch Lf_pref
Lf_sl6:
    s_mov_b32 s72, 0
Lf_ck6:
    s_sleep 2
    buffer_load_dwordx2 v[20:21], v11, s[4:7], s45 offen sc1
    s_add_u32 s72, s72, 1
    s_waitcnt vmcnt(0)
    v_and_b32 v20, v20, v21
    v_cmp_eq_u32 vcc, 1, v20
    s_nop 1
    s_cmp_eq_u64 vcc, exec
    s_cbranch_scc1 Lf_ok6
    s_cmp_lt_u32 s72, 131072
    s_cbranch_scc1 Lf_ck6
    s_branch Lf_ok6
Lf_x:
    s_mov_b32 s69, 0
Lf_x2:
    buffer_load_dwordx4 v[224:227], v19, s[4:7], s47 offen offset:0 sc1
    buffer_load_dwordx4 v[228:231], v19, s[4:7], s47 offen offset:1024 sc1
    buffer_load_dwordx4 v[232:235], v19, s[4:7], s47 offen offset:2048 sc1
    buffer_load_dwordx4 v[236:239], v19, s[4:7], s47 offen offset:3072 sc1
    s_add_u32 s69, s69, 1
    s_waitcnt vmcnt(0)
    s_nop 0
    v_max3_u32 v6, v224, v225, v226
    v_max3_u32 v7, v227, v228, v229
    v_max3_u32 v7, v7, v230, v231
    v_max3_u32 v6, v6, v232, v233
    v_max3_u32 v7, v7, v234, v235
    v_max3_u32 v6, v6, v236, v237
    v_max3_u32 v7, v7, v238, v239
    v_max_u32 v6, v6, v7
    v_cmp_eq_u32 vcc, -1, v6
    s_nop 1
    s_cbranch_vccz Lf_xd
    s_cmp_lt_u32 s69, 131072
    s_cbranch_scc1 Lf_x2
    s_branch Lf_xd
Lcode_end:
.section .rodata,"a"
.p2align 6
.amdhsa_kernel fz_kernel
  .amdhsa_next_free_vgpr 512
  .amdhsa_next_free_sgpr 102
  .amdhsa_accum_offset 256
  .amdhsa_group_segment_fixed_size 0
  .amdhsa_kernarg_size 88
  .amdhsa_user_sgpr_count 2
  .amdhsa_user_sgpr_kernarg_segment_ptr 1
  .amdhsa_system_sgpr_workgroup_id_x 1
.end_amdhsa_kernel
```
